```python
import torch

def _softmax(x, axis=-1):
    return torch.softmax(x, dim=axis)
def _gelu(x):
    return torch.nn.functional.gelu(x, approximate="tanh")
def _silu(x):
    return torch.nn.functional.silu(x)
def _sigmoid(x):
    return torch.sigmoid(x)
def _layernorm(x, axis=-1, eps=1e-5):
    m = x.mean(dim=axis, keepdim=True)
    v = x.var(dim=axis, keepdim=True, unbiased=False)
    return (x - m) / torch.sqrt(v + eps)
def _scatter_add(tgt, idx, src, axis=0):
    return tgt.clone().index_add_(axis, idx, src)
def _segment_sum(src, seg, n):
    out = torch.zeros((n,) + src.shape[1:], dtype=src.dtype)
    return out.index_add_(0, seg, src)
def _pad(x, pw):
    flat = tuple(v for pair in reversed(pw) for v in pair)
    return torch.nn.functional.pad(x, flat)

kernel_name = 'sequential_preLN__sliding_local_dilated__dense_activation_gelu__prompt'

def setup_inputs():

    _w = (lambda a: (lambda t: t.to(torch.bfloat16) if t.is_floating_point() else t)(torch.as_tensor(a)))
    def _A_setup():
        B, S, D = 1, 2048, 448
        return {
            "x": _w((lambda *s: torch.randn(*s, dtype=torch.bfloat16) * 0.05)(B, S, D)),
            "wqkv": _w((lambda *s: torch.randn(*s, dtype=torch.bfloat16) * 0.05)(D, 3 * D)),
            "wo": _w((lambda *s: torch.randn(*s, dtype=torch.bfloat16) * 0.05)(D, D)),
        }
    _A_in = _A_setup()

    def _B_setup():
        B, S, D, F = 1, 2048, 448, 1792
        return {
            "x": _w((lambda *s: torch.randn(*s, dtype=torch.bfloat16) * 0.05)(B, S, D)),
            "w1": _w((lambda *s: torch.randn(*s, dtype=torch.bfloat16) * 0.8)(D, F) * (D ** -0.5)),
            "b1": _w((lambda *s: torch.randn(*s, dtype=torch.bfloat16) * 0.8)(F) * 0.01),
            "w2": _w((lambda *s: torch.randn(*s, dtype=torch.bfloat16) * 0.8)(F, D) * (F ** -0.5)),
            "b2": _w((lambda *s: torch.randn(*s, dtype=torch.bfloat16) * 0.8)(D) * 0.01),
        }
    _B_in = _B_setup()

    return {
        "A_x": _A_in["x"],
        "A_wqkv": _A_in["wqkv"],
        "A_wo": _A_in["wo"],
        "B_x": _B_in["x"],
        "B_w1": _B_in["w1"],
        "B_b1": _B_in["b1"],
        "B_w2": _B_in["w2"],
        "B_b2": _B_in["b2"],
    }

def reference(A_x, A_wqkv, A_wo, B_x, B_w1, B_b1, B_w2, B_b2):
    def _A_ref(x, wqkv, wo):
        B, S, D = x.shape
        H = 16; Dh = D // H
        W, dil = 8, 2
        qkv = (lambda x, *d: x.permute(*d))((x @ wqkv).reshape(B, S, 3, H, Dh), 2, 0, 3, 1, 4)
        q, k, v = qkv[0], qkv[1], qkv[2]
        scale = Dh ** -0.5
        pos = torch.arange(S)
        off = torch.arange(W) * dil
        idx = pos[:, None] - off[None, :]
        mask = idx >= 0
        idx_c = torch.where(mask, idx, 0).reshape(-1)
        kg = k[:, :, idx_c, :].reshape(B, H, S, W, Dh)
        vg = v[:, :, idx_c, :].reshape(B, H, S, W, Dh)
        logits = torch.einsum("bhsd,bhswd->bhsw", q, kg) * scale
        logits = torch.where(mask[None, None, :, :], logits, -1e9)
        attn = _softmax(logits, axis=-1)
        o = torch.einsum("bhsw,bhswd->bhsd", attn, vg)
        return (lambda x, *d: x.permute(*d))(o, 0, 2, 1, 3).reshape(B, S, D) @ wo

    def _B_ref(x, w1, b1, w2, b2):
        h = torch.einsum("bsd,df->bsf", x, w1) + b1
        h = _gelu(h)
        return torch.einsum("bsf,fd->bsd", h, w2) + b2

    x = A_x
    h = x + _A_ref(_layernorm(x, axis=-1), A_wqkv, A_wo)
    h2 = h + _B_ref(_layernorm(h, axis=-1), B_w1, B_b1, B_w2, B_b2)
    return h2
```

```asm
; @launch grid=(256,1,1) block=(256,1,1) lds=163840
.amdgcn_target "amdgcn-amd-amdhsa--gfx950"
.text
.globl sequential_preLN__sliding_local_dilated__dense_activation_gelu__prompt_kernel
.p2align 8
.type sequential_preLN__sliding_local_dilated__dense_activation_gelu__prompt_kernel,@function
sequential_preLN__sliding_local_dilated__dense_activation_gelu__prompt_kernel:
    s_cmp_ge_u32 s2, 256
    s_cbranch_scc1 Lend
    s_load_dwordx2 s[8:9], s[0:1], 0
    s_load_dwordx2 s[12:13], s[0:1], 8
    s_load_dwordx2 s[16:17], s[0:1], 16
    s_load_dwordx2 s[20:21], s[0:1], 32
    s_load_dwordx2 s[28:29], s[0:1], 40
    s_load_dwordx2 s[24:25], s[0:1], 48
    s_load_dwordx2 s[32:33], s[0:1], 56
    s_getpc_b64 s[94:95]
    s_lshr_b32 s92, s2, 3
    s_mul_i32 s93, s92, 2304
    v_lshrrev_b32 v1, 3, v0
    v_min_u32 v1, 17, v1
    v_lshl_add_u32 v1, v1, 7, s93
    global_load_dword v1, v1, s[94:95]
    s_load_dwordx2 s[36:37], s[0:1], 64
    s_load_dwordx2 s[40:41], s[0:1], 80
    v_lshrrev_b32 v5, 6, v0
    v_and_b32 v2, 63, v0
    v_readfirstlane_b32 s67, v5
    s_and_b32 s65, s92, 3
    s_lshr_b32 s66, s92, 2
    s_and_b32 s93, s2, 7
    s_lshl_b32 s64, s93, 2
    s_add_u32 s64, s64, s65
    v_lshrrev_b32 v5, 3, v2
    v_and_b32 v8, 7, v2
    v_lshrrev_b32 v9, 4, v2
    v_and_b32 v16, 1, v9
    v_lshlrev_b32 v16, 1, v16
    v_xor_b32 v16, v16, v8
    v_mul_u32_u24 v17, 2688, v5
    v_lshl_add_u32 v11, v16, 4, v17
    v_xor_b32 v16, 4, v16
    v_add_u32 v17, 20480, v17
    v_lshl_add_u32 v12, v16, 4, v17
    s_mul_i32 s94, s64, 57344
    s_sub_u32 s94, s94, 14336
    s_and_b32 s95, s67, 1
    s_lshl_b32 s92, s95, 2
    v_xor_b32 v16, v9, v8
    v_xor_b32 v16, s92, v16
    v_mul_u32_u24 v17, 896, v5
    v_lshl_add_u32 v10, v16, 4, v17
    s_mul_i32 s92, s67, 7168
    s_add_u32 s92, s92, s94
    s_max_i32 s93, s92, 0
    v_add_u32 v13, s93, v10
    s_add_u32 s93, s92, 28672
    v_add_u32 v14, s93, v10
    s_mul_i32 s92, s95, 7168
    s_add_u32 s92, s92, s94
    s_add_u32 s92, s92, 57344
    v_add_u32 v15, s92, v10
    s_lshl_b32 s77, s95, 10
    s_mul_i32 s80, s67, 43008
    s_lshl_b32 s92, s66, 7
    s_add_u32 s80, s80, s92
    s_lshl_b32 s81, s67, 12
    s_lshl_b32 s82, s67, 10
    s_and_b32 s92, s2, 7
    s_and_b32 s93, s65, 1
    s_mov_b32 s74, s92
    s_mul_i32 s92, s74, 37
    s_lshr_b32 s92, s92, 8
    s_mul_i32 s92, s92, 7
    s_sub_u32 s74, s74, s92
    s_sub_u32 s97, s66, s74
    s_cselect_b32 s92, 7, 0
    s_add_u32 s97, s97, s92
    s_mov_b32 s10, 1835008
    s_mov_b32 s11, 0x20000
    s_mov_b32 s14, 1204224
    s_mov_b32 s15, 0x20000
    s_mov_b32 s18, 401408
    s_mov_b32 s19, 0x20000
    s_mov_b32 s22, 1605632
    s_mov_b32 s23, 0x20000
    s_mov_b32 s30, 3584
    s_mov_b32 s31, 0x20000
    s_mov_b32 s26, 1605632
    s_mov_b32 s27, 0x20000
    s_mov_b32 s34, 896
    s_mov_b32 s35, 0x20000
    s_mov_b32 s38, 1835008
    s_mov_b32 s39, 0x20000
    s_mov_b32 s42, 2097152
    s_mov_b32 s43, 0x20000
    v_lshlrev_b32 v3, 4, v2
    v_mov_b32 v4, 0
    s_lshr_b32 s93, s65, 1
    s_mul_i32 s54, s93, 4096
    s_add_u32 s54, s54, 516096
    s_and_b32 s96, s65, 1
    s_mul_i32 s96, s96, 7
    s_add_u32 s96, s96, s66
    s_mul_i32 s70, s67, 7168
    s_mul_i32 s95, s66, 57472
    s_add_u32 s70, s70, s95
    s_mul_i32 s71, s67, 1024
    s_add_u32 s71, s71, 106496
    s_mul_i32 s72, s67, 57344
    s_mul_i32 s95, s96, 256
    s_add_u32 s72, s72, s95
    s_mul_i32 s73, s67, 4096
    s_mul_i32 s57, s65, 57344
    s_mul_i32 s95, s67, 14336
    s_add_u32 s57, s57, s95
    s_mul_i32 s48, s66, 2048
    s_add_u32 s48, s48, s57
    s_mul_i32 s47, s65, 49152
    s_mul_i32 s95, s67, 1024
    s_add_u32 s47, s47, s95
    s_add_u32 s47, s47, 1441792
    s_lshl_b32 s83, s67, 11
    s_mov_b32 s84, 0x22222222
    s_mov_b32 s85, 0x22222222
    s_mov_b32 s86, 0x44444444
    s_mov_b32 s87, 0x44444444
    s_mov_b32 s88, 0x88888888
    s_mov_b32 s89, 0x88888888
    s_mov_b32 s90, 0
    s_mov_b32 s91, 0xffff0000
    s_mov_b32 s98, 0
    s_mov_b32 s99, -1
    s_mov_b32 s78, 0xffff0000
    s_mov_b32 s79, -1
    s_mul_i32 s75, s74, 172032
    s_add_u32 s75, s75, s80
    s_lshl_b32 s76, s74, 7
    s_add_u32 s74, s74, 1
    s_cmp_eq_u32 s74, 7
    s_cselect_b32 s74, 0, s74
    s_cmp_eq_u32 s66, 7
    s_cbranch_scc1 Lhelper
    s_waitcnt lgkmcnt(0)
    s_add_u32 m0, s82, 73728
    s_nop 0
    buffer_load_dwordx4 v13, s[8:11], s76 offen lds
    s_add_u32 m0, s81, 57344
    s_nop 0
    buffer_load_dwordx4 v11, s[12:15], s75 offen offset:0 lds
    buffer_load_dwordx4 v12, s[12:15], s75 offen offset:1024 lds
    s_add_u32 m0, s77, 81920
    s_nop 0
    buffer_load_dwordx4 v15, s[8:11], s76 offen lds
    s_add_u32 m0, s81, 58496
    s_nop 0
    buffer_load_dwordx4 v11, s[12:15], s75 offen offset:896 lds
    buffer_load_dwordx4 v12, s[12:15], s75 offen offset:1920 lds
    s_add_u32 m0, s82, 77824
    s_nop 0
    buffer_load_dwordx4 v14, s[8:11], s76 offen lds
    s_and_b32 s92, s2, 7
    s_lshl_b32 s92, s92, 21
    s_add_u32 s40, s40, s92
    s_addc_u32 s41, s41, 0
    s_buffer_load_dwordx2 s[68:69], s[40:43], s54 offset:3840
    s_add_u32 s1, s80, 1792
    s_mul_i32 s75, s74, 172032
    s_add_u32 s75, s75, s80
    s_lshl_b32 s76, s74, 7
    s_add_u32 s74, s74, 1
    s_cmp_eq_u32 s74, 7
    s_cselect_b32 s74, 0, s74
    s_add_u32 m0, s82, 100368
    s_nop 0
    buffer_load_dwordx4 v13, s[8:11], s76 offen lds
    s_add_u32 m0, s81, 83984
    s_nop 0
    buffer_load_dwordx4 v11, s[12:15], s75 offen offset:0 lds
    v_mov_b32 v20, 0x3f803f80
    v_mov_b32 v21, 0x3f803f80
    v_mov_b32 v22, 0x3f803f80
    v_mov_b32 v23, 0x3f803f80
    v_mov_b32 v16, 83968
    ds_write_b128 v16, v[20:23] offset:0
    ds_write_b128 v16, v[20:23] offset:26640
    ds_write_b128 v16, v[20:23] offset:53280
    ds_write_b128 v16, v[20:23] offset:63536
    ds_write_b128 v4, v[20:23] offset:57328
    v_bfe_u32 v5, v2, 2, 2
    v_bfe_u32 v8, v2, 4, 1
    v_lshl_add_u32 v9, v8, 3, v5
    v_lshlrev_b32 v9, 7, v9
    v_bfe_u32 v5, v2, 3, 1
    v_lshl_or_b32 v5, v8, 1, v5
    v_xor_b32 v5, s67, v5
    v_lshl_add_u32 v9, v5, 5, v9
    v_and_b32 v8, 3, v2
    v_lshl_add_u32 v9, v8, 3, v9
    v_lshrrev_b32 v10, 5, v2
    v_lshl_add_u32 v18, v10, 11, v9
    v_lshl_add_u32 v17, v10, 12, v9
    v_add_u32 v17, 57344, v17
    v_and_b32 v5, 15, v2
    v_lshrrev_b32 v8, 4, v2
    v_lshrrev_b32 v9, 1, v5
    v_xor_b32 v8, v8, v9
    v_lshlrev_b32 v8, 4, v8
    v_lshl_add_u32 v8, v5, 7, v8
    v_add_u32 v19, 73728, v8
    v_xor_b32 v24, 64, v19
    v_cmp_eq_u32 vcc, 0, v5
    s_add_u32 s92, s83, 2048
    s_nop 0
    v_cndmask_b32 v25, v19, v16, vcc
    v_add_u32 v27, s92, v19
    v_cndmask_b32 v26, v24, v16, vcc
    v_add_u32 v28, s92, v24
    v_lshrrev_b32 v8, 5, v2
    v_lshrrev_b32 v9, 1, v5
    v_xor_b32 v8, v8, v9
    v_lshlrev_b32 v8, 4, v8
    v_bfe_u32 v9, v2, 4, 1
    v_lshl_add_u32 v8, v9, 3, v8
    v_lshl_add_u32 v8, v5, 7, v8
    s_add_u32 s92, s97, 1
    s_and_b32 s92, s92, 3
    s_mul_i32 s92, s92, 26640
    s_cmp_eq_u32 s97, 6
    s_cselect_b32 s92, 90176, s92
    s_min_u32 s97, s97, 5
    s_add_u32 s92, s92, s83
    s_add_u32 s92, s92, 49136
    v_xor_b32 v9, 0, v8
    v_add_u32 v40, s92, v9
    v_xor_b32 v9, 32, v8
    v_add_u32 v41, s92, v9
    v_xor_b32 v9, 64, v8
    v_add_u32 v42, s92, v9
    v_xor_b32 v9, 96, v8
    v_add_u32 v43, s92, v9
    buffer_load_dwordx4 v12, s[12:15], s75 offen offset:1024 lds
    s_add_u32 m0, s77, 108560
    s_nop 0
    buffer_load_dwordx4 v15, s[8:11], s76 offen lds
    s_add_u32 m0, s81, 85136
    s_nop 0
    buffer_load_dwordx4 v11, s[12:15], s75 offen offset:896 lds
    v_lshrrev_b32 v8, 4, v2
    v_lshlrev_b32 v8, 2, v8
    v_sub_u32 v8, v5, v8
    v_mov_b32 v16, 0xf149f2ca
    v_add_u32 v9, 16, v8
    v_and_b32 v9, 0xfffffff1, v9
    v_mov_b32 v10, 0xffff
    v_cmp_eq_u32 vcc, 0, v9
    s_nop 1
    v_cndmask_b32 v44, v16, v4, vcc
    v_cndmask_b32 v52, v4, v10, vcc
    v_add_u32 v9, 15, v8
    v_and_b32 v9, 0xfffffff1, v9
    v_mov_b32 v10, 0xffff0000
    v_cmp_eq_u32 vcc, 0, v9
    s_nop 1
    v_cndmask_b32 v45, v16, v4, vcc
    v_cndmask_b32 v52, v52, v10, vcc
    v_add_u32 v9, 14, v8
    v_and_b32 v9, 0xfffffff1, v9
    v_mov_b32 v10, 0xffff
    v_cmp_eq_u32 vcc, 0, v9
    s_nop 1
    v_cndmask_b32 v46, v16, v4, vcc
    v_cndmask_b32 v53, v4, v10, vcc
    v_add_u32 v9, 13, v8
    v_and_b32 v9, 0xfffffff1, v9
    v_mov_b32 v10, 0xffff0000
    v_cmp_eq_u32 vcc, 0, v9
    s_nop 1
    v_cndmask_b32 v47, v16, v4, vcc
    v_cndmask_b32 v53, v53, v10, vcc
    v_add_u32 v9, 0, v8
    v_and_b32 v9, 0xfffffff1, v9
    v_mov_b32 v10, 0xffff
    v_cmp_eq_u32 vcc, 0, v9
    s_nop 1
    v_cndmask_b32 v48, v16, v4, vcc
    v_cndmask_b32 v54, v4, v10, vcc
    v_add_u32 v9, -1, v8
    v_and_b32 v9, 0xfffffff1, v9
    v_mov_b32 v10, 0xffff0000
    v_cmp_eq_u32 vcc, 0, v9
    s_nop 1
    v_cndmask_b32 v49, v16, v4, vcc
    v_cndmask_b32 v54, v54, v10, vcc
    v_add_u32 v9, -2, v8
    v_and_b32 v9, 0xfffffff1, v9
    v_mov_b32 v10, 0xffff
    v_cmp_eq_u32 vcc, 0, v9
    s_nop 1
    v_cndmask_b32 v50, v16, v4, vcc
    v_cndmask_b32 v55, v4, v10, vcc
    v_add_u32 v9, -3, v8
    v_and_b32 v9, 0xfffffff1, v9
    v_mov_b32 v10, 0xffff0000
    v_cmp_eq_u32 vcc, 0, v9
    s_nop 1
    v_cndmask_b32 v51, v16, v4, vcc
    v_cndmask_b32 v55, v55, v10, vcc
    s_or_b32 s92, s67, s64
    s_cmp_eq_u32 s92, 0
    s_cselect_b32 s92, 0xf149f2ca, 0
    v_min_f32 v44, s92, v44
    v_min_f32 v45, s92, v45
    v_min_f32 v46, s92, v46
    v_min_f32 v47, s92, v47
    v_lshlrev_b32 v8, 2, v5
    v_add_u32 v29, 77056, v8
    s_mul_i32 s92, s67, 64
    s_add_u32 s92, s92, 64
    v_add_u32 v30, s92, v29
    v_lshrrev_b32 v8, 4, v2
    v_and_b32 v9, 1, v5
    v_lshl_add_u32 v8, v8, 2, v9
    s_add_u32 s92, s92, 77312
    v_add_u32 v9, 16, v8
    v_cmp_le_u32 vcc, v8, v5
    s_nop 1
    v_cndmask_b32 v9, v8, v9, vcc
    v_lshl_add_u32 v60, v9, 2, s92
    v_add_u32 v8, 2, v8
    v_add_u32 v9, 16, v8
    v_cmp_le_u32 vcc, v8, v5
    s_nop 1
    v_cndmask_b32 v9, v8, v9, vcc
    v_lshl_add_u32 v61, v9, 2, s92
    s_mov_b32 vcc_lo, 0x00f0000f
    s_mov_b32 vcc_hi, 0xf0000f00
    v_lshlrev_b32 v8, 2, v2
    v_add_u32 v8, 77696, v8
    v_cndmask_b32 v62, v8, v30, vcc
    v_cndmask_b32 v63, v8, v29, vcc
    v_and_b32 v8, 0x30, v2
    v_add_u32 v31, 77056, v8
    v_lshrrev_b32 v8, 1, v8
    v_mul_u32_u24 v9, 136, v5
    s_mov_b32 s92, 57344
    v_add3_u32 v8, v8, v9, s92
    s_lshl_b32 s92, s67, 5
    v_add_u32 v56, s92, v8
    s_mul_i32 s92, s67, 2176
    v_add_u32 v57, s92, v8
    v_lshlrev_b32 v8, 3, v2
    s_mul_i32 s92, s67, 2560
    s_add_u32 s92, s92, 96256
    v_add_u32 v58, s92, v8
    s_mul_i32 s92, s67, 512
    s_add_u32 s92, s92, 96256
    v_add_u32 v59, s92, v8
    v_lshrrev_b32 v5, 4, v2
    v_lshlrev_b32 v8, 5, v5
    v_and_b32 v9, 0x70, v3
    v_xor_b32 v8, v8, v9
    v_lshrrev_b32 v10, 3, v2
    v_mul_u32_u24 v10, 896, v10
    v_add_u32 v64, v8, v10
    v_and_b32 v8, 1, v5
    v_lshlrev_b32 v8, 6, v8
    v_xor_b32 v8, v8, v9
    v_add_u32 v65, v8, v10
    v_add_u32 v66, 6144, v65
    v_lshlrev_b32 v8, 6, v5
    v_and_b32 v9, 0xf0, v3
    v_xor_b32 v8, v8, v9
    v_mul_u32_u24 v5, 3584, v5
    v_add_u32 v67, v5, v8
    v_add_u32 v68, 13312, v67
    v_add_u32 v69, 26624, v67
    v_add_u32 v70, 39936, v67
    v_lshrrev_b32 v5, 2, v2
    v_bfe_u32 v8, v2, 3, 2
    v_lshlrev_b32 v8, 5, v8
    v_and_b32 v9, 3, v2
    v_lshl_or_b32 v8, v9, 3, v8
    v_lshl_add_u32 v5, v5, 7, v8
    v_add_u32 v5, 106496, v5
    v_xor_b32 v71, 0, v5
    v_xor_b32 v72, 32, v5
    v_xor_b32 v73, 64, v5
    v_xor_b32 v74, 96, v5
    buffer_load_dwordx4 v12, s[12:15], s75 offen offset:1920 lds
    s_add_u32 m0, s82, 104464
    s_nop 0
    buffer_load_dwordx4 v14, s[8:11], s76 offen lds
    s_mov_b64 exec, 0
    s_cmp_eq_u32 s67, 3
    s_cbranch_scc1 Ljoin
    s_cmp_eq_u32 s66, 0
    s_cbranch_scc1 Ltr0
    s_cmp_eq_u32 s66, 1
    s_cbranch_scc1 Ltr1
    s_cmp_eq_u32 s66, 2
    s_cbranch_scc1 Ltr2
    s_cmp_eq_u32 s66, 3
    s_cbranch_scc1 Ltr3
    s_cmp_eq_u32 s66, 4
    s_cbranch_scc1 Ltr4
    s_cmp_eq_u32 s66, 5
    s_cbranch_scc1 Ltr5
Ltr6:
    s_cmp_eq_u32 s67, 1
    s_cbranch_scc1 Lv6_1
    s_cmp_eq_u32 s67, 2
    s_cbranch_scc1 Lv6_2
    s_branch Lvar6
Ltr0:
    s_cmp_eq_u32 s67, 1
    s_cbranch_scc1 Lv0_1
    s_cmp_eq_u32 s67, 2
    s_cbranch_scc1 Lv0_2
    s_branch Lvar0
Ltr1:
    s_cmp_eq_u32 s67, 1
    s_cbranch_scc1 Lv1_1
    s_cmp_eq_u32 s67, 2
    s_cbranch_scc1 Lv1_2
    s_branch Lvar1
Ltr2:
    s_cmp_eq_u32 s67, 1
    s_cbranch_scc1 Lv2_1
    s_cmp_eq_u32 s67, 2
    s_cbranch_scc1 Lv2_2
    s_branch Lvar2
Ltr3:
    s_cmp_eq_u32 s67, 1
    s_cbranch_scc1 Lv3_1
    s_cmp_eq_u32 s67, 2
    s_cbranch_scc1 Lv3_2
    s_branch Lvar3
Ltr4:
    s_cmp_eq_u32 s67, 1
    s_cbranch_scc1 Lv4_1
    s_cmp_eq_u32 s67, 2
    s_cbranch_scc1 Lv4_2
    s_branch Lvar4
Ltr5:
    s_cmp_eq_u32 s67, 1
    s_cbranch_scc1 Lv5_1
    s_cmp_eq_u32 s67, 2
    s_cbranch_scc1 Lv5_2
    s_branch Lvar5
Lres0:
    ds_read_b64 v[32:33], v40
    ds_read_b64 v[34:35], v41
    ds_read_b64 v[36:37], v42
    ds_read_b64 v[38:39], v43
    s_waitcnt lgkmcnt(0)
    s_branch Lresb0
Lres1:
    ds_read_b64 v[32:33], v40
    ds_read_b64 v[34:35], v41
    ds_read_b64 v[36:37], v42
    ds_read_b64 v[38:39], v43
    s_waitcnt lgkmcnt(0)
    s_branch Lresb1
Lres2:
    ds_read_b64 v[32:33], v40
    ds_read_b64 v[34:35], v41
    ds_read_b64 v[36:37], v42
    ds_read_b64 v[38:39], v43
    s_waitcnt lgkmcnt(0)
    s_branch Lresb2
Lres3:
    ds_read_b64 v[32:33], v40
    ds_read_b64 v[34:35], v41
    ds_read_b64 v[36:37], v42
    ds_read_b64 v[38:39], v43
    s_waitcnt lgkmcnt(0)
    s_branch Lresb3
Lres4:
    ds_read_b64 v[32:33], v40
    ds_read_b64 v[34:35], v41
    ds_read_b64 v[36:37], v42
    ds_read_b64 v[38:39], v43
    s_waitcnt lgkmcnt(0)
    s_branch Lresb4
Lres5:
    ds_read_b64 v[32:33], v40
    ds_read_b64 v[34:35], v41
    ds_read_b64 v[36:37], v42
    ds_read_b64 v[38:39], v43
    s_waitcnt lgkmcnt(0)
    s_branch Lresb5
Lhelper:
    s_waitcnt lgkmcnt(0)
    v_mul_u32_u24 v20, 37, v2
    v_lshrrev_b32 v20, 8, v20
    v_mul_u32_u24 v21, 1792, v20
    v_lshl_add_u32 v21, v2, 7, v21
    v_lshlrev_b32 v20, 7, v2
    s_mul_i32 s93, s65, 4
    s_add_u32 s93, s93, s67
    s_and_b32 s92, s2, 7
    s_mul_i32 s94, s93, 8
    s_add_u32 s94, s94, s92
    s_mov_b64 exec, -1
    s_and_b32 s92, s2, 7
    s_mul_i32 s97, s92, 229376
    s_mul_i32 s95, s93, 15232
    s_add_u32 s97, s97, s95
    s_sub_u32 s97, s97, 14336
    s_max_i32 s97, s97, 0
    s_add_u32 s3, s97, 0
    buffer_load_dword v1, v20, s[8:11], s3 offen
    s_mov_b32 exec_hi, 0x7fffff
    s_add_u32 s3, s97, 8192
    buffer_load_dword v1, v20, s[8:11], s3 offen
    s_mov_b64 exec, -1
    s_and_b32 s92, s2, 7
    s_lshl_b32 s92, s92, 21
    s_add_u32 s40, s40, s92
    s_addc_u32 s41, s41, 0
    s_mov_b32 exec_lo, 0x1ffffff
    s_mov_b32 exec_hi, 0x0
    s_mul_i32 s92, s94, 3200
    s_add_u32 s3, s92, 0
    buffer_load_dword v1, v20, s[16:19], s3 offen
    s_mov_b32 exec_lo, 0xfffffff
    s_mov_b32 exec_hi, 0x0
    s_mul_i32 s3, s94, 10752
    buffer_load_dword v1, v21, s[12:15], s3 offen offset:1792
    s_mov_b32 exec_lo, 0xffffffff
    s_mov_b32 exec_hi, 0x1ffff
    s_mul_i32 s92, s94, 12544
    s_add_u32 s3, s92, 0
    buffer_load_dword v1, v20, s[20:23], s3 offen
    s_add_u32 s3, s92, 6272
    buffer_load_dword v1, v20, s[20:23], s3 offen
    s_mov_b32 exec_lo, 0xffffffff
    s_mov_b32 exec_hi, 0x1ffff
    s_mul_i32 s92, s94, 12544
    s_add_u32 s3, s92, 0
    buffer_load_dword v1, v20, s[24:27], s3 offen
    s_add_u32 s3, s92, 6272
    buffer_load_dword v1, v20, s[24:27], s3 offen
    s_mov_b32 exec_lo, 0xff
    s_mov_b32 exec_hi, 0x0
    s_lshl_b32 s92, s93, 10
    s_add_u32 s3, s92, 507904
    buffer_load_dword v1, v20, s[40:43], s3 offen
    s_mov_b32 exec_lo, 0x3
    s_mov_b32 exec_hi, 0x0
    s_lshl_b32 s3, s93, 8
    buffer_load_dword v1, v20, s[28:31], s3 offen
    buffer_load_dword v1, v20, s[32:35], s3 offen
    s_mov_b32 exec_lo, 0xffffffff
    s_mov_b32 exec_hi, 0x1ffff
    s_mul_i32 s92, s93, 6272
    s_add_u32 s3, s92, 401408
    s_add_u32 s92, s92, 1605632
Lh_1:
    buffer_load_dword v1, v20, s[20:23], s3 offen
    s_add_u32 s3, s3, 100352
    s_cmp_lt_u32 s3, s92
    s_cbranch_scc1 Lh_1
    s_mov_b32 exec_lo, 0xffffffff
    s_mov_b32 exec_hi, 0x1ffff
    s_mul_i32 s92, s93, 6272
    s_add_u32 s3, s92, 0
    s_add_u32 s92, s92, 401408
Lh_2:
    buffer_load_dword v1, v20, s[24:27], s3 offen
    s_add_u32 s3, s3, 100352
    s_cmp_lt_u32 s3, s92
    s_cbranch_scc1 Lh_2
    s_mov_b32 exec_lo, 0xf
    s_mov_b32 exec_hi, 0x0
    s_lshl_b32 s92, s93, 9
    s_add_u32 s3, s92, 516096
    buffer_load_dword v1, v20, s[40:43], s3 offen
    s_mov_b32 exec_lo, 0xffffffff
    s_mov_b32 exec_hi, 0x1ffff
    s_mul_i32 s92, s93, 6272
    s_add_u32 s3, s92, 401408
    s_add_u32 s92, s92, 1605632
Lh_3:
    buffer_load_dword v1, v20, s[24:27], s3 offen
    s_add_u32 s3, s3, 100352
    s_cmp_lt_u32 s3, s92
    s_cbranch_scc1 Lh_3
    s_mov_b64 exec, -1
    s_branch Lfin
.p2align 12
Lback:
    s_mov_b64 exec, -1
    s_waitcnt vmcnt(7)
    s_waitcnt lgkmcnt(0)
    s_barrier
    ds_read_b128 v[168:171], v27 offset:0
    ds_read_b128 a[0:3], v25 offset:0
    ds_read_b64_tr_b16 v[152:153], v17 offset:0
    ds_read_b64_tr_b16 v[154:155], v17 offset:512
    ds_read_b128 a[4:7], v19 offset:2048
    ds_read_b128 a[8:11], v19 offset:4096
    ds_read_b128 a[12:15], v19 offset:6144
    ds_read_b128 a[16:19], v19 offset:8192
    ds_read_b64_tr_b16 v[156:157], v17 offset:2048
    ds_read_b64_tr_b16 v[158:159], v17 offset:2560
    s_mul_i32 s68, s68, 0x9E3779B1
    s_add_u32 s68, s68, 0x7F4A7C15
    s_mul_i32 s69, s69, 0x85EBCA6B
    s_add_u32 s69, s69, 0x165667B1
    v_mov_b32 v6, s68
    v_mov_b32 v7, s69
    s_waitcnt lgkmcnt(9)
    v_mfma_f32_16x16x32_bf16 v[116:119], v[168:171], v[168:171], 0
    s_mul_i32 s75, s74, 172032
    s_add_u32 s75, s75, s80
    s_lshl_b32 s76, s74, 7
    s_add_u32 s74, s74, 1
    s_cmp_eq_u32 s74, 7
    s_cselect_b32 s74, 0, s74
    s_add_u32 m0, s82, 127008
    ds_read_b128 v[172:175], v28 offset:0
    v_mfma_f32_16x16x32_bf16 v[124:127], v[20:23], v[168:171], 0
    s_waitcnt lgkmcnt(9)
    buffer_load_dwordx4 v13, s[8:11], s76 offen lds
    ds_read_b128 a[20:23], v26 offset:0
    v_mfma_f32_16x16x32_bf16 v[120:123], a[0:3], a[0:3], 0
    s_waitcnt lgkmcnt(8)
    s_add_u32 m0, s81, 110624
    ds_read_b64_tr_b16 v[160:161], v17 offset:8192
    v_mfma_f32_16x16x32_bf16 v[76:79], v[152:155], a[0:3], 0
    s_waitcnt lgkmcnt(8)
    buffer_load_dwordx4 v11, s[12:15], s75 offen offset:0 lds
    ds_read_b64_tr_b16 v[162:163], v17 offset:8704
    v_mfma_f32_16x16x32_bf16 v[80:83], v[152:155], a[4:7], 0
    s_waitcnt lgkmcnt(8)
    ds_read_b128 a[24:27], v24 offset:2048
    v_mfma_f32_16x16x32_bf16 v[84:87], v[152:155], a[8:11], 0
    s_waitcnt lgkmcnt(8)
    buffer_load_dwordx4 v12, s[12:15], s75 offen offset:1024 lds
    ds_read_b128 a[28:31], v24 offset:4096
    v_mfma_f32_16x16x32_bf16 v[88:91], v[152:155], a[12:15], 0
    s_waitcnt lgkmcnt(8)
    ds_read_b128 a[32:35], v24 offset:6144
    v_mfma_f32_16x16x32_bf16 v[92:95], v[152:155], a[16:19], 0
    s_waitcnt lgkmcnt(7)
    s_add_u32 m0, s77, 135200
    ds_read_b128 a[36:39], v24 offset:8192
    v_mfma_f32_16x16x32_bf16 v[96:99], v[156:159], a[0:3], 0
    buffer_load_dwordx4 v15, s[8:11], s76 offen lds
    ds_read_b64_tr_b16 v[164:165], v17 offset:10240
    v_mfma_f32_16x16x32_bf16 v[100:103], v[156:159], a[4:7], 0
    s_add_u32 m0, s81, 111776
    ds_read_b64_tr_b16 v[166:167], v17 offset:10752
    v_mfma_f32_16x16x32_bf16 v[104:107], v[156:159], a[8:11], 0
    buffer_load_dwordx4 v11, s[12:15], s75 offen offset:896 lds
    v_mfma_f32_16x16x32_bf16 v[108:111], v[156:159], a[12:15], 0
    v_mfma_f32_16x16x32_bf16 v[112:115], v[156:159], a[16:19], 0
    s_waitcnt lgkmcnt(9)
    buffer_load_dwordx4 v12, s[12:15], s75 offen offset:1920 lds
    v_mfma_f32_16x16x32_bf16 v[116:119], v[172:175], v[172:175], v[116:119]
    v_mfma_f32_16x16x32_bf16 v[124:127], v[20:23], v[172:175], v[124:127]
    s_waitcnt lgkmcnt(8)
    s_add_u32 m0, s82, 131104
    v_mfma_f32_16x16x32_bf16 v[120:123], a[20:23], a[20:23], v[120:123]
    s_waitcnt lgkmcnt(6)
    buffer_load_dwordx4 v14, s[8:11], s76 offen lds
    v_mfma_f32_16x16x32_bf16 v[76:79], v[160:163], a[20:23], v[76:79]
    s_waitcnt lgkmcnt(5)
    s_mul_i32 s75, s74, 172032
    s_add_u32 s75, s75, s80
    s_lshl_b32 s76, s74, 7
    s_add_u32 s74, s74, 1
    s_cmp_eq_u32 s74, 7
    s_cselect_b32 s74, 0, s74
    s_add_u32 m0, s82, 47088
    v_mfma_f32_16x16x32_bf16 v[80:83], v[160:163], a[24:27], v[80:83]
    s_waitcnt lgkmcnt(4)
    buffer_load_dwordx4 v13, s[8:11], s76 offen lds
    v_mfma_f32_16x16x32_bf16 v[84:87], v[160:163], a[28:31], v[84:87]
    s_waitcnt lgkmcnt(3)
    v_mfma_f32_16x16x32_bf16 v[88:91], v[160:163], a[32:35], v[88:91]
    s_cmp_eq_u32 s97, 0
    s_cbranch_scc1 Lres0
Lresb0:
    s_waitcnt vmcnt(8)
    s_waitcnt lgkmcnt(0)
    s_barrier
    ds_read_b128 v[168:171], v27 offset:26640
    ds_read_b128 a[40:43], v25 offset:26640
    v_mfma_f32_16x16x32_bf16 v[92:95], v[160:163], a[36:39], v[92:95]
    s_add_u32 m0, s81, 30704
    ds_read_b64_tr_b16 v[152:153], v17 offset:26640
    ds_read_b64_tr_b16 v[154:155], v17 offset:27152
    v_mfma_f32_16x16x32_bf16 v[96:99], v[164:167], a[20:23], v[96:99]
    buffer_load_dwordx4 v11, s[12:15], s75 offen offset:0 lds
    ds_read_b128 a[44:47], v19 offset:28688
    v_mfma_f32_16x16x32_bf16 v[100:103], v[164:167], a[24:27], v[100:103]
    ds_read_b128 a[48:51], v19 offset:30736
    v_mfma_f32_16x16x32_bf16 v[104:107], v[164:167], a[28:31], v[104:107]
    buffer_load_dwordx4 v12, s[12:15], s75 offen offset:1024 lds
    ds_read_b128 a[52:55], v19 offset:32784
    ds_read_b128 a[56:59], v19 offset:34832
    v_mfma_f32_16x16x32_bf16 v[108:111], v[164:167], a[32:35], v[108:111]
    ds_read_b64_tr_b16 v[156:157], v17 offset:28688
    v_mfma_f32_16x16x32_bf16 v[112:115], v[164:167], a[36:39], v[112:115]
    s_waitcnt lgkmcnt(8)
    s_add_u32 m0, s77, 55280
    ds_read_b64_tr_b16 v[158:159], v17 offset:29200
    v_mfma_f32_16x16x32_bf16 v[116:119], v[168:171], v[168:171], v[116:119]
    buffer_load_dwordx4 v15, s[8:11], s76 offen lds
    ds_read_b128 v[172:175], v28 offset:26640
    v_mfma_f32_16x16x32_bf16 v[124:127], v[20:23], v[168:171], v[124:127]
    s_waitcnt lgkmcnt(9)
    ds_read_b128 a[60:63], v26 offset:26640
    v_mfma_f32_16x16x32_bf16 v[120:123], a[40:43], a[40:43], v[120:123]
    s_waitcnt lgkmcnt(8)
    s_add_u32 m0, s81, 31856
    ds_read_b64_tr_b16 v[160:161], v17 offset:34832
    v_mfma_f32_16x16x32_bf16 v[76:79], v[152:155], a[40:43], v[76:79]
    s_waitcnt lgkmcnt(8)
    buffer_load_dwordx4 v11, s[12:15], s75 offen offset:896 lds
    ds_read_b64_tr_b16 v[162:163], v17 offset:35344
    v_mfma_f32_16x16x32_bf16 v[80:83], v[152:155], a[44:47], v[80:83]
    s_waitcnt lgkmcnt(8)
    ds_read_b128 a[64:67], v24 offset:28688
    v_mfma_f32_16x16x32_bf16 v[84:87], v[152:155], a[48:51], v[84:87]
    s_waitcnt lgkmcnt(8)
    ds_read_b128 a[68:71], v24 offset:30736
    v_mfma_f32_16x16x32_bf16 v[88:91], v[152:155], a[52:55], v[88:91]
    s_waitcnt lgkmcnt(8)
    buffer_load_dwordx4 v12, s[12:15], s75 offen offset:1920 lds
    ds_read_b128 a[72:75], v24 offset:32784
    v_mfma_f32_16x16x32_bf16 v[92:95], v[152:155], a[56:59], v[92:95]
    s_waitcnt lgkmcnt(7)
    s_add_u32 m0, s82, 51184
    ds_read_b128 a[76:79], v24 offset:34832
    v_mfma_f32_16x16x32_bf16 v[96:99], v[156:159], a[40:43], v[96:99]
    buffer_load_dwordx4 v14, s[8:11], s76 offen lds
    ds_read_b64_tr_b16 v[164:165], v17 offset:36880
    v_mfma_f32_16x16x32_bf16 v[100:103], v[156:159], a[44:47], v[100:103]
    ds_read_b64_tr_b16 v[166:167], v17 offset:37392
    v_mfma_f32_16x16x32_bf16 v[104:107], v[156:159], a[48:51], v[104:107]
    s_mul_i32 s75, s74, 172032
    s_add_u32 s75, s75, s80
    s_lshl_b32 s76, s74, 7
    s_add_u32 s74, s74, 1
    s_cmp_eq_u32 s74, 7
    s_cselect_b32 s74, 0, s74
    s_add_u32 m0, s82, 73728
    v_mfma_f32_16x16x32_bf16 v[108:111], v[156:159], a[52:55], v[108:111]
    buffer_load_dwordx4 v13, s[8:11], s76 offen lds
    v_mfma_f32_16x16x32_bf16 v[112:115], v[156:159], a[56:59], v[112:115]
    s_waitcnt lgkmcnt(9)
    v_mfma_f32_16x16x32_bf16 v[116:119], v[172:175], v[172:175], v[116:119]
    s_add_u32 m0, s81, 57344
    v_mfma_f32_16x16x32_bf16 v[124:127], v[20:23], v[172:175], v[124:127]
    s_waitcnt lgkmcnt(8)
    buffer_load_dwordx4 v11, s[12:15], s75 offen offset:0 lds
    v_mfma_f32_16x16x32_bf16 v[120:123], a[60:63], a[60:63], v[120:123]
    s_waitcnt lgkmcnt(6)
    v_mfma_f32_16x16x32_bf16 v[76:79], v[160:163], a[60:63], v[76:79]
    s_waitcnt lgkmcnt(5)
    v_mfma_f32_16x16x32_bf16 v[80:83], v[160:163], a[64:67], v[80:83]
    s_waitcnt lgkmcnt(4)
    buffer_load_dwordx4 v12, s[12:15], s75 offen offset:1024 lds
    v_mfma_f32_16x16x32_bf16 v[84:87], v[160:163], a[68:71], v[84:87]
    s_waitcnt lgkmcnt(3)
    v_mfma_f32_16x16x32_bf16 v[88:91], v[160:163], a[72:75], v[88:91]
    s_cmp_eq_u32 s97, 1
    s_cbranch_scc1 Lres1
Lresb1:
    s_waitcnt vmcnt(10)
    s_waitcnt lgkmcnt(0)
    s_barrier
    ds_read_b128 v[168:171], v27 offset:53280
    ds_read_b128 a[80:83], v25 offset:53280
    v_mfma_f32_16x16x32_bf16 v[92:95], v[160:163], a[76:79], v[92:95]
    s_add_u32 m0, s77, 81920
    ds_read_b64_tr_b16 v[152:153], v17 offset:53280
    ds_read_b64_tr_b16 v[154:155], v17 offset:53792
    v_mfma_f32_16x16x32_bf16 v[96:99], v[164:167], a[60:63], v[96:99]
    buffer_load_dwordx4 v15, s[8:11], s76 offen lds
    ds_read_b128 a[84:87], v19 offset:55328
    v_mfma_f32_16x16x32_bf16 v[100:103], v[164:167], a[64:67], v[100:103]
    ds_read_b128 a[88:91], v19 offset:57376
    v_mfma_f32_16x16x32_bf16 v[104:107], v[164:167], a[68:71], v[104:107]
    s_add_u32 m0, s81, 58496
    ds_read_b128 a[92:95], v19 offset:59424
    ds_read_b128 a[96:99], v19 offset:61472
    v_mfma_f32_16x16x32_bf16 v[108:111], v[164:167], a[72:75], v[108:111]
    buffer_load_dwordx4 v11, s[12:15], s75 offen offset:896 lds
    ds_read_b64_tr_b16 v[156:157], v17 offset:55328
    v_mfma_f32_16x16x32_bf16 v[112:115], v[164:167], a[76:79], v[112:115]
    s_waitcnt lgkmcnt(8)
    ds_read_b64_tr_b16 v[158:159], v17 offset:55840
    v_mfma_f32_16x16x32_bf16 v[116:119], v[168:171], v[168:171], v[116:119]
    ds_read_b128 v[172:175], v28 offset:53280
    v_mfma_f32_16x16x32_bf16 v[124:127], v[20:23], v[168:171], v[124:127]
    s_waitcnt lgkmcnt(9)
    buffer_load_dwordx4 v12, s[12:15], s75 offen offset:1920 lds
    ds_read_b128 a[100:103], v26 offset:53280
    v_mfma_f32_16x16x32_bf16 v[120:123], a[80:83], a[80:83], v[120:123]
    s_waitcnt lgkmcnt(8)
    ds_read_b64_tr_b16 v[160:161], v17 offset:61472
    v_mfma_f32_16x16x32_bf16 v[76:79], v[152:155], a[80:83], v[76:79]
    s_waitcnt lgkmcnt(8)
    s_add_u32 m0, s82, 77824
    ds_read_b64_tr_b16 v[162:163], v17 offset:61984
    v_mfma_f32_16x16x32_bf16 v[80:83], v[152:155], a[84:87], v[80:83]
    s_waitcnt lgkmcnt(8)
    buffer_load_dwordx4 v14, s[8:11], s76 offen lds
    ds_read_b128 a[104:107], v24 offset:55328
    v_mfma_f32_16x16x32_bf16 v[84:87], v[152:155], a[88:91], v[84:87]
    s_waitcnt lgkmcnt(8)
    ds_read_b128 a[108:111], v24 offset:57376
    v_mfma_f32_16x16x32_bf16 v[88:91], v[152:155], a[92:95], v[88:91]
    s_waitcnt lgkmcnt(8)
    s_mul_i32 s75, s74, 172032
    s_add_u32 s75, s75, s80
    s_lshl_b32 s76, s74, 7
    s_add_u32 s74, s74, 1
    s_cmp_eq_u32 s74, 7
    s_cselect_b32 s74, 0, s74
    s_add_u32 m0, s82, 100368
    ds_read_b128 a[112:115], v24 offset:59424
    v_mfma_f32_16x16x32_bf16 v[92:95], v[152:155], a[96:99], v[92:95]
    s_waitcnt lgkmcnt(7)
    buffer_load_dwordx4 v13, s[8:11], s76 offen lds
    ds_read_b128 a[116:119], v24 offset:61472
    v_mfma_f32_16x16x32_bf16 v[96:99], v[156:159], a[80:83], v[96:99]
    ds_read_b64_tr_b16 v[164:165], v17 offset:63520
    v_mfma_f32_16x16x32_bf16 v[100:103], v[156:159], a[84:87], v[100:103]
    s_add_u32 m0, s81, 83984
    ds_read_b64_tr_b16 v[166:167], v17 offset:64032
    v_mfma_f32_16x16x32_bf16 v[104:107], v[156:159], a[88:91], v[104:107]
    buffer_load_dwordx4 v11, s[12:15], s75 offen offset:0 lds
    v_mfma_f32_16x16x32_bf16 v[108:111], v[156:159], a[92:95], v[108:111]
    v_subrev_u32 v19, 26640, v19
    v_mfma_f32_16x16x32_bf16 v[112:115], v[156:159], a[96:99], v[112:115]
    s_waitcnt lgkmcnt(9)
    v_subrev_u32 v24, 26640, v24
    v_subrev_u32 v25, 26640, v25
    v_mfma_f32_16x16x32_bf16 v[116:119], v[172:175], v[172:175], v[116:119]
    buffer_load_dwordx4 v12, s[12:15], s75 offen offset:1024 lds
    v_mfma_f32_16x16x32_bf16 v[124:127], v[20:23], v[172:175], v[124:127]
    s_waitcnt lgkmcnt(8)
    v_subrev_u32 v26, 26640, v26
    v_mfma_f32_16x16x32_bf16 v[120:123], a[100:103], a[100:103], v[120:123]
    s_waitcnt lgkmcnt(6)
    s_add_u32 m0, s77, 108560
    v_subrev_u32 v27, 26640, v27
    v_subrev_u32 v28, 26640, v28
    v_mfma_f32_16x16x32_bf16 v[76:79], v[160:163], a[100:103], v[76:79]
    s_waitcnt lgkmcnt(5)
    buffer_load_dwordx4 v15, s[8:11], s76 offen lds
    v_mfma_f32_16x16x32_bf16 v[80:83], v[160:163], a[104:107], v[80:83]
    s_waitcnt lgkmcnt(4)
    v_subrev_u32 v17, 26640, v17
    v_mfma_f32_16x16x32_bf16 v[84:87], v[160:163], a[108:111], v[84:87]
    s_waitcnt lgkmcnt(3)
    v_mfma_f32_16x16x32_bf16 v[88:91], v[160:163], a[112:115], v[88:91]
    s_cmp_eq_u32 s97, 2
    s_cbranch_scc1 Lres2
Lresb2:
    s_waitcnt vmcnt(11)
    s_waitcnt lgkmcnt(0)
    s_barrier
    ds_read_b128 v[168:171], v27 offset:0
    ds_read_b128 a[120:123], v25 offset:0
    v_mfma_f32_16x16x32_bf16 v[92:95], v[160:163], a[116:119], v[92:95]
    s_add_u32 m0, s81, 85136
    ds_read_b64_tr_b16 v[152:153], v17 offset:0
    ds_read_b64_tr_b16 v[154:155], v17 offset:512
    v_mfma_f32_16x16x32_bf16 v[96:99], v[164:167], a[100:103], v[96:99]
    buffer_load_dwordx4 v11, s[12:15], s75 offen offset:896 lds
    ds_read_b128 a[124:127], v19 offset:2048
    v_mfma_f32_16x16x32_bf16 v[100:103], v[164:167], a[104:107], v[100:103]
    ds_read_b128 a[128:131], v19 offset:4096
    v_mfma_f32_16x16x32_bf16 v[104:107], v[164:167], a[108:111], v[104:107]
    ds_read_b128 a[132:135], v19 offset:6144
    ds_read_b128 a[136:139], v19 offset:8192
    v_mfma_f32_16x16x32_bf16 v[108:111], v[164:167], a[112:115], v[108:111]
    buffer_load_dwordx4 v12, s[12:15], s75 offen offset:1920 lds
    ds_read_b64_tr_b16 v[156:157], v17 offset:2048
    v_mfma_f32_16x16x32_bf16 v[112:115], v[164:167], a[116:119], v[112:115]
    s_waitcnt lgkmcnt(8)
    ds_read_b64_tr_b16 v[158:159], v17 offset:2560
    v_mfma_f32_16x16x32_bf16 v[116:119], v[168:171], v[168:171], v[116:119]
    s_add_u32 m0, s82, 104464
    ds_read_b128 v[172:175], v28 offset:0
    v_mfma_f32_16x16x32_bf16 v[124:127], v[20:23], v[168:171], v[124:127]
    s_waitcnt lgkmcnt(9)
    buffer_load_dwordx4 v14, s[8:11], s76 offen lds
    ds_read_b128 a[140:143], v26 offset:0
    v_mfma_f32_16x16x32_bf16 v[120:123], a[120:123], a[120:123], v[120:123]
    s_waitcnt lgkmcnt(8)
    ds_read_b64_tr_b16 v[160:161], v17 offset:8192
    v_mfma_f32_16x16x32_bf16 v[76:79], v[152:155], a[120:123], v[76:79]
    s_waitcnt lgkmcnt(8)
    s_lshl_b32 s76, s74, 7
    s_add_u32 m0, s82, 137264
    ds_read_b64_tr_b16 v[162:163], v17 offset:8704
    v_mfma_f32_16x16x32_bf16 v[80:83], v[152:155], a[124:127], v[80:83]
    s_waitcnt lgkmcnt(8)
    buffer_load_dwordx4 v13, s[8:11], s76 offen lds
    ds_read_b128 a[144:147], v24 offset:2048
    v_mfma_f32_16x16x32_bf16 v[84:87], v[152:155], a[128:131], v[84:87]
    s_waitcnt lgkmcnt(8)
    ds_read_b128 a[148:151], v24 offset:4096
    v_mfma_f32_16x16x32_bf16 v[88:91], v[152:155], a[132:135], v[88:91]
    s_waitcnt lgkmcnt(8)
    s_add_u32 m0, s77, 145456
    ds_read_b128 a[152:155], v24 offset:6144
    v_mfma_f32_16x16x32_bf16 v[92:95], v[152:155], a[136:139], v[92:95]
    s_waitcnt lgkmcnt(7)
    buffer_load_dwordx4 v15, s[8:11], s76 offen lds
    ds_read_b128 a[156:159], v24 offset:8192
    v_mfma_f32_16x16x32_bf16 v[96:99], v[156:159], a[120:123], v[96:99]
    ds_read_b64_tr_b16 v[164:165], v17 offset:10240
    v_mfma_f32_16x16x32_bf16 v[100:103], v[156:159], a[124:127], v[100:103]
    s_add_u32 m0, s82, 141360
    ds_read_b64_tr_b16 v[166:167], v17 offset:10752
    v_mfma_f32_16x16x32_bf16 v[104:107], v[156:159], a[128:131], v[104:107]
    buffer_load_dwordx4 v14, s[8:11], s76 offen lds
    v_mfma_f32_16x16x32_bf16 v[108:111], v[156:159], a[132:135], v[108:111]
    v_add_u32 v19, 26640, v19
    v_mfma_f32_16x16x32_bf16 v[112:115], v[156:159], a[136:139], v[112:115]
    s_waitcnt lgkmcnt(9)
    s_mul_i32 s75, s74, 172032
    s_add_u32 s75, s75, s80
    s_lshl_b32 s76, s74, 7
    s_add_u32 s74, s74, 1
    s_cmp_eq_u32 s74, 7
    s_cselect_b32 s74, 0, s74
    s_add_u32 m0, s81, 110624
    v_add_u32 v24, 26640, v24
    v_add_u32 v25, 26640, v25
    v_mfma_f32_16x16x32_bf16 v[116:119], v[172:175], v[172:175], v[116:119]
    buffer_load_dwordx4 v11, s[12:15], s75 offen offset:0 lds
    v_mfma_f32_16x16x32_bf16 v[124:127], v[20:23], v[172:175], v[124:127]
    s_waitcnt lgkmcnt(8)
    v_add_u32 v26, 26640, v26
    v_mfma_f32_16x16x32_bf16 v[120:123], a[140:143], a[140:143], v[120:123]
    s_waitcnt lgkmcnt(6)
    v_add_u32 v27, 26640, v27
    v_add_u32 v28, 26640, v28
    v_mfma_f32_16x16x32_bf16 v[76:79], v[160:163], a[140:143], v[76:79]
    s_waitcnt lgkmcnt(5)
    buffer_load_dwordx4 v12, s[12:15], s75 offen offset:1024 lds
    v_mfma_f32_16x16x32_bf16 v[80:83], v[160:163], a[144:147], v[80:83]
    s_waitcnt lgkmcnt(4)
    v_add_u32 v17, 26640, v17
    v_mfma_f32_16x16x32_bf16 v[84:87], v[160:163], a[148:151], v[84:87]
    s_waitcnt lgkmcnt(3)
    v_mfma_f32_16x16x32_bf16 v[88:91], v[160:163], a[152:155], v[88:91]
    s_cmp_eq_u32 s97, 3
    s_cbranch_scc1 Lres3
Lresb3:
    s_waitcnt vmcnt(12)
    s_waitcnt lgkmcnt(0)
    s_barrier
    ds_read_b128 v[168:171], v27 offset:0
    ds_read_b128 a[160:163], v25 offset:0
    v_mfma_f32_16x16x32_bf16 v[92:95], v[160:163], a[156:159], v[92:95]
    s_add_u32 m0, s81, 111776
    ds_read_b64_tr_b16 v[152:153], v17 offset:0
    ds_read_b64_tr_b16 v[154:155], v17 offset:512
    v_mfma_f32_16x16x32_bf16 v[96:99], v[164:167], a[140:143], v[96:99]
    buffer_load_dwordx4 v11, s[12:15], s75 offen offset:896 lds
    ds_read_b128 a[164:167], v19 offset:2048
    v_mfma_f32_16x16x32_bf16 v[100:103], v[164:167], a[144:147], v[100:103]
    ds_read_b128 a[168:171], v19 offset:4096
    v_mfma_f32_16x16x32_bf16 v[104:107], v[164:167], a[148:151], v[104:107]
    ds_read_b128 a[172:175], v19 offset:6144
    ds_read_b128 a[176:179], v19 offset:8192
    v_mfma_f32_16x16x32_bf16 v[108:111], v[164:167], a[152:155], v[108:111]
    buffer_load_dwordx4 v12, s[12:15], s75 offen offset:1920 lds
    ds_read_b64_tr_b16 v[156:157], v17 offset:2048
    v_mfma_f32_16x16x32_bf16 v[112:115], v[164:167], a[156:159], v[112:115]
    s_waitcnt lgkmcnt(8)
    ds_read_b64_tr_b16 v[158:159], v17 offset:2560
    v_mfma_f32_16x16x32_bf16 v[116:119], v[168:171], v[168:171], v[116:119]
    s_mul_i32 s75, s74, 172032
    s_add_u32 s75, s75, s1
    s_add_u32 m0, s83, 0
    ds_read_b128 v[172:175], v28 offset:0
    v_mfma_f32_16x16x32_bf16 v[124:127], v[20:23], v[168:171], v[124:127]
    s_waitcnt lgkmcnt(9)
    buffer_load_dwordx4 v11, s[12:15], s75 offen lds
    ds_read_b128 a[180:183], v26 offset:0
    v_mfma_f32_16x16x32_bf16 v[120:123], a[160:163], a[160:163], v[120:123]
    s_waitcnt lgkmcnt(8)
    ds_read_b64_tr_b16 v[160:161], v17 offset:8192
    v_mfma_f32_16x16x32_bf16 v[76:79], v[152:155], a[160:163], v[76:79]
    s_waitcnt lgkmcnt(8)
    s_add_u32 s74, s74, 1
    s_cmp_eq_u32 s74, 7
    s_cselect_b32 s74, 0, s74
    ds_read_b64_tr_b16 v[162:163], v17 offset:8704
    v_mfma_f32_16x16x32_bf16 v[80:83], v[152:155], a[164:167], v[80:83]
    s_waitcnt lgkmcnt(8)
    buffer_load_dwordx4 v12, s[12:15], s75 offen offset:1024 lds
    ds_read_b128 a[184:187], v24 offset:2048
    v_mfma_f32_16x16x32_bf16 v[84:87], v[152:155], a[168:171], v[84:87]
    s_waitcnt lgkmcnt(8)
    ds_read_b128 a[188:191], v24 offset:4096
    v_mfma_f32_16x16x32_bf16 v[88:91], v[152:155], a[172:175], v[88:91]
    s_waitcnt lgkmcnt(8)
    s_mul_i32 s75, s74, 172032
    s_add_u32 s75, s75, s1
    s_add_u32 m0, s83, 8192
    ds_read_b128 a[192:195], v24 offset:6144
    v_mfma_f32_16x16x32_bf16 v[92:95], v[152:155], a[176:179], v[92:95]
    s_waitcnt lgkmcnt(7)
    buffer_load_dwordx4 v11, s[12:15], s75 offen lds
    ds_read_b128 a[196:199], v24 offset:8192
    v_mfma_f32_16x16x32_bf16 v[96:99], v[156:159], a[160:163], v[96:99]
    ds_read_b64_tr_b16 v[164:165], v17 offset:10240
    v_mfma_f32_16x16x32_bf16 v[100:103], v[156:159], a[164:167], v[100:103]
    s_add_u32 s74, s74, 1
    s_cmp_eq_u32 s74, 7
    s_cselect_b32 s74, 0, s74
    ds_read_b64_tr_b16 v[166:167], v17 offset:10752
    v_mfma_f32_16x16x32_bf16 v[104:107], v[156:159], a[168:171], v[104:107]
    buffer_load_dwordx4 v12, s[12:15], s75 offen offset:1024 lds
    v_mfma_f32_16x16x32_bf16 v[108:111], v[156:159], a[172:175], v[108:111]
    v_mfma_f32_16x16x32_bf16 v[112:115], v[156:159], a[176:179], v[112:115]
    s_waitcnt lgkmcnt(9)
    s_mul_i32 s75, s74, 172032
    s_add_u32 s75, s75, s1
    s_add_u32 m0, s83, 16384
    v_mfma_f32_16x16x32_bf16 v[116:119], v[172:175], v[172:175], v[116:119]
    buffer_load_dwordx4 v11, s[12:15], s75 offen lds
    v_mfma_f32_16x16x32_bf16 v[124:127], v[20:23], v[172:175], v[124:127]
    s_waitcnt lgkmcnt(8)
    v_mfma_f32_16x16x32_bf16 v[120:123], a[180:183], a[180:183], v[120:123]
    s_waitcnt lgkmcnt(6)
    s_add_u32 s74, s74, 1
    s_cmp_eq_u32 s74, 7
    s_cselect_b32 s74, 0, s74
    v_mfma_f32_16x16x32_bf16 v[76:79], v[160:163], a[180:183], v[76:79]
    s_waitcnt lgkmcnt(5)
    buffer_load_dwordx4 v12, s[12:15], s75 offen offset:1024 lds
    v_mfma_f32_16x16x32_bf16 v[80:83], v[160:163], a[184:187], v[80:83]
    s_waitcnt lgkmcnt(4)
    v_mfma_f32_16x16x32_bf16 v[84:87], v[160:163], a[188:191], v[84:87]
    s_waitcnt lgkmcnt(3)
    v_mfma_f32_16x16x32_bf16 v[88:91], v[160:163], a[192:195], v[88:91]
    s_cmp_eq_u32 s97, 4
    s_cbranch_scc1 Lres4
Lresb4:
    s_waitcnt vmcnt(10)
    s_waitcnt lgkmcnt(0)
    s_barrier
    ds_read_b128 v[168:171], v27 offset:26640
    ds_read_b128 a[200:203], v25 offset:26640
    s_mul_i32 s75, s74, 172032
    s_add_u32 s75, s75, s1
    s_add_u32 m0, s83, 24576
    v_mfma_f32_16x16x32_bf16 v[92:95], v[160:163], a[196:199], v[92:95]
    buffer_load_dwordx4 v11, s[12:15], s75 offen lds
    ds_read_b64_tr_b16 v[152:153], v17 offset:26640
    ds_read_b64_tr_b16 v[154:155], v17 offset:27152
    v_mfma_f32_16x16x32_bf16 v[96:99], v[164:167], a[180:183], v[96:99]
    ds_read_b128 a[204:207], v19 offset:28688
    v_mfma_f32_16x16x32_bf16 v[100:103], v[164:167], a[184:187], v[100:103]
    s_add_u32 s74, s74, 1
    s_cmp_eq_u32 s74, 7
    s_cselect_b32 s74, 0, s74
    ds_read_b128 a[208:211], v19 offset:30736
    v_mfma_f32_16x16x32_bf16 v[104:107], v[164:167], a[188:191], v[104:107]
    buffer_load_dwordx4 v12, s[12:15], s75 offen offset:1024 lds
    ds_read_b128 a[212:215], v19 offset:32784
    ds_read_b128 a[216:219], v19 offset:34832
    v_mfma_f32_16x16x32_bf16 v[108:111], v[164:167], a[192:195], v[108:111]
    ds_read_b64_tr_b16 v[156:157], v17 offset:28688
    v_mfma_f32_16x16x32_bf16 v[112:115], v[164:167], a[196:199], v[112:115]
    s_waitcnt lgkmcnt(8)
    s_mul_i32 s75, s74, 172032
    s_add_u32 s75, s75, s1
    s_add_u32 m0, s83, 32768
    ds_read_b64_tr_b16 v[158:159], v17 offset:29200
    v_mfma_f32_16x16x32_bf16 v[116:119], v[168:171], v[168:171], v[116:119]
    buffer_load_dwordx4 v11, s[12:15], s75 offen lds
    ds_read_b128 v[172:175], v28 offset:26640
    ds_read_b128 a[220:223], v26 offset:26640
    v_mfma_f32_16x16x32_bf16 v[124:127], v[20:23], v[168:171], v[124:127]
    s_waitcnt lgkmcnt(10)
    ds_read_b64_tr_b16 v[160:161], v17 offset:34832
    ds_read_b64_tr_b16 v[162:163], v17 offset:35344
    v_mfma_f32_16x16x32_bf16 v[120:123], a[200:203], a[200:203], v[120:123]
    s_waitcnt lgkmcnt(10)
    s_add_u32 s74, s74, 1
    s_cmp_eq_u32 s74, 7
    s_cselect_b32 s74, 0, s74
    ds_read_b128 a[224:227], v24 offset:28688
    v_mfma_f32_16x16x32_bf16 v[76:79], v[152:155], a[200:203], v[76:79]
    s_waitcnt lgkmcnt(10)
    buffer_load_dwordx4 v12, s[12:15], s75 offen offset:1024 lds
    ds_read_b128 a[228:231], v24 offset:30736
    ds_read_b128 a[232:235], v24 offset:32784
    v_mfma_f32_16x16x32_bf16 v[80:83], v[152:155], a[204:207], v[80:83]
    s_waitcnt lgkmcnt(11)
    ds_read_b128 a[236:239], v24 offset:34832
    ds_read_b64_tr_b16 v[164:165], v17 offset:36880
    v_mfma_f32_16x16x32_bf16 v[84:87], v[152:155], a[208:211], v[84:87]
    s_waitcnt lgkmcnt(12)
    s_mul_i32 s75, s74, 172032
    s_add_u32 s75, s75, s1
    s_add_u32 m0, s83, 40960
    ds_read_b64_tr_b16 v[166:167], v17 offset:37392
    v_mfma_f32_16x16x32_bf16 v[88:91], v[152:155], a[212:215], v[88:91]
    s_waitcnt lgkmcnt(12)
    buffer_load_dwordx4 v11, s[12:15], s75 offen lds
    v_mfma_f32_16x16x32_bf16 v[92:95], v[152:155], a[216:219], v[92:95]
    s_waitcnt lgkmcnt(10)
    v_add_u32 v19, 63536, v19
    v_add_u32 v24, 63536, v24
    v_add_u32 v25, 63536, v25
    v_mfma_f32_16x16x32_bf16 v[96:99], v[156:159], a[200:203], v[96:99]
    s_add_u32 s74, s74, 1
    s_cmp_eq_u32 s74, 7
    s_cselect_b32 s74, 0, s74
    v_add_u32 v26, 63536, v26
    v_add_u32 v27, 63536, v27
    v_add_u32 v28, 63536, v28
    v_mfma_f32_16x16x32_bf16 v[100:103], v[156:159], a[204:207], v[100:103]
    buffer_load_dwordx4 v12, s[12:15], s75 offen offset:1024 lds
    v_mfma_f32_16x16x32_bf16 v[104:107], v[156:159], a[208:211], v[104:107]
    ds_read_b128 v[176:179], v27 offset:0
    ds_read_b128 a[240:243], v25 offset:0
    v_mfma_f32_16x16x32_bf16 v[108:111], v[156:159], a[212:215], v[108:111]
    s_mul_i32 s75, s74, 172032
    s_add_u32 s75, s75, s1
    s_add_u32 m0, s83, 49152
    ds_read_b128 v[180:183], v28 offset:0
    v_mfma_f32_16x16x32_bf16 v[112:115], v[156:159], a[216:219], v[112:115]
    s_waitcnt lgkmcnt(12)
    buffer_load_dwordx4 v11, s[12:15], s75 offen lds
    ds_read_b128 v[132:135], v26 offset:0
    v_mfma_f32_16x16x32_bf16 v[116:119], v[172:175], v[172:175], v[116:119]
    ds_read_b128 a[244:247], v19 offset:2048
    v_mfma_f32_16x16x32_bf16 v[124:127], v[20:23], v[172:175], v[124:127]
    s_waitcnt lgkmcnt(13)
    s_add_u32 s74, s74, 1
    s_cmp_eq_u32 s74, 7
    s_cselect_b32 s74, 0, s74
    ds_read_b128 a[248:251], v19 offset:4096
    v_mfma_f32_16x16x32_bf16 v[120:123], a[220:223], a[220:223], v[120:123]
    s_waitcnt lgkmcnt(12)
    buffer_load_dwordx4 v12, s[12:15], s75 offen offset:1024 lds
    ds_read_b128 a[252:255], v19 offset:6144
    ds_read_b128 v[128:131], v19 offset:8192
    v_mfma_f32_16x16x32_bf16 v[76:79], v[160:163], a[220:223], v[76:79]
    s_waitcnt lgkmcnt(13)
    ds_read_b128 v[136:139], v24 offset:2048
    v_mfma_f32_16x16x32_bf16 v[80:83], v[160:163], a[224:227], v[80:83]
    s_waitcnt lgkmcnt(8)
    s_add_u32 m0, s71, 24576
    s_add_u32 s3, s70, 172032
    s_cmp_ge_u32 s3, 401408
    s_cselect_b32 s76, 401408, 0
    s_sub_u32 s3, s3, s76
    ds_read_b128 v[140:143], v24 offset:4096
    v_mfma_f32_16x16x32_bf16 v[116:119], v[176:179], v[176:179], v[116:119]
    buffer_load_dwordx4 v64, s[16:19], s3 offen lds
    ds_read_b128 v[144:147], v24 offset:6144
    v_mfma_f32_16x16x32_bf16 v[124:127], v[20:23], v[176:179], v[124:127]
    s_waitcnt lgkmcnt(9)
    ds_read_b128 v[148:151], v24 offset:8192
    v_mfma_f32_16x16x32_bf16 v[120:123], a[240:243], a[240:243], v[120:123]
    s_waitcnt lgkmcnt(9)
    s_add_u32 m0, s71, 45056
    s_add_u32 s3, s70, 315392
    s_cmp_ge_u32 s3, 401408
    s_cselect_b32 s76, 401408, 0
    s_sub_u32 s3, s3, s76
    v_mfma_f32_16x16x32_bf16 v[116:119], v[180:183], v[180:183], v[116:119]
    buffer_load_dwordx4 v64, s[16:19], s3 offen lds
    v_mfma_f32_16x16x32_bf16 v[124:127], v[20:23], v[180:183], v[124:127]
    s_waitcnt lgkmcnt(8)
    v_mfma_f32_16x16x32_bf16 v[120:123], v[132:135], v[132:135], v[120:123]
    s_cmp_eq_u32 s97, 5
    s_cbranch_scc1 Lres5
Lresb5:
    v_mfma_f32_16x16x32_bf16 v[84:87], v[160:163], a[228:231], v[84:87]
    s_cmp_eq_u32 s66, 1
    s_cbranch_scc1 Lvar1
    s_cmp_eq_u32 s66, 2
    s_cbranch_scc1 Lvar2
    v_mfma_f32_16x16x32_bf16 v[88:91], v[160:163], a[232:235], v[88:91]
    s_cmp_eq_u32 s66, 3
    s_cbranch_scc1 Lvar3
    s_cmp_eq_u32 s66, 4
    s_cbranch_scc1 Lvar4
    v_mfma_f32_16x16x32_bf16 v[92:95], v[160:163], a[236:239], v[92:95]
    s_cmp_eq_u32 s66, 5
    s_cbranch_scc1 Lvar5
    s_cmp_eq_u32 s66, 6
    s_cbranch_scc1 Lvar6
Lvar0:
Lst0:
    s_cbranch_execz Lback
    s_waitcnt vmcnt(16)
    s_waitcnt lgkmcnt(0)
    s_barrier
    ds_read_b64_tr_b16 v[152:153], v17 offset:53280
Lst1:
Lv0_1:
    s_cbranch_execz Lback
    ds_read_b64_tr_b16 v[154:155], v17 offset:53792
    ds_read_b64_tr_b16 v[156:157], v17 offset:55328
    ds_read_b64_tr_b16 v[158:159], v17 offset:55840
    s_add_u32 m0, s71, 49152
    s_add_u32 s3, s70, 344064
    v_mfma_f32_16x16x32_bf16 v[96:99], v[164:167], a[220:223], v[96:99]
    s_nop 3
    buffer_load_dwordx4 v64, s[16:19], s3 offen lds
    ds_read_b64_tr_b16 v[160:161], v17 offset:61472
    ds_read_b64_tr_b16 v[162:163], v17 offset:61984
    v_mfma_f32_16x16x32_bf16 v[100:103], v[164:167], a[224:227], v[100:103]
    v_cndmask_b32 v15, v116, v117, s[84:85]
    v_cndmask_b32 v15, v15, v118, s[86:87]
    v_cndmask_b32 v15, v15, v119, s[88:89]
    v_mfma_f32_16x16x32_bf16 v[104:107], v[164:167], a[228:231], v[104:107]
    s_add_u32 m0, s71, 53248
    s_add_u32 s3, s70, 372736
    v_mul_f32 v14, 0xbb124925, v124
    v_mov_b32_dpp v40, v120 row_newbcast:0 row_mask:0xf bank_mask:0xf
    v_mov_b32_dpp v41, v121 row_newbcast:0 row_mask:0xf bank_mask:0xf
    v_mfma_f32_16x16x32_bf16 v[108:111], v[164:167], a[232:235], v[108:111]
    buffer_load_dwordx4 v64, s[16:19], s3 offen lds
    v_mfma_f32_16x16x32_bf16 v[112:115], v[164:167], a[236:239], v[112:115]
    s_waitcnt lgkmcnt(4)
    v_mov_b32_dpp v42, v122 row_newbcast:0 row_mask:0xf bank_mask:0xf
    v_mov_b32_dpp v43, v123 row_newbcast:0 row_mask:0xf bank_mask:0xf
    v_cndmask_b32 v25, v120, v121, s[84:85]
    v_cndmask_b32 v25, v25, v122, s[86:87]
    v_mfma_f32_16x16x32_bf16 v[76:79], v[152:155], a[240:243], v[76:79]
    ds_read_b64_tr_b16 v[164:165], v17 offset:63520
    ds_read_b64_tr_b16 v[166:167], v17 offset:64032
    v_cndmask_b32 v25, v25, v123, s[88:89]
    v_mfma_f32_16x16x32_bf16 v[80:83], v[152:155], a[244:247], v[80:83]
    s_add_u32 m0, s71, 28672
    s_add_u32 s3, s70, 200704
    v_cndmask_b32 v24, v40, v41, s[84:85]
    v_cndmask_b32 v24, v24, v42, s[86:87]
    v_cndmask_b32 v24, v24, v43, s[88:89]
    v_mfma_f32_16x16x32_bf16 v[84:87], v[152:155], a[248:251], v[84:87]
    buffer_load_dwordx4 v64, s[16:19], s3 offen lds
    v_mfma_f32_16x16x32_bf16 v[88:91], v[152:155], a[252:255], v[88:91]
    v_mul_f32 v24, 0xbb124925, v24
    v_mul_f32 v15, 0x3b124925, v15
    v_fma_f32 v15, -v14, v14, v15
    v_max_f32 v15, 0, v15
    v_mfma_f32_16x16x32_bf16 v[92:95], v[152:155], v[128:131], v[92:95]
    s_waitcnt lgkmcnt(2)
    v_add_f32 v15, 0x3727c5ac, v15
    v_rsq_f32 v15, v15
    v_mfma_f32_16x16x32_bf16 v[76:79], v[160:163], v[132:135], v[76:79]
    s_add_u32 m0, s71, 32768
    s_add_u32 s3, s70, 229376
    v_mul_f32 v25, 0x3b124925, v25
    v_fma_f32 v25, -v24, v24, v25
    v_max_f32 v25, 0, v25
    v_mfma_f32_16x16x32_bf16 v[80:83], v[160:163], v[136:139], v[80:83]
    buffer_load_dwordx4 v64, s[16:19], s3 offen lds
    v_mfma_f32_16x16x32_bf16 v[84:87], v[160:163], v[140:143], v[84:87]
    v_add_f32 v25, 0x3727c5ac, v25
    v_rsq_f32 v25, v25
    v_mfma_f32_16x16x32_bf16 v[88:91], v[160:163], v[144:147], v[88:91]
    ds_write2_b32 v62, v14, v15 offset0:0 offset1:80
    v_mfma_f32_16x16x32_bf16 v[92:95], v[160:163], v[148:151], v[92:95]
    s_add_u32 m0, s71, 36864
    s_add_u32 s3, s70, 258048
    ds_write2_b32 v63, v24, v25 offset0:0 offset1:80
    v_mfma_f32_16x16x32_bf16 v[96:99], v[156:159], a[240:243], v[96:99]
    buffer_load_dwordx4 v64, s[16:19], s3 offen lds
    v_mfma_f32_16x16x32_bf16 v[100:103], v[156:159], a[244:247], v[100:103]
    v_mfma_f32_16x16x32_bf16 v[104:107], v[156:159], a[248:251], v[104:107]
    s_waitcnt vmcnt(13)
    s_waitcnt lgkmcnt(0)
    s_barrier
    ds_read2_b32 v[26:27], v29 offset0:16 offset1:32
    ds_read2_b32 v[176:177], v29 offset0:48 offset1:64
    v_mfma_f32_16x16x32_bf16 v[108:111], v[156:159], a[252:255], v[108:111]
    s_add_u32 m0, s71, 40960
    s_add_u32 s3, s70, 286720
    ds_read_b32 v5, v29
    ds_read_b32 v9, v30 offset:320
    v_mfma_f32_16x16x32_bf16 v[112:115], v[156:159], v[128:131], v[112:115]
    buffer_load_dwordx4 v64, s[16:19], s3 offen lds
    ds_read_b32 v60, v60
    ds_read_b32 v61, v61
    v_mfma_f32_16x16x32_bf16 v[96:99], v[164:167], v[132:135], v[96:99]
    ds_read_b64_tr_b16 v[200:201], v18 offset:0
    ds_read_b64_tr_b16 v[202:203], v18 offset:512
    v_mfma_f32_16x16x32_bf16 v[100:103], v[164:167], v[136:139], v[100:103]
    ds_read_b64_tr_b16 v[204:205], v18 offset:4096
    ds_read_b64_tr_b16 v[206:207], v18 offset:4608
    s_waitcnt lgkmcnt(9)
    v_fmac_f32_dpp v80, v76, v26 row_newbcast:0 row_mask:0xf bank_mask:0xf
    v_mfma_f32_16x16x32_bf16 v[104:107], v[164:167], v[140:143], v[104:107]
    s_add_u32 m0, s71, 0
    s_add_u32 s3, s70, 0
    ds_read_b64_tr_b16 v[208:209], v18 offset:8192
    ds_read_b64_tr_b16 v[210:211], v18 offset:8704
    v_fmac_f32_dpp v81, v77, v26 row_newbcast:0 row_mask:0xf bank_mask:0xf
    v_fmac_f32_dpp v82, v78, v26 row_newbcast:0 row_mask:0xf bank_mask:0xf
    v_mfma_f32_16x16x32_bf16 v[108:111], v[164:167], v[144:147], v[108:111]
    buffer_load_dwordx4 v64, s[16:19], s3 offen lds
    v_mfma_f32_16x16x32_bf16 v[112:115], v[164:167], v[148:151], v[112:115]
    s_waitcnt lgkmcnt(4)
    v_fmac_f32_dpp v83, v79, v26 row_newbcast:0 row_mask:0xf bank_mask:0xf
    v_cvt_pk_bf16_f32 v80, v80, v81
    v_cvt_pk_bf16_f32 v81, v82, v83
    v_mfma_f32_16x16x32_bf16 v[180:183], a[0:3], v[200:203], 0
    s_add_u32 m0, s71, 4096
    s_add_u32 s3, s70, 28672
    ds_write_b64 v56, v[80:81] offset:0
    ds_read_b64_tr_b16 v[212:213], v18 offset:12288
    ds_read_b64_tr_b16 v[214:215], v18 offset:12800
    v_fmac_f32_dpp v84, v76, v27 row_newbcast:0 row_mask:0xf bank_mask:0xf
    v_mfma_f32_16x16x32_bf16 v[184:187], a[4:7], v[200:203], 0
    buffer_load_dwordx4 v64, s[16:19], s3 offen lds
    v_fmac_f32_dpp v85, v77, v27 row_newbcast:0 row_mask:0xf bank_mask:0xf
    v_mfma_f32_16x16x32_bf16 v[188:191], a[8:11], v[200:203], 0
    v_fmac_f32_dpp v86, v78, v27 row_newbcast:0 row_mask:0xf bank_mask:0xf
    v_fmac_f32_dpp v87, v79, v27 row_newbcast:0 row_mask:0xf bank_mask:0xf
    v_cvt_pk_bf16_f32 v84, v84, v85
    v_mfma_f32_16x16x32_bf16 v[192:195], a[12:15], v[200:203], 0
    v_cvt_pk_bf16_f32 v85, v86, v87
    v_fmac_f32_dpp v88, v76, v176 row_newbcast:0 row_mask:0xf bank_mask:0xf
    v_fmac_f32_dpp v89, v77, v176 row_newbcast:0 row_mask:0xf bank_mask:0xf
    v_mfma_f32_16x16x32_bf16 v[196:199], a[16:19], v[200:203], 0
    s_waitcnt lgkmcnt(5)
    s_add_u32 m0, s71, 8192
    s_add_u32 s3, s70, 57344
    ds_write_b64 v56, v[84:85] offset:2176
    v_fmac_f32_dpp v90, v78, v176 row_newbcast:0 row_mask:0xf bank_mask:0xf
    v_fmac_f32_dpp v91, v79, v176 row_newbcast:0 row_mask:0xf bank_mask:0xf
    v_cvt_pk_bf16_f32 v88, v88, v89
    v_mfma_f32_16x16x32_bf16 v[180:183], a[20:23], v[204:207], v[180:183]
    buffer_load_dwordx4 v64, s[16:19], s3 offen lds
    ds_read_b64_tr_b16 v[200:201], v18 offset:16384
    ds_read_b64_tr_b16 v[202:203], v18 offset:16896
    v_mfma_f32_16x16x32_bf16 v[184:187], a[24:27], v[204:207], v[184:187]
    v_cvt_pk_bf16_f32 v89, v90, v91
    v_fmac_f32_dpp v92, v76, v177 row_newbcast:0 row_mask:0xf bank_mask:0xf
    v_mfma_f32_16x16x32_bf16 v[188:191], a[28:31], v[204:207], v[188:191]
    ds_write_b64 v56, v[88:89] offset:4352
    v_fmac_f32_dpp v93, v77, v177 row_newbcast:0 row_mask:0xf bank_mask:0xf
    v_fmac_f32_dpp v94, v78, v177 row_newbcast:0 row_mask:0xf bank_mask:0xf
    v_fmac_f32_dpp v95, v79, v177 row_newbcast:0 row_mask:0xf bank_mask:0xf
    v_cvt_pk_bf16_f32 v92, v92, v93
    v_mfma_f32_16x16x32_bf16 v[192:195], a[32:35], v[204:207], v[192:195]
    s_add_u32 m0, s71, 12288
    s_add_u32 s3, s70, 86016
    v_cvt_pk_bf16_f32 v93, v94, v95
    v_fmac_f32_dpp v100, v96, v26 row_newbcast:0 row_mask:0xf bank_mask:0xf
    v_mfma_f32_16x16x32_bf16 v[196:199], a[36:39], v[204:207], v[196:199]
    s_waitcnt lgkmcnt(7)
    buffer_load_dwordx4 v64, s[16:19], s3 offen lds
    ds_write_b64 v56, v[92:93] offset:6528
    v_fmac_f32_dpp v101, v97, v26 row_newbcast:0 row_mask:0xf bank_mask:0xf
    v_mfma_f32_16x16x32_bf16 v[180:183], a[40:43], v[208:211], v[180:183]
    ds_read_b64_tr_b16 v[204:205], v18 offset:20480
    ds_read_b64_tr_b16 v[206:207], v18 offset:20992
    v_fmac_f32_dpp v102, v98, v26 row_newbcast:0 row_mask:0xf bank_mask:0xf
    v_mfma_f32_16x16x32_bf16 v[184:187], a[44:47], v[208:211], v[184:187]
    v_fmac_f32_dpp v103, v99, v26 row_newbcast:0 row_mask:0xf bank_mask:0xf
    v_cvt_pk_bf16_f32 v100, v100, v101
    v_cvt_pk_bf16_f32 v101, v102, v103
    v_mfma_f32_16x16x32_bf16 v[188:191], a[48:51], v[208:211], v[188:191]
    s_add_u32 m0, s71, 16384
    s_add_u32 s3, s70, 114688
    ds_write_b64 v56, v[100:101] offset:10880
    v_fmac_f32_dpp v104, v96, v27 row_newbcast:0 row_mask:0xf bank_mask:0xf
    v_fmac_f32_dpp v105, v97, v27 row_newbcast:0 row_mask:0xf bank_mask:0xf
    v_fmac_f32_dpp v106, v98, v27 row_newbcast:0 row_mask:0xf bank_mask:0xf
    v_mfma_f32_16x16x32_bf16 v[192:195], a[52:55], v[208:211], v[192:195]
    buffer_load_dwordx4 v64, s[16:19], s3 offen lds
    v_fmac_f32_dpp v107, v99, v27 row_newbcast:0 row_mask:0xf bank_mask:0xf
    v_mfma_f32_16x16x32_bf16 v[196:199], a[56:59], v[208:211], v[196:199]
    s_waitcnt lgkmcnt(8)
    v_cvt_pk_bf16_f32 v104, v104, v105
    v_cvt_pk_bf16_f32 v105, v106, v107
    v_mfma_f32_16x16x32_bf16 v[180:183], a[60:63], v[212:215], v[180:183]
    ds_write_b64 v56, v[104:105] offset:13056
    ds_read_b64_tr_b16 v[208:209], v18 offset:24576
    ds_read_b64_tr_b16 v[210:211], v18 offset:25088
    v_fmac_f32_dpp v108, v96, v176 row_newbcast:0 row_mask:0xf bank_mask:0xf
    v_fmac_f32_dpp v109, v97, v176 row_newbcast:0 row_mask:0xf bank_mask:0xf
    v_mfma_f32_16x16x32_bf16 v[184:187], a[64:67], v[212:215], v[184:187]
    s_add_u32 m0, s71, 20480
    s_add_u32 s3, s70, 143360
    v_fmac_f32_dpp v110, v98, v176 row_newbcast:0 row_mask:0xf bank_mask:0xf
    v_fmac_f32_dpp v111, v99, v176 row_newbcast:0 row_mask:0xf bank_mask:0xf
    v_cvt_pk_bf16_f32 v108, v108, v109
    v_mfma_f32_16x16x32_bf16 v[188:191], a[68:71], v[212:215], v[188:191]
    buffer_load_dwordx4 v64, s[16:19], s3 offen lds
    v_cvt_pk_bf16_f32 v109, v110, v111
    v_mfma_f32_16x16x32_bf16 v[192:195], a[72:75], v[212:215], v[192:195]
    ds_write_b64 v56, v[108:109] offset:15232
    v_fmac_f32_dpp v112, v96, v177 row_newbcast:0 row_mask:0xf bank_mask:0xf
    v_fmac_f32_dpp v113, v97, v177 row_newbcast:0 row_mask:0xf bank_mask:0xf
    v_mfma_f32_16x16x32_bf16 v[196:199], a[76:79], v[212:215], v[196:199]
    s_waitcnt lgkmcnt(9)
    v_fmac_f32_dpp v114, v98, v177 row_newbcast:0 row_mask:0xf bank_mask:0xf
    v_fmac_f32_dpp v115, v99, v177 row_newbcast:0 row_mask:0xf bank_mask:0xf
    v_cvt_pk_bf16_f32 v112, v112, v113
    v_cvt_pk_bf16_f32 v113, v114, v115
    v_mfma_f32_16x16x32_bf16 v[180:183], a[80:83], v[200:203], v[180:183]
    ds_read_b64_tr_b16 v[212:213], v18 offset:28672
    ds_read_b64_tr_b16 v[214:215], v18 offset:29184
    ds_write_b64 v56, v[112:113] offset:17408
    v_mfma_f32_16x16x32_bf16 v[184:187], a[84:87], v[200:203], v[184:187]
    v_fmac_f32_dpp v96, v96, v5 row_newbcast:0 row_mask:0xf bank_mask:0xf
    v_fmac_f32_dpp v97, v97, v5 row_newbcast:0 row_mask:0xf bank_mask:0xf
    v_fmac_f32_dpp v98, v98, v5 row_newbcast:0 row_mask:0xf bank_mask:0xf
    v_fmac_f32_dpp v99, v99, v5 row_newbcast:0 row_mask:0xf bank_mask:0xf
    v_mfma_f32_16x16x32_bf16 v[188:191], a[88:91], v[200:203], v[188:191]
    v_cvt_pk_bf16_f32 v96, v96, v97
    v_cvt_pk_bf16_f32 v97, v98, v99
    v_mfma_f32_16x16x32_bf16 v[192:195], a[92:95], v[200:203], v[192:195]
    ds_write_b64 v56, v[96:97] offset:8704
    v_mul_f32 v9, 0x3e8b97f6, v9
    v_mul_f32 v8, v9, v60
    v_mul_f32 v9, v9, v61
    v_mfma_f32_16x16x32_bf16 v[196:199], a[96:99], v[200:203], v[196:199]
    s_waitcnt vmcnt(14)
    s_waitcnt lgkmcnt(0)
    s_barrier
    ds_read_b64 v[118:119], v57 offset:96
    ds_read_b64 v[122:123], v57 offset:8800
    ds_read_b64 v[126:127], v57 offset:10976
    v_mfma_f32_16x16x32_bf16 v[180:183], a[100:103], v[204:207], v[180:183]
    ds_read_b64_tr_b16 v[200:201], v18 offset:32768
    ds_read_b64_tr_b16 v[202:203], v18 offset:33280
    v_mov_b32 v116, 0
    v_mov_b32 v117, 0
    v_mfma_f32_16x16x32_bf16 v[184:187], a[104:107], v[204:207], v[184:187]
    s_add_u32 m0, s73, 0
    s_add_u32 s3, s72, 0
    v_mov_b32 v120, 0
    v_mov_b32 v121, 0
    v_mov_b32 v124, 0
    v_mov_b32 v125, 0
    v_mov_b32 v161, s68
    v_mfma_f32_16x16x32_bf16 v[188:191], a[108:111], v[204:207], v[188:191]
    buffer_load_dwordx4 v67, s[20:23], s3 offen offset:0 lds
    v_mov_b32 v163, s69
    v_mfma_f32_16x16x32_bf16 v[192:195], a[112:115], v[204:207], v[192:195]
    ds_read_b64 v[24:25], v57 offset:0
    ds_read_b64 v[26:27], v57 offset:32
    ds_read_b64 v[40:41], v57 offset:8704
    s_waitcnt lgkmcnt(7)
    v_cndmask_b32 v118, v4, v118, s[98:99]
    v_cndmask_b32 v119, v4, v119, s[98:99]
    v_mfma_f32_16x16x32_bf16 v[196:199], a[116:119], v[204:207], v[196:199]
    s_waitcnt lgkmcnt(6)
    ds_read_b64 v[42:43], v57 offset:8736
    ds_read_b64 v[76:77], v57 offset:10880
    v_mfma_f32_16x16x32_bf16 v[152:155], v[120:123], v[116:119], v[44:47]
    s_waitcnt lgkmcnt(7)
    ds_read_b64 v[78:79], v57 offset:10912
    ds_read_b64 v[92:93], v57 offset:56
    ds_read_b64 v[94:95], v57 offset:88
    v_mfma_f32_16x16x32_bf16 v[156:159], v[124:127], v[116:119], v[48:51]
    ds_read_b64 v[96:97], v57 offset:8760
    ds_read_b64 v[98:99], v57 offset:8792
    v_mfma_f32_16x16x32_bf16 v[180:183], a[120:123], v[208:211], v[180:183]
    ds_read_b64 v[100:101], v57 offset:10936
    ds_read_b64 v[102:103], v57 offset:10968
    ds_read_b64_tr_b16 v[204:205], v18 offset:36864
    ds_read_b64_tr_b16 v[206:207], v18 offset:37376
    v_mfma_f32_16x16x32_bf16 v[184:187], a[124:127], v[208:211], v[184:187]
    buffer_load_dwordx4 v68, s[20:23], s3 offen offset:1024 lds
    v_mfma_f32_16x16x32_bf16 v[188:191], a[128:131], v[208:211], v[188:191]
    v_max3_f32 v160, v152, v153, v156
    v_max3_f32 v162, v154, v155, v158
    v_mfma_f32_16x16x32_bf16 v[192:195], a[132:135], v[208:211], v[192:195]
    s_waitcnt lgkmcnt(12)
    v_cndmask_b32 v26, v26, v4, s[90:91]
    v_cndmask_b32 v27, v27, v4, s[90:91]
    s_waitcnt lgkmcnt(6)
    v_cndmask_b32 v94, v94, v4, s[90:91]
    v_cndmask_b32 v95, v95, v4, s[90:91]
    v_mfma_f32_16x16x32_bf16 v[196:199], a[136:139], v[208:211], v[196:199]
    s_add_u32 s92, s47, 0
    v_max_f32 v160, v160, v157
    v_max_f32 v162, v162, v159
    v_mfma_f32_16x16x32_bf16 v[80:83], v[40:43], v[24:27], v[44:47]
    buffer_store_dwordx4 v[160:163], v3, s[40:43], s92 offen sc1
    v_mfma_f32_16x16x32_bf16 v[84:87], v[76:79], v[24:27], v[48:51]
    s_waitcnt lgkmcnt(4)
    v_mfma_f32_16x16x32_bf16 v[104:107], v[96:99], v[92:95], v[44:47]
    s_waitcnt lgkmcnt(2)
    buffer_load_dwordx4 v69, s[20:23], s3 offen offset:2048 lds
    v_mfma_f32_16x16x32_bf16 v[108:111], v[100:103], v[92:95], v[48:51]
    v_mfma_f32_16x16x32_bf16 v[180:183], a[140:143], v[212:215], v[180:183]
    ds_read_b64_tr_b16 v[208:209], v18 offset:40960
    ds_read_b64_tr_b16 v[210:211], v18 offset:41472
    v_mfma_f32_16x16x32_bf16 v[184:187], a[144:147], v[212:215], v[184:187]
    v_mfma_f32_16x16x32_bf16 v[188:191], a[148:151], v[212:215], v[188:191]
    v_max3_f32 v88, v80, v81, v84
    v_max3_f32 v90, v82, v83, v86
    v_max_f32 v88, v88, v85
    v_mfma_f32_16x16x32_bf16 v[192:195], a[152:155], v[212:215], v[192:195]
    v_max_f32 v90, v90, v87
    v_max3_f32 v112, v104, v105, v108
    v_max3_f32 v114, v106, v107, v110
    v_mfma_f32_16x16x32_bf16 v[196:199], a[156:159], v[212:215], v[196:199]
    buffer_load_dwordx4 v70, s[20:23], s3 offen offset:3072 lds
    v_max_f32 v112, v112, v109
    v_mfma_f32_16x16x32_bf16 v[180:183], a[160:163], v[200:203], v[180:183]
    ds_read_b64_tr_b16 v[212:213], v18 offset:45056
    ds_read_b64_tr_b16 v[214:215], v18 offset:45568
    v_max_f32 v114, v114, v111
    v_mfma_f32_16x16x32_bf16 v[184:187], a[164:167], v[200:203], v[184:187]
    v_mul_f32 v88, v88, v8
    v_mul_f32 v90, v90, v9
    v_max_f32 v80, v88, v90
    v_mfma_f32_16x16x32_bf16 v[188:191], a[168:171], v[200:203], v[188:191]
    v_mul_f32 v112, v112, v8
    v_mul_f32 v114, v114, v9
    v_max_f32 v104, v112, v114
    v_mfma_f32_16x16x32_bf16 v[192:195], a[172:175], v[200:203], v[192:195]
    s_nop 0
    v_permlane16_swap_b32 v80, v104
    v_max_f32 v80, v80, v104
    v_mov_b32 v104, v80
    v_mfma_f32_16x16x32_bf16 v[196:199], a[176:179], v[200:203], v[196:199]
    s_waitcnt lgkmcnt(4)
    s_add_u32 m0, s73, 16384
    s_add_u32 s3, s72, 229376
    v_permlane32_swap_b32 v80, v104
    v_max_f32 v80, v80, v104
    v_mov_b32 v104, v80
    v_mfma_f32_16x16x32_bf16 v[180:183], a[180:183], v[204:207], v[180:183]
    buffer_load_dwordx4 v67, s[20:23], s3 offen offset:0 lds
    ds_read_b64_tr_b16 v[200:201], v18 offset:49152
    ds_read_b64_tr_b16 v[202:203], v18 offset:49664
    v_mfma_f32_16x16x32_bf16 v[184:187], a[184:187], v[204:207], v[184:187]
    v_permlane16_swap_b32 v80, v104
    v_sub_f32 v88, v88, v80
    v_sub_f32 v90, v90, v80
    v_mfma_f32_16x16x32_bf16 v[188:191], a[188:191], v[204:207], v[188:191]
    v_sub_f32 v112, v112, v104
    v_sub_f32 v114, v114, v104
    v_mfma_f32_16x16x32_bf16 v[192:195], a[192:195], v[204:207], v[192:195]
    v_exp_f32 v88, v88
    v_mfma_f32_16x16x32_bf16 v[196:199], a[196:199], v[204:207], v[196:199]
    s_waitcnt lgkmcnt(4)
    v_exp_f32 v90, v90
    v_mfma_f32_16x16x32_bf16 v[180:183], a[200:203], v[208:211], v[180:183]
    ds_read_b64_tr_b16 v[204:205], v18 offset:53248
    ds_read_b64_tr_b16 v[206:207], v18 offset:53760
    v_mfma_f32_16x16x32_bf16 v[184:187], a[204:207], v[208:211], v[184:187]
    buffer_load_dwordx4 v68, s[20:23], s3 offen offset:1024 lds
    v_mfma_f32_16x16x32_bf16 v[188:191], a[208:211], v[208:211], v[188:191]
    v_exp_f32 v112, v112
    v_mfma_f32_16x16x32_bf16 v[192:195], a[212:215], v[208:211], v[192:195]
    v_exp_f32 v114, v114
    v_add_f32 v80, v88, v90
    v_mfma_f32_16x16x32_bf16 v[196:199], a[216:219], v[208:211], v[196:199]
    s_waitcnt lgkmcnt(4)
    ds_read_b128 v[76:79], v31 offset:0
    v_add_f32 v104, v112, v114
    v_mul_f32 v88, v88, v60
    v_mfma_f32_16x16x32_bf16 v[180:183], a[220:223], v[212:215], v[180:183]
    s_waitcnt lgkmcnt(3)
    ds_read_b128 v[100:103], v31 offset:64
    v_mul_f32 v90, v90, v61
    v_permlane16_swap_b32 v80, v104
    v_mfma_f32_16x16x32_bf16 v[180:183], a[240:243], v[200:203], v[180:183]
    s_waitcnt lgkmcnt(2)
    ds_read_b128 v[124:127], v31 offset:128
    v_add_f32 v80, v80, v104
    v_mov_b32 v104, v80
    v_mfma_f32_16x16x32_bf16 v[180:183], v[132:135], v[204:207], v[180:183]
    buffer_load_dwordx4 v69, s[20:23], s3 offen offset:2048 lds
    ds_read_b128 v[84:87], v31 offset:192
    v_mfma_f32_16x16x32_bf16 v[184:187], a[224:227], v[212:215], v[184:187]
    ds_read_b128 v[108:111], v31 offset:256
    v_mul_f32 v112, v112, v60
    v_mul_f32 v114, v114, v61
    v_mfma_f32_16x16x32_bf16 v[184:187], a[244:247], v[200:203], v[184:187]
    v_permlane32_swap_b32 v80, v104
    v_add_f32 v80, v80, v104
    v_mov_b32 v104, v80
    v_mfma_f32_16x16x32_bf16 v[184:187], v[136:139], v[204:207], v[184:187]
    s_nop 0
    v_permlane16_swap_b32 v80, v104
    v_mfma_f32_16x16x32_bf16 v[188:191], a[228:231], v[212:215], v[188:191]
    v_mov_b32 v14, v180
    v_mov_b32 v15, v180
    v_mfma_f32_16x16x32_bf16 v[188:191], a[248:251], v[200:203], v[188:191]
    s_nop 0
    v_permlane16_swap_b32 v14, v15
    v_mov_b32 v15, v14
    s_nop 1
    v_permlane32_swap_b32 v14, v15
    v_mfma_f32_16x16x32_bf16 v[188:191], v[140:143], v[204:207], v[188:191]
    buffer_load_dwordx4 v70, s[20:23], s3 offen offset:3072 lds
    v_mfma_f32_16x16x32_bf16 v[192:195], a[232:235], v[212:215], v[192:195]
    s_waitcnt lgkmcnt(4)
    v_fmac_f32 v180, v76, v14
    v_fmac_f32 v181, v77, v14
    v_fmac_f32 v182, v78, v14
    v_mfma_f32_16x16x32_bf16 v[192:195], a[252:255], v[200:203], v[192:195]
    v_fmac_f32 v183, v79, v14
    v_cvt_pk_bf16_f32 v180, v180, v181
    v_mfma_f32_16x16x32_bf16 v[192:195], v[144:147], v[204:207], v[192:195]
    v_cvt_pk_bf16_f32 v181, v182, v183
    s_waitcnt lgkmcnt(3)
    v_fmac_f32 v184, v100, v14
    v_mfma_f32_16x16x32_bf16 v[196:199], a[236:239], v[212:215], v[196:199]
    ds_write_b64 v58, v[180:181] offset:0
    v_fmac_f32 v185, v101, v14
    v_fmac_f32 v186, v102, v14
    v_mfma_f32_16x16x32_bf16 v[196:199], v[128:131], v[200:203], v[196:199]
    v_fmac_f32 v187, v103, v14
    v_cvt_pk_bf16_f32 v184, v184, v185
    v_cvt_pk_bf16_f32 v185, v186, v187
    v_mfma_f32_16x16x32_bf16 v[196:199], v[148:151], v[204:207], v[196:199]
    ds_write_b64 v58, v[184:185] offset:512
    s_waitcnt lgkmcnt(4)
    v_fmac_f32 v188, v124, v14
    v_fmac_f32 v189, v125, v14
    v_fmac_f32 v190, v126, v14
    v_fmac_f32 v191, v127, v14
    v_cvt_pk_bf16_f32 v188, v188, v189
    v_cvt_pk_bf16_f32 v189, v190, v191
    ds_write_b64 v58, v[188:189] offset:1024
    s_waitcnt lgkmcnt(4)
    v_pk_fma_f32 v[192:193], v[84:85], v[14:15], v[192:193] op_sel_hi:[1,0,1]
    v_pk_fma_f32 v[194:195], v[86:87], v[14:15], v[194:195] op_sel_hi:[1,0,1]
    v_cvt_pk_bf16_f32 v192, v192, v193
    v_cvt_pk_bf16_f32 v193, v194, v195
    ds_write_b64 v58, v[192:193] offset:1536
    s_waitcnt lgkmcnt(4)
    v_pk_fma_f32 v[196:197], v[108:109], v[14:15], v[196:197] op_sel_hi:[1,0,1]
    v_pk_fma_f32 v[198:199], v[110:111], v[14:15], v[198:199] op_sel_hi:[1,0,1]
    v_cvt_pk_bf16_f32 v196, v196, v197
    v_cvt_pk_bf16_f32 v197, v198, v199
    ds_write_b64 v58, v[196:197] offset:2048
    s_waitcnt vmcnt(9)
    s_waitcnt lgkmcnt(0)
    s_barrier
    s_add_u32 m0, s73, 32768
    s_add_u32 s3, s72, 458752
    buffer_load_dwordx4 v67, s[20:23], s3 offen offset:0 lds
    ds_read_b64 v[76:77], v59 offset:0
    ds_read_b64 v[78:79], v59 offset:512
    ds_read_b64 v[100:101], v59 offset:2560
    ds_read_b64 v[102:103], v59 offset:3072
    ds_read_b64 v[124:125], v59 offset:5120
    ds_read_b64 v[126:127], v59 offset:5632
    ds_read_b64 v[84:85], v59 offset:7680
    buffer_load_dwordx4 v68, s[20:23], s3 offen offset:1024 lds
    ds_read_b64 v[86:87], v59 offset:8192
    v_rcp_f32 v80, v80
    v_rcp_f32 v104, v104
    v_mul_f32 v88, v88, v80
    v_mul_f32 v90, v90, v80
    v_cvt_pk_bf16_f32 v88, v88, v88
    v_cvt_pk_bf16_f32 v90, v90, v90
    v_and_b32 v24, v88, v52
    v_and_b32 v25, v90, v53
    v_and_b32 v26, v88, v54
    v_and_b32 v27, v90, v55
    v_mul_f32 v112, v112, v104
    v_mul_f32 v114, v114, v104
    v_cvt_pk_bf16_f32 v112, v112, v112
    buffer_load_dwordx4 v69, s[20:23], s3 offen offset:2048 lds
    v_cvt_pk_bf16_f32 v114, v114, v114
    v_and_b32 v92, v112, v52
    v_and_b32 v93, v114, v53
    v_and_b32 v94, v112, v54
    v_and_b32 v95, v114, v55
    s_waitcnt vmcnt(9)
    s_add_u32 s93, s47, 4096
    buffer_load_dwordx4 v[120:123], v3, s[40:43], s93 offen sc1
    s_waitcnt lgkmcnt(6)
    v_mfma_f32_16x16x32_bf16 v[212:215], v[76:79], v[24:27], 0
    s_waitcnt lgkmcnt(4)
    ds_read_b64_tr_b16 a[0:1], v71 offset:0
    ds_read_b64_tr_b16 a[2:3], v71 offset:2048
    v_mfma_f32_16x16x32_bf16 v[208:211], v[100:103], v[24:27], 0
    ds_read_b64_tr_b16 a[4:5], v72 offset:0
    ds_read_b64_tr_b16 a[6:7], v72 offset:2048
    v_mfma_f32_16x16x32_bf16 v[204:207], v[100:103], v[92:95], 0
    s_waitcnt lgkmcnt(6)
    ds_read_b64_tr_b16 a[8:9], v73 offset:0
    ds_read_b64_tr_b16 a[10:11], v73 offset:2048
    buffer_load_dwordx4 v70, s[20:23], s3 offen offset:3072 lds
    v_mfma_f32_16x16x32_bf16 v[200:203], v[124:127], v[92:95], 0
    s_waitcnt lgkmcnt(6)
    ds_read_b64_tr_b16 a[12:13], v74 offset:0
    ds_read_b64_tr_b16 a[14:15], v74 offset:2048
    v_mfma_f32_16x16x32_bf16 v[108:111], v[84:87], v[92:95], 0
    ds_read_b64_tr_b16 a[16:17], v71 offset:4096
    ds_read_b64_tr_b16 a[18:19], v71 offset:6144
    s_add_u32 m0, s73, 49152
    s_add_u32 s3, s72, 688128
    buffer_load_dwordx4 v67, s[20:23], s3 offen offset:0 lds
    ds_read_b64_tr_b16 a[20:21], v72 offset:4096
    ds_read_b64_tr_b16 a[22:23], v72 offset:6144
    ds_read_b64_tr_b16 a[24:25], v73 offset:4096
    ds_read_b64_tr_b16 a[26:27], v73 offset:6144
    ds_read_b64_tr_b16 a[28:29], v74 offset:4096
    ds_read_b64_tr_b16 a[30:31], v74 offset:6144
    ds_read_b64_tr_b16 a[32:33], v71 offset:8192
    ds_read_b64_tr_b16 a[34:35], v71 offset:10240
    buffer_load_dwordx4 v68, s[20:23], s3 offen offset:1024 lds
    ds_read_b64_tr_b16 a[36:37], v72 offset:8192
    ds_read_b64_tr_b16 a[38:39], v72 offset:10240
    ds_read_b64_tr_b16 a[40:41], v73 offset:8192
    ds_read_b64_tr_b16 a[42:43], v73 offset:10240
    ds_read_b64_tr_b16 a[44:45], v74 offset:8192
    ds_read_b64_tr_b16 a[46:47], v74 offset:10240
    ds_read_b64_tr_b16 a[48:49], v71 offset:12288
    ds_read_b64_tr_b16 a[50:51], v71 offset:14336
    buffer_load_dwordx4 v69, s[20:23], s3 offen offset:2048 lds
    ds_read_b64_tr_b16 a[52:53], v72 offset:12288
    ds_read_b64_tr_b16 a[54:55], v72 offset:14336
    ds_read_b64_tr_b16 a[56:57], v73 offset:12288
    ds_read_b64_tr_b16 a[58:59], v73 offset:14336
    ds_read_b64_tr_b16 a[60:61], v74 offset:12288
    ds_read_b64_tr_b16 a[62:63], v74 offset:14336
    ds_read_b64_tr_b16 a[64:65], v71 offset:16384
    ds_read_b64_tr_b16 a[66:67], v71 offset:18432
    ds_read_b64_tr_b16 a[68:69], v72 offset:16384
    buffer_load_dwordx4 v70, s[20:23], s3 offen offset:3072 lds
    ds_read_b64_tr_b16 a[70:71], v72 offset:18432
    ds_read_b64_tr_b16 a[72:73], v73 offset:16384
    ds_read_b64_tr_b16 a[74:75], v73 offset:18432
    ds_read_b64_tr_b16 a[76:77], v74 offset:16384
    ds_read_b64_tr_b16 a[78:79], v74 offset:18432
    ds_read_b64_tr_b16 a[80:81], v71 offset:20480
    ds_read_b64_tr_b16 a[82:83], v71 offset:22528
    ds_read_b64_tr_b16 a[84:85], v72 offset:20480
    s_add_u32 m0, s73, 65536
    s_add_u32 s3, s72, 917504
    buffer_load_dwordx4 v67, s[20:23], s3 offen offset:0 lds
    ds_read_b64_tr_b16 a[86:87], v72 offset:22528
    ds_read_b64_tr_b16 a[88:89], v73 offset:20480
    ds_read_b64_tr_b16 a[90:91], v73 offset:22528
    ds_read_b64_tr_b16 a[92:93], v74 offset:20480
    ds_read_b64_tr_b16 a[94:95], v74 offset:22528
    v_cvt_pk_bf16_f32 v168, v212, v213
    v_cvt_pk_bf16_f32 v169, v214, v215
    v_cvt_pk_bf16_f32 v170, v208, v209
    v_cvt_pk_bf16_f32 v171, v210, v211
    v_cvt_pk_bf16_f32 v204, v204, v205
    buffer_load_dwordx4 v68, s[20:23], s3 offen offset:1024 lds
    v_cvt_pk_bf16_f32 v205, v206, v207
    v_cvt_pk_bf16_f32 v172, v200, v201
    v_cvt_pk_bf16_f32 v173, v202, v203
    v_cvt_pk_bf16_f32 v174, v108, v109
    v_cvt_pk_bf16_f32 v175, v110, v111
    buffer_load_dwordx4 v69, s[20:23], s3 offen offset:2048 lds
    buffer_load_dwordx4 v70, s[20:23], s3 offen offset:3072 lds
    s_waitcnt vmcnt(9)
    v_cmp_ne_u32 vcc, s68, v121
    v_cmp_ne_u32 s[6:7], s69, v123
    s_nop 0
    s_or_b64 vcc, vcc, s[6:7]
    s_cbranch_scc1 Lxd_6
Lxk_4:
    v_add_f32 v160, v160, v120
    v_add_f32 v162, v162, v122
    v_mul_f32 v160, v160, v8
    v_mul_f32 v162, v162, v9
    v_max_f32 v152, v160, v162
    v_mov_b32 v153, v152
    s_nop 1
    v_permlane16_swap_b32 v152, v153
    v_max_f32 v152, v152, v153
    v_mov_b32 v153, v152
    s_nop 1
    v_permlane32_swap_b32 v152, v153
    v_max_f32 v152, v152, v153
    v_sub_f32 v160, v160, v152
    v_sub_f32 v162, v162, v152
    v_exp_f32 v160, v160
    v_exp_f32 v162, v162
    s_nop 0
    v_add_f32 v152, v160, v162
    v_mov_b32 v153, v152
    v_mul_f32 v160, v160, v60
    v_mul_f32 v162, v162, v61
    v_permlane16_swap_b32 v152, v153
    v_add_f32 v152, v152, v153
    v_mov_b32 v153, v152
    s_nop 1
    v_permlane32_swap_b32 v152, v153
    v_add_f32 v152, v152, v153
    v_rcp_f32 v152, v152
    s_nop 0
    v_mul_f32 v160, v160, v152
    v_mul_f32 v162, v162, v152
    v_cvt_pk_bf16_f32 v160, v160, v160
    v_cvt_pk_bf16_f32 v162, v162, v162
    v_and_b32 v116, v160, v52
    v_and_b32 v117, v162, v53
    v_and_b32 v118, v160, v54
    v_and_b32 v119, v162, v55
    s_nop 1
    v_mfma_f32_16x16x32_bf16 v[176:179], v[84:87], v[116:119], 0
Lst2:
Lv0_2:
    s_cbranch_execz Lback
    s_nop 7
    v_cvt_pk_bf16_f32 v176, v176, v177
    v_cvt_pk_bf16_f32 v177, v178, v179
    v_cndmask_b32 v170, v170, v204, s[90:91]
    v_cndmask_b32 v171, v171, v205, s[90:91]
    v_cndmask_b32 v174, v174, v176, s[98:99]
    v_cndmask_b32 v175, v175, v177, s[98:99]
    buffer_store_dwordx4 v[168:171], v3, s[40:43], s48 offen offset:0 sc1
    buffer_store_dwordx4 v[172:175], v3, s[40:43], s48 offen offset:1024 sc1
    s_waitcnt lgkmcnt(0)
    s_barrier
    s_mul_i32 s52, s65, 512
    s_add_u32 s52, s52, 507904
    s_mul_i32 s49, s66, 64
    s_add_u32 s49, s49, s52
    s_mul_i32 s50, s65, 128
    s_mul_i32 s95, s66, 8
    s_add_u32 s50, s50, s95
    s_add_u32 s50, s50, 512000
    s_mul_i32 s45, s67, 11264
    s_add_u32 s45, s45, 114688
    s_mul_i32 s0, s67, 7168
    v_min_u32 v5, 6, v2
    v_lshlrev_b32 v8, 3, v5
    v_mul_u32_u24 v5, 64, v5
    v_add_u32 v9, 1, v2
    v_lshrrev_b32 v9, 2, v9
    v_min_u32 v9, 1, v9
    v_lshlrev_b32 v9, 20, v9
    v_add_lshl_u32 v9, v9, v2, 10
    v_min_u32 v10, 1, v2
    v_lshlrev_b32 v10, 30, v10
    v_bfe_u32 v14, v2, 4, 1
    v_lshlrev_b32 v25, 5, v14
    v_and_b32 v14, 3, v2
    v_lshl_add_u32 v25, v14, 3, v25
    v_bfe_u32 v11, v2, 2, 2
    v_lshrrev_b32 v14, 5, v2
    v_lshl_add_u32 v14, v14, 2, v11
    v_xor_b32 v11, s67, v11
    s_add_u32 m0, s73, 81920
    s_add_u32 s3, s72, 1146880
    buffer_load_dwordx4 v67, s[20:23], s3 offen offset:0 lds
    v_lshl_add_u32 v11, v11, 6, v25
    v_lshl_add_u32 v19, v14, 8, v11
    v_add_u32 v24, 57344, v19
    v_lshl_add_u32 v11, v14, 7, v25
    v_bfe_u32 v14, v2, 3, 1
    v_lshl_add_u32 v11, v14, 6, v11
    v_xor_b32 v14, 64, v11
    v_add_u32 v15, s45, v11
    v_add_u32 v16, s45, v14
    v_add_u32 v17, s0, v11
    v_add_u32 v18, s0, v14
    s_mul_i32 s92, s96, 256
    s_mul_i32 s95, s67, 64
    s_add_u32 s92, s92, s95
    v_and_b32 v11, 31, v2
    buffer_load_dwordx4 v68, s[20:23], s3 offen offset:1024 lds
    v_lshl_add_u32 v26, v11, 1, s92
    s_lshl_b32 s93, s66, 7
    v_and_b32 v14, 0x70, v3
    v_add_u32 v28, s93, v14
    ds_read_b64_tr_b16 a[96:97], v71 offset:24576
    ds_read_b64_tr_b16 a[98:99], v71 offset:26624
    s_lshr_b32 s93, s67, 1
    ds_read_b64_tr_b16 a[100:101], v72 offset:24576
    s_and_b32 s94, s67, 1
    ds_read_b64_tr_b16 a[102:103], v72 offset:26624
    s_mul_i32 s55, s65, 57344
    ds_read_b64_tr_b16 a[104:105], v73 offset:24576
    buffer_load_dwordx4 v69, s[20:23], s3 offen offset:2048 lds
    s_mul_i32 s95, s93, 28672
    ds_read_b64_tr_b16 a[106:107], v73 offset:26624
    s_add_u32 s55, s55, s95
    ds_read_b64_tr_b16 a[108:109], v74 offset:24576
    ds_read_b64_tr_b16 a[110:111], v74 offset:26624
    s_mul_i32 s95, s66, 4096
    ds_read_b64_tr_b16 a[112:113], v71 offset:28672
    s_add_u32 s55, s55, s95
    ds_read_b64_tr_b16 a[114:115], v71 offset:30720
    s_mul_i32 s95, s94, 256
    ds_read_b64_tr_b16 a[116:117], v72 offset:28672
    buffer_load_dwordx4 v70, s[20:23], s3 offen offset:3072 lds
    s_add_u32 s55, s55, s95
    ds_read_b64_tr_b16 a[118:119], v72 offset:30720
    s_add_u32 s55, s55, 262144
    ds_read_b64_tr_b16 a[120:121], v73 offset:28672
    ds_read_b64_tr_b16 a[122:123], v73 offset:30720
    s_mul_i32 s56, s65, 4096
    ds_read_b64_tr_b16 a[124:125], v74 offset:28672
    s_mul_i32 s95, s93, 2048
    ds_read_b64_tr_b16 a[126:127], v74 offset:30720
    s_add_u32 s56, s56, s95
    ds_read_b64_tr_b16 a[128:129], v71 offset:32768
    buffer_load_ushort v26, v26, s[28:31], 0 offen
    s_mul_i32 s95, s66, 256
    ds_read_b64_tr_b16 a[130:131], v71 offset:34816
    s_add_u32 s56, s56, s95
    ds_read_b64_tr_b16 a[132:133], v72 offset:32768
    s_mul_i32 s95, s94, 128
    ds_read_b64_tr_b16 a[134:135], v72 offset:34816
    ds_read_b64_tr_b16 a[136:137], v73 offset:32768
    s_add_u32 s56, s56, s95
    ds_read_b64_tr_b16 a[138:139], v73 offset:34816
    s_add_u32 s56, s56, 491520
    ds_read_b64_tr_b16 a[140:141], v74 offset:32768
    buffer_load_dwordx4 v[28:31], v28, s[32:35], 0 offen
    s_and_b32 s92, s65, 1
    ds_read_b64_tr_b16 a[142:143], v74 offset:34816
    s_xor_b32 s93, s92, 1
    ds_read_b64_tr_b16 a[144:145], v71 offset:36864
    s_mul_i32 s94, s67, 14336
    ds_read_b64_tr_b16 a[146:147], v71 offset:38912
    ds_read_b64_tr_b16 a[148:149], v72 offset:36864
    s_mul_i32 s95, s66, 128
    ds_read_b64_tr_b16 a[150:151], v72 offset:38912
    s_add_u32 s94, s94, s95
    ds_read_b64_tr_b16 a[152:153], v73 offset:36864
    s_mul_i32 s44, s92, 114688
    ds_read_b64_tr_b16 a[154:155], v73 offset:38912
    s_add_u32 s44, s44, s94
    ds_read_b64_tr_b16 a[156:157], v74 offset:36864
    s_mul_i32 s74, s93, 114688
    ds_read_b64_tr_b16 a[158:159], v74 offset:38912
    s_add_u32 s74, s74, s94
    v_lshlrev_b32 v164, 16, v32
    v_and_b32 v165, 0xffff0000, v32
    v_lshlrev_b32 v166, 16, v33
    v_and_b32 v167, 0xffff0000, v33
    v_lshlrev_b32 v176, 16, v34
    v_and_b32 v177, 0xffff0000, v34
    v_lshlrev_b32 v178, 16, v35
    v_and_b32 v179, 0xffff0000, v35
    v_lshlrev_b32 v180, 16, v36
    v_and_b32 v181, 0xffff0000, v36
    v_lshlrev_b32 v182, 16, v37
    v_and_b32 v183, 0xffff0000, v37
    v_lshlrev_b32 v184, 16, v38
    v_and_b32 v185, 0xffff0000, v38
    v_lshlrev_b32 v186, 16, v39
    v_and_b32 v187, 0xffff0000, v39
    v_and_b32 v14, 15, v2
    v_lshlrev_b32 v14, 3, v14
    v_lshrrev_b32 v11, 4, v2
    v_lshlrev_b32 v11, 9, v11
    v_lshl_add_u32 v11, v14, 1, v11
    s_waitcnt vmcnt(6)
    s_barrier
    s_cmp_lg_u32 s67, 0
    s_cbranch_scc1 Lg_7
    buffer_store_dwordx2 v[6:7], v10, s[40:43], s49 offen
Lg_7:
    s_branch Ljoin
Lvar1:
Lst3:
    s_cbranch_execz Lback
    v_mfma_f32_16x16x32_bf16 v[88:91], v[160:163], a[232:235], v[88:91]
    v_mfma_f32_16x16x32_bf16 v[92:95], v[160:163], a[236:239], v[92:95]
    s_waitcnt vmcnt(16)
    s_waitcnt lgkmcnt(0)
    s_barrier
    ds_read_b64_tr_b16 v[152:153], v17 offset:53280
    ds_read_b64_tr_b16 v[154:155], v17 offset:53792
    ds_read_b64_tr_b16 v[156:157], v17 offset:55328
    ds_read_b64_tr_b16 v[158:159], v17 offset:55840
    s_add_u32 m0, s71, 49152
    s_sub_u32 s3, s70, 57344
    v_mfma_f32_16x16x32_bf16 v[96:99], v[164:167], a[220:223], v[96:99]
    s_nop 3
    buffer_load_dwordx4 v64, s[16:19], s3 offen lds
    ds_read_b64_tr_b16 v[160:161], v17 offset:61472
    ds_read_b64_tr_b16 v[162:163], v17 offset:61984
    v_mfma_f32_16x16x32_bf16 v[100:103], v[164:167], a[224:227], v[100:103]
    v_cndmask_b32 v15, v116, v117, s[84:85]
    v_cndmask_b32 v15, v15, v118, s[86:87]
    v_cndmask_b32 v15, v15, v119, s[88:89]
    v_mfma_f32_16x16x32_bf16 v[104:107], v[164:167], a[228:231], v[104:107]
    s_add_u32 m0, s71, 53248
    s_sub_u32 s3, s70, 28672
    v_mul_f32 v14, 0xbb124925, v124
    v_mov_b32_dpp v40, v120 row_newbcast:0 row_mask:0xf bank_mask:0xf
    v_mov_b32_dpp v41, v121 row_newbcast:0 row_mask:0xf bank_mask:0xf
    v_mfma_f32_16x16x32_bf16 v[108:111], v[164:167], a[232:235], v[108:111]
    buffer_load_dwordx4 v64, s[16:19], s3 offen lds
    v_mfma_f32_16x16x32_bf16 v[112:115], v[164:167], a[236:239], v[112:115]
    s_waitcnt lgkmcnt(4)
    v_mov_b32_dpp v42, v122 row_newbcast:0 row_mask:0xf bank_mask:0xf
    v_mov_b32_dpp v43, v123 row_newbcast:0 row_mask:0xf bank_mask:0xf
    v_cndmask_b32 v25, v120, v121, s[84:85]
    v_cndmask_b32 v25, v25, v122, s[86:87]
    v_mfma_f32_16x16x32_bf16 v[76:79], v[152:155], a[240:243], v[76:79]
    ds_read_b64_tr_b16 v[164:165], v17 offset:63520
    ds_read_b64_tr_b16 v[166:167], v17 offset:64032
    v_cndmask_b32 v25, v25, v123, s[88:89]
    v_mfma_f32_16x16x32_bf16 v[80:83], v[152:155], a[244:247], v[80:83]
    s_add_u32 m0, s71, 28672
    s_add_u32 s3, s70, 200704
    v_cndmask_b32 v24, v40, v41, s[84:85]
    v_cndmask_b32 v24, v24, v42, s[86:87]
    v_cndmask_b32 v24, v24, v43, s[88:89]
    v_mfma_f32_16x16x32_bf16 v[84:87], v[152:155], a[248:251], v[84:87]
    buffer_load_dwordx4 v64, s[16:19], s3 offen lds
    v_mfma_f32_16x16x32_bf16 v[88:91], v[152:155], a[252:255], v[88:91]
    v_mul_f32 v24, 0xbb124925, v24
    v_mul_f32 v15, 0x3b124925, v15
    v_fma_f32 v15, -v14, v14, v15
    v_max_f32 v15, 0, v15
    v_mfma_f32_16x16x32_bf16 v[92:95], v[152:155], v[128:131], v[92:95]
    s_waitcnt lgkmcnt(2)
    v_add_f32 v15, 0x3727c5ac, v15
    v_rsq_f32 v15, v15
    v_mfma_f32_16x16x32_bf16 v[76:79], v[160:163], v[132:135], v[76:79]
    s_add_u32 m0, s71, 32768
    s_add_u32 s3, s70, 229376
    v_mul_f32 v25, 0x3b124925, v25
    v_fma_f32 v25, -v24, v24, v25
    v_max_f32 v25, 0, v25
    v_mfma_f32_16x16x32_bf16 v[80:83], v[160:163], v[136:139], v[80:83]
    buffer_load_dwordx4 v64, s[16:19], s3 offen lds
    v_mfma_f32_16x16x32_bf16 v[84:87], v[160:163], v[140:143], v[84:87]
    v_add_f32 v25, 0x3727c5ac, v25
    v_rsq_f32 v25, v25
    v_mfma_f32_16x16x32_bf16 v[88:91], v[160:163], v[144:147], v[88:91]
    ds_write2_b32 v62, v14, v15 offset0:0 offset1:80
    v_mfma_f32_16x16x32_bf16 v[92:95], v[160:163], v[148:151], v[92:95]
    s_add_u32 m0, s71, 36864
    s_add_u32 s3, s70, 258048
    ds_write2_b32 v63, v24, v25 offset0:0 offset1:80
    v_mfma_f32_16x16x32_bf16 v[96:99], v[156:159], a[240:243], v[96:99]
    buffer_load_dwordx4 v64, s[16:19], s3 offen lds
    v_mfma_f32_16x16x32_bf16 v[100:103], v[156:159], a[244:247], v[100:103]
    v_mfma_f32_16x16x32_bf16 v[104:107], v[156:159], a[248:251], v[104:107]
    s_waitcnt vmcnt(13)
    s_waitcnt lgkmcnt(0)
    s_barrier
    ds_read2_b32 v[26:27], v29 offset0:16 offset1:32
    ds_read2_b32 v[176:177], v29 offset0:48 offset1:64
    v_mfma_f32_16x16x32_bf16 v[108:111], v[156:159], a[252:255], v[108:111]
    s_add_u32 m0, s71, 40960
    s_add_u32 s3, s70, 286720
    ds_read_b32 v5, v29
    ds_read_b32 v9, v30 offset:320
    v_mfma_f32_16x16x32_bf16 v[112:115], v[156:159], v[128:131], v[112:115]
    buffer_load_dwordx4 v64, s[16:19], s3 offen lds
    ds_read_b32 v60, v60
    ds_read_b32 v61, v61
    v_mfma_f32_16x16x32_bf16 v[96:99], v[164:167], v[132:135], v[96:99]
    ds_read_b64_tr_b16 v[200:201], v18 offset:0
    ds_read_b64_tr_b16 v[202:203], v18 offset:512
    v_mfma_f32_16x16x32_bf16 v[100:103], v[164:167], v[136:139], v[100:103]
    ds_read_b64_tr_b16 v[204:205], v18 offset:4096
    ds_read_b64_tr_b16 v[206:207], v18 offset:4608
    s_waitcnt lgkmcnt(9)
    v_fmac_f32_dpp v80, v76, v26 row_newbcast:0 row_mask:0xf bank_mask:0xf
    v_mfma_f32_16x16x32_bf16 v[104:107], v[164:167], v[140:143], v[104:107]
    s_add_u32 m0, s71, 0
    s_add_u32 s3, s70, 0
    ds_read_b64_tr_b16 v[208:209], v18 offset:8192
    ds_read_b64_tr_b16 v[210:211], v18 offset:8704
    v_fmac_f32_dpp v81, v77, v26 row_newbcast:0 row_mask:0xf bank_mask:0xf
    v_fmac_f32_dpp v82, v78, v26 row_newbcast:0 row_mask:0xf bank_mask:0xf
    v_mfma_f32_16x16x32_bf16 v[108:111], v[164:167], v[144:147], v[108:111]
    buffer_load_dwordx4 v64, s[16:19], s3 offen lds
    v_mfma_f32_16x16x32_bf16 v[112:115], v[164:167], v[148:151], v[112:115]
    s_waitcnt lgkmcnt(4)
    v_fmac_f32_dpp v83, v79, v26 row_newbcast:0 row_mask:0xf bank_mask:0xf
    v_cvt_pk_bf16_f32 v80, v80, v81
    v_cvt_pk_bf16_f32 v81, v82, v83
    v_mfma_f32_16x16x32_bf16 v[180:183], a[0:3], v[200:203], 0
    s_add_u32 m0, s71, 4096
    s_add_u32 s3, s70, 28672
    ds_write_b64 v56, v[80:81] offset:0
    ds_read_b64_tr_b16 v[212:213], v18 offset:12288
    ds_read_b64_tr_b16 v[214:215], v18 offset:12800
    v_fmac_f32_dpp v84, v76, v27 row_newbcast:0 row_mask:0xf bank_mask:0xf
    v_mfma_f32_16x16x32_bf16 v[184:187], a[4:7], v[200:203], 0
    buffer_load_dwordx4 v64, s[16:19], s3 offen lds
    v_fmac_f32_dpp v85, v77, v27 row_newbcast:0 row_mask:0xf bank_mask:0xf
    v_mfma_f32_16x16x32_bf16 v[188:191], a[8:11], v[200:203], 0
    v_fmac_f32_dpp v86, v78, v27 row_newbcast:0 row_mask:0xf bank_mask:0xf
    v_fmac_f32_dpp v87, v79, v27 row_newbcast:0 row_mask:0xf bank_mask:0xf
    v_cvt_pk_bf16_f32 v84, v84, v85
    v_mfma_f32_16x16x32_bf16 v[192:195], a[12:15], v[200:203], 0
    v_cvt_pk_bf16_f32 v85, v86, v87
    v_fmac_f32_dpp v88, v76, v176 row_newbcast:0 row_mask:0xf bank_mask:0xf
    v_fmac_f32_dpp v89, v77, v176 row_newbcast:0 row_mask:0xf bank_mask:0xf
    v_mfma_f32_16x16x32_bf16 v[196:199], a[16:19], v[200:203], 0
    s_waitcnt lgkmcnt(5)
    s_add_u32 m0, s71, 8192
    s_add_u32 s3, s70, 57344
    ds_write_b64 v56, v[84:85] offset:2176
    v_fmac_f32_dpp v90, v78, v176 row_newbcast:0 row_mask:0xf bank_mask:0xf
    v_fmac_f32_dpp v91, v79, v176 row_newbcast:0 row_mask:0xf bank_mask:0xf
    v_cvt_pk_bf16_f32 v88, v88, v89
    v_mfma_f32_16x16x32_bf16 v[180:183], a[20:23], v[204:207], v[180:183]
    buffer_load_dwordx4 v64, s[16:19], s3 offen lds
    ds_read_b64_tr_b16 v[200:201], v18 offset:16384
    ds_read_b64_tr_b16 v[202:203], v18 offset:16896
    v_mfma_f32_16x16x32_bf16 v[184:187], a[24:27], v[204:207], v[184:187]
    v_cvt_pk_bf16_f32 v89, v90, v91
    v_fmac_f32_dpp v92, v76, v177 row_newbcast:0 row_mask:0xf bank_mask:0xf
    v_mfma_f32_16x16x32_bf16 v[188:191], a[28:31], v[204:207], v[188:191]
    ds_write_b64 v56, v[88:89] offset:4352
    v_fmac_f32_dpp v93, v77, v177 row_newbcast:0 row_mask:0xf bank_mask:0xf
    v_fmac_f32_dpp v94, v78, v177 row_newbcast:0 row_mask:0xf bank_mask:0xf
    v_fmac_f32_dpp v95, v79, v177 row_newbcast:0 row_mask:0xf bank_mask:0xf
    v_cvt_pk_bf16_f32 v92, v92, v93
    v_mfma_f32_16x16x32_bf16 v[192:195], a[32:35], v[204:207], v[192:195]
    s_add_u32 m0, s71, 12288
    s_add_u32 s3, s70, 86016
    v_cvt_pk_bf16_f32 v93, v94, v95
    v_fmac_f32_dpp v100, v96, v26 row_newbcast:0 row_mask:0xf bank_mask:0xf
    v_mfma_f32_16x16x32_bf16 v[196:199], a[36:39], v[204:207], v[196:199]
    s_waitcnt lgkmcnt(7)
    buffer_load_dwordx4 v64, s[16:19], s3 offen lds
    ds_write_b64 v56, v[92:93] offset:6528
    v_fmac_f32_dpp v101, v97, v26 row_newbcast:0 row_mask:0xf bank_mask:0xf
    v_mfma_f32_16x16x32_bf16 v[180:183], a[40:43], v[208:211], v[180:183]
    ds_read_b64_tr_b16 v[204:205], v18 offset:20480
    ds_read_b64_tr_b16 v[206:207], v18 offset:20992
    v_fmac_f32_dpp v102, v98, v26 row_newbcast:0 row_mask:0xf bank_mask:0xf
    v_mfma_f32_16x16x32_bf16 v[184:187], a[44:47], v[208:211], v[184:187]
    v_fmac_f32_dpp v103, v99, v26 row_newbcast:0 row_mask:0xf bank_mask:0xf
    v_cvt_pk_bf16_f32 v100, v100, v101
    v_cvt_pk_bf16_f32 v101, v102, v103
    v_mfma_f32_16x16x32_bf16 v[188:191], a[48:51], v[208:211], v[188:191]
    s_add_u32 m0, s71, 16384
    s_add_u32 s3, s70, 114688
    ds_write_b64 v56, v[100:101] offset:10880
    v_fmac_f32_dpp v104, v96, v27 row_newbcast:0 row_mask:0xf bank_mask:0xf
    v_fmac_f32_dpp v105, v97, v27 row_newbcast:0 row_mask:0xf bank_mask:0xf
    v_fmac_f32_dpp v106, v98, v27 row_newbcast:0 row_mask:0xf bank_mask:0xf
    v_mfma_f32_16x16x32_bf16 v[192:195], a[52:55], v[208:211], v[192:195]
    buffer_load_dwordx4 v64, s[16:19], s3 offen lds
    v_fmac_f32_dpp v107, v99, v27 row_newbcast:0 row_mask:0xf bank_mask:0xf
    v_mfma_f32_16x16x32_bf16 v[196:199], a[56:59], v[208:211], v[196:199]
    s_waitcnt lgkmcnt(8)
    v_cvt_pk_bf16_f32 v104, v104, v105
    v_cvt_pk_bf16_f32 v105, v106, v107
    v_mfma_f32_16x16x32_bf16 v[180:183], a[60:63], v[212:215], v[180:183]
    ds_write_b64 v56, v[104:105] offset:13056
    ds_read_b64_tr_b16 v[208:209], v18 offset:24576
    ds_read_b64_tr_b16 v[210:211], v18 offset:25088
    v_fmac_f32_dpp v108, v96, v176 row_newbcast:0 row_mask:0xf bank_mask:0xf
    v_fmac_f32_dpp v109, v97, v176 row_newbcast:0 row_mask:0xf bank_mask:0xf
    v_mfma_f32_16x16x32_bf16 v[184:187], a[64:67], v[212:215], v[184:187]
    s_add_u32 m0, s71, 20480
    s_add_u32 s3, s70, 143360
    v_fmac_f32_dpp v110, v98, v176 row_newbcast:0 row_mask:0xf bank_mask:0xf
    v_fmac_f32_dpp v111, v99, v176 row_newbcast:0 row_mask:0xf bank_mask:0xf
    v_cvt_pk_bf16_f32 v108, v108, v109
    v_mfma_f32_16x16x32_bf16 v[188:191], a[68:71], v[212:215], v[188:191]
    buffer_load_dwordx4 v64, s[16:19], s3 offen lds
    v_cvt_pk_bf16_f32 v109, v110, v111
    v_mfma_f32_16x16x32_bf16 v[192:195], a[72:75], v[212:215], v[192:195]
    ds_write_b64 v56, v[108:109] offset:15232
    v_fmac_f32_dpp v112, v96, v177 row_newbcast:0 row_mask:0xf bank_mask:0xf
    v_fmac_f32_dpp v113, v97, v177 row_newbcast:0 row_mask:0xf bank_mask:0xf
    v_mfma_f32_16x16x32_bf16 v[196:199], a[76:79], v[212:215], v[196:199]
    s_waitcnt lgkmcnt(9)
    v_fmac_f32_dpp v114, v98, v177 row_newbcast:0 row_mask:0xf bank_mask:0xf
    v_fmac_f32_dpp v115, v99, v177 row_newbcast:0 row_mask:0xf bank_mask:0xf
    v_cvt_pk_bf16_f32 v112, v112, v113
    v_cvt_pk_bf16_f32 v113, v114, v115
    v_mfma_f32_16x16x32_bf16 v[180:183], a[80:83], v[200:203], v[180:183]
    ds_read_b64_tr_b16 v[212:213], v18 offset:28672
    ds_read_b64_tr_b16 v[214:215], v18 offset:29184
    ds_write_b64 v56, v[112:113] offset:17408
    v_mfma_f32_16x16x32_bf16 v[184:187], a[84:87], v[200:203], v[184:187]
    v_fmac_f32_dpp v96, v96, v5 row_newbcast:0 row_mask:0xf bank_mask:0xf
    v_fmac_f32_dpp v97, v97, v5 row_newbcast:0 row_mask:0xf bank_mask:0xf
    v_fmac_f32_dpp v98, v98, v5 row_newbcast:0 row_mask:0xf bank_mask:0xf
    v_fmac_f32_dpp v99, v99, v5 row_newbcast:0 row_mask:0xf bank_mask:0xf
    v_mfma_f32_16x16x32_bf16 v[188:191], a[88:91], v[200:203], v[188:191]
    v_cvt_pk_bf16_f32 v96, v96, v97
    v_cvt_pk_bf16_f32 v97, v98, v99
    v_mfma_f32_16x16x32_bf16 v[192:195], a[92:95], v[200:203], v[192:195]
    ds_write_b64 v56, v[96:97] offset:8704
    v_mul_f32 v9, 0x3e8b97f6, v9
    v_mul_f32 v8, v9, v60
    v_mul_f32 v9, v9, v61
    v_mfma_f32_16x16x32_bf16 v[196:199], a[96:99], v[200:203], v[196:199]
    s_waitcnt vmcnt(14)
    s_waitcnt lgkmcnt(0)
    s_barrier
    ds_read_b64 v[24:25], v57 offset:0
    ds_read_b64 v[26:27], v57 offset:32
    ds_read_b64 v[40:41], v57 offset:8704
    ds_read_b64 v[42:43], v57 offset:8736
    ds_read_b64 v[76:77], v57 offset:10880
    ds_read_b64 v[78:79], v57 offset:10912
    ds_read_b64 v[118:119], v57 offset:96
    ds_read_b64 v[122:123], v57 offset:8800
    ds_read_b64 v[126:127], v57 offset:10976
    v_mfma_f32_16x16x32_bf16 v[180:183], a[100:103], v[204:207], v[180:183]
    ds_read_b64_tr_b16 v[200:201], v18 offset:32768
    ds_read_b64_tr_b16 v[202:203], v18 offset:33280
    v_mov_b32 v116, 0
    v_mov_b32 v117, 0
    v_mfma_f32_16x16x32_bf16 v[184:187], a[104:107], v[204:207], v[184:187]
    s_add_u32 m0, s73, 0
    s_add_u32 s3, s72, 0
    v_mov_b32 v120, 0
    v_mov_b32 v121, 0
    v_mov_b32 v124, 0
    v_mov_b32 v125, 0
    v_mov_b32 v89, s68
    v_mfma_f32_16x16x32_bf16 v[188:191], a[108:111], v[204:207], v[188:191]
    buffer_load_dwordx4 v67, s[20:23], s3 offen offset:0 lds
    v_mov_b32 v91, s69
    v_mfma_f32_16x16x32_bf16 v[192:195], a[112:115], v[204:207], v[192:195]
    ds_read_b64 v[92:93], v57 offset:40
    v_mov_b32 v161, s68
    v_mov_b32 v163, s69
    s_waitcnt lgkmcnt(10)
    v_cndmask_b32 v26, v26, v4, s[78:79]
    v_cndmask_b32 v27, v27, v4, s[78:79]
    v_mfma_f32_16x16x32_bf16 v[196:199], a[116:119], v[204:207], v[196:199]
    s_waitcnt lgkmcnt(8)
    ds_read_b64 v[94:95], v57 offset:72
    v_mfma_f32_16x16x32_bf16 v[80:83], v[40:43], v[24:27], v[44:47]
    s_waitcnt lgkmcnt(7)
    ds_read_b64 v[96:97], v57 offset:8744
    v_mfma_f32_16x16x32_bf16 v[84:87], v[76:79], v[24:27], v[48:51]
    s_waitcnt lgkmcnt(6)
    ds_read_b64 v[98:99], v57 offset:8776
    v_mfma_f32_16x16x32_bf16 v[152:155], v[120:123], v[116:119], v[44:47]
    s_waitcnt lgkmcnt(6)
    ds_read_b64 v[100:101], v57 offset:10920
    v_mfma_f32_16x16x32_bf16 v[156:159], v[124:127], v[116:119], v[48:51]
    buffer_load_dwordx4 v68, s[20:23], s3 offen offset:1024 lds
    ds_read_b64 v[102:103], v57 offset:10952
    v_mfma_f32_16x16x32_bf16 v[180:183], a[120:123], v[208:211], v[180:183]
    ds_read_b64_tr_b16 v[204:205], v18 offset:36864
    ds_read_b64_tr_b16 v[206:207], v18 offset:37376
    v_mfma_f32_16x16x32_bf16 v[184:187], a[124:127], v[208:211], v[184:187]
    v_max3_f32 v88, v80, v81, v84
    v_max3_f32 v90, v82, v83, v86
    v_max_f32 v88, v88, v85
    v_max_f32 v90, v90, v87
    v_mfma_f32_16x16x32_bf16 v[188:191], a[128:131], v[208:211], v[188:191]
    v_max3_f32 v160, v152, v153, v156
    v_max3_f32 v162, v154, v155, v158
    v_max_f32 v160, v160, v157
    v_max_f32 v162, v162, v159
    v_mfma_f32_16x16x32_bf16 v[192:195], a[132:135], v[208:211], v[192:195]
    s_add_u32 s92, s47, 4096
    s_waitcnt lgkmcnt(6)
    v_cndmask_b32 v94, v94, v4, s[90:91]
    v_cndmask_b32 v95, v95, v4, s[90:91]
    v_mfma_f32_16x16x32_bf16 v[196:199], a[136:139], v[208:211], v[196:199]
    s_waitcnt lgkmcnt(4)
    buffer_store_dwordx4 v[88:91], v3, s[40:43], s92 offen sc1
    v_mfma_f32_16x16x32_bf16 v[104:107], v[96:99], v[92:95], v[44:47]
    s_waitcnt lgkmcnt(2)
    buffer_load_dwordx4 v69, s[20:23], s3 offen offset:2048 lds
    s_add_u32 s95, s47, 8192
    buffer_store_dwordx4 v[160:163], v3, s[40:43], s95 offen sc1
    v_mfma_f32_16x16x32_bf16 v[108:111], v[100:103], v[92:95], v[48:51]
    v_mfma_f32_16x16x32_bf16 v[180:183], a[140:143], v[212:215], v[180:183]
    ds_read_b64_tr_b16 v[208:209], v18 offset:40960
    ds_read_b64_tr_b16 v[210:211], v18 offset:41472
    v_mfma_f32_16x16x32_bf16 v[184:187], a[144:147], v[212:215], v[184:187]
    v_mfma_f32_16x16x32_bf16 v[188:191], a[148:151], v[212:215], v[188:191]
    s_nop 2
    v_max3_f32 v112, v104, v105, v108
    v_max3_f32 v114, v106, v107, v110
    v_mfma_f32_16x16x32_bf16 v[192:195], a[152:155], v[212:215], v[192:195]
    v_max_f32 v112, v112, v109
    v_max_f32 v114, v114, v111
    v_mul_f32 v112, v112, v8
    v_mfma_f32_16x16x32_bf16 v[196:199], a[156:159], v[212:215], v[196:199]
    buffer_load_dwordx4 v70, s[20:23], s3 offen offset:3072 lds
    v_mfma_f32_16x16x32_bf16 v[180:183], a[160:163], v[200:203], v[180:183]
    ds_read_b64_tr_b16 v[212:213], v18 offset:45056
    ds_read_b64_tr_b16 v[214:215], v18 offset:45568
    v_mul_f32 v114, v114, v9
    v_mfma_f32_16x16x32_bf16 v[184:187], a[164:167], v[200:203], v[184:187]
    v_max_f32 v104, v112, v114
    v_mov_b32 v105, v104
    v_mfma_f32_16x16x32_bf16 v[188:191], a[168:171], v[200:203], v[188:191]
    s_nop 0
    v_permlane16_swap_b32 v104, v105
    v_max_f32 v104, v104, v105
    v_mov_b32 v105, v104
    v_mfma_f32_16x16x32_bf16 v[192:195], a[172:175], v[200:203], v[192:195]
    s_nop 0
    v_permlane32_swap_b32 v104, v105
    v_max_f32 v104, v104, v105
    v_mfma_f32_16x16x32_bf16 v[196:199], a[176:179], v[200:203], v[196:199]
    s_waitcnt lgkmcnt(4)
    s_add_u32 m0, s73, 16384
    s_add_u32 s3, s72, 229376
    v_sub_f32 v112, v112, v104
    v_sub_f32 v114, v114, v104
    v_mfma_f32_16x16x32_bf16 v[180:183], a[180:183], v[204:207], v[180:183]
    buffer_load_dwordx4 v67, s[20:23], s3 offen offset:0 lds
    ds_read_b64_tr_b16 v[200:201], v18 offset:49152
    ds_read_b64_tr_b16 v[202:203], v18 offset:49664
    v_mfma_f32_16x16x32_bf16 v[184:187], a[184:187], v[204:207], v[184:187]
    v_exp_f32 v112, v112
    v_mfma_f32_16x16x32_bf16 v[188:191], a[188:191], v[204:207], v[188:191]
    v_exp_f32 v114, v114
    s_nop 0
    v_add_f32 v104, v112, v114
    v_mfma_f32_16x16x32_bf16 v[192:195], a[192:195], v[204:207], v[192:195]
    v_mov_b32 v105, v104
    v_mul_f32 v112, v112, v60
    v_mfma_f32_16x16x32_bf16 v[196:199], a[196:199], v[204:207], v[196:199]
    s_waitcnt lgkmcnt(4)
    v_mul_f32 v114, v114, v61
    v_permlane16_swap_b32 v104, v105
    v_add_f32 v104, v104, v105
    v_mfma_f32_16x16x32_bf16 v[180:183], a[200:203], v[208:211], v[180:183]
    ds_read_b64_tr_b16 v[204:205], v18 offset:53248
    ds_read_b64_tr_b16 v[206:207], v18 offset:53760
    v_mfma_f32_16x16x32_bf16 v[184:187], a[204:207], v[208:211], v[184:187]
    buffer_load_dwordx4 v68, s[20:23], s3 offen offset:1024 lds
    v_mov_b32 v105, v104
    v_mfma_f32_16x16x32_bf16 v[188:191], a[208:211], v[208:211], v[188:191]
    s_nop 0
    v_permlane32_swap_b32 v104, v105
    v_add_f32 v104, v104, v105
    v_mfma_f32_16x16x32_bf16 v[192:195], a[212:215], v[208:211], v[192:195]
    v_rcp_f32 v104, v104
    s_nop 0
    v_mul_f32 v112, v112, v104
    v_mfma_f32_16x16x32_bf16 v[196:199], a[216:219], v[208:211], v[196:199]
    s_waitcnt lgkmcnt(4)
    ds_read_b128 v[76:79], v31 offset:0
    v_mul_f32 v114, v114, v104
    v_mfma_f32_16x16x32_bf16 v[180:183], a[220:223], v[212:215], v[180:183]
    s_waitcnt lgkmcnt(3)
    ds_read_b128 v[100:103], v31 offset:64
    v_cvt_pk_bf16_f32 v112, v112, v112
    v_cvt_pk_bf16_f32 v114, v114, v114
    v_mfma_f32_16x16x32_bf16 v[180:183], a[240:243], v[200:203], v[180:183]
    s_waitcnt lgkmcnt(2)
    ds_read_b128 v[124:127], v31 offset:128
    v_and_b32 v92, v112, v52
    v_mfma_f32_16x16x32_bf16 v[180:183], v[132:135], v[204:207], v[180:183]
    buffer_load_dwordx4 v69, s[20:23], s3 offen offset:2048 lds
    ds_read_b128 v[84:87], v31 offset:192
    v_mfma_f32_16x16x32_bf16 v[184:187], a[224:227], v[212:215], v[184:187]
    ds_read_b128 v[108:111], v31 offset:256
    v_and_b32 v93, v114, v53
    v_mfma_f32_16x16x32_bf16 v[184:187], a[244:247], v[200:203], v[184:187]
    v_and_b32 v94, v112, v54
    v_and_b32 v95, v114, v55
    v_mfma_f32_16x16x32_bf16 v[184:187], v[136:139], v[204:207], v[184:187]
    v_mfma_f32_16x16x32_bf16 v[188:191], a[228:231], v[212:215], v[188:191]
    v_mov_b32 v14, v180
    v_mov_b32 v15, v180
    v_mfma_f32_16x16x32_bf16 v[188:191], a[248:251], v[200:203], v[188:191]
    s_nop 0
    v_permlane16_swap_b32 v14, v15
    v_mov_b32 v15, v14
    s_nop 1
    v_permlane32_swap_b32 v14, v15
    v_mfma_f32_16x16x32_bf16 v[188:191], v[140:143], v[204:207], v[188:191]
    buffer_load_dwordx4 v70, s[20:23], s3 offen offset:3072 lds
    v_mfma_f32_16x16x32_bf16 v[192:195], a[232:235], v[212:215], v[192:195]
    s_waitcnt lgkmcnt(4)
    v_fmac_f32 v180, v76, v14
    v_fmac_f32 v181, v77, v14
    v_fmac_f32 v182, v78, v14
    v_mfma_f32_16x16x32_bf16 v[192:195], a[252:255], v[200:203], v[192:195]
    v_fmac_f32 v183, v79, v14
    v_cvt_pk_bf16_f32 v180, v180, v181
    v_mfma_f32_16x16x32_bf16 v[192:195], v[144:147], v[204:207], v[192:195]
    v_cvt_pk_bf16_f32 v181, v182, v183
    s_waitcnt lgkmcnt(3)
    v_fmac_f32 v184, v100, v14
    v_mfma_f32_16x16x32_bf16 v[196:199], a[236:239], v[212:215], v[196:199]
    ds_write_b64 v58, v[180:181] offset:0
    v_fmac_f32 v185, v101, v14
    v_fmac_f32 v186, v102, v14
    v_mfma_f32_16x16x32_bf16 v[196:199], v[128:131], v[200:203], v[196:199]
    v_fmac_f32 v187, v103, v14
    v_cvt_pk_bf16_f32 v184, v184, v185
    v_cvt_pk_bf16_f32 v185, v186, v187
    v_mfma_f32_16x16x32_bf16 v[196:199], v[148:151], v[204:207], v[196:199]
    ds_write_b64 v58, v[184:185] offset:512
    s_waitcnt lgkmcnt(4)
    v_fmac_f32 v188, v124, v14
    v_fmac_f32 v189, v125, v14
    v_fmac_f32 v190, v126, v14
    v_fmac_f32 v191, v127, v14
    v_cvt_pk_bf16_f32 v188, v188, v189
    v_cvt_pk_bf16_f32 v189, v190, v191
    ds_write_b64 v58, v[188:189] offset:1024
    s_waitcnt lgkmcnt(4)
    v_pk_fma_f32 v[192:193], v[84:85], v[14:15], v[192:193] op_sel_hi:[1,0,1]
    v_pk_fma_f32 v[194:195], v[86:87], v[14:15], v[194:195] op_sel_hi:[1,0,1]
    v_cvt_pk_bf16_f32 v192, v192, v193
    v_cvt_pk_bf16_f32 v193, v194, v195
    ds_write_b64 v58, v[192:193] offset:1536
    s_waitcnt lgkmcnt(4)
    v_pk_fma_f32 v[196:197], v[108:109], v[14:15], v[196:197] op_sel_hi:[1,0,1]
    v_pk_fma_f32 v[198:199], v[110:111], v[14:15], v[198:199] op_sel_hi:[1,0,1]
    v_cvt_pk_bf16_f32 v196, v196, v197
    v_cvt_pk_bf16_f32 v197, v198, v199
Lst4:
Lv1_1:
Lv1_2:
    s_cbranch_execz Lback
    ds_write_b64 v58, v[196:197] offset:2048
    s_waitcnt vmcnt(10)
    s_waitcnt lgkmcnt(0)
    s_barrier
    s_add_u32 m0, s73, 32768
    s_add_u32 s3, s72, 458752
    buffer_load_dwordx4 v67, s[20:23], s3 offen offset:0 lds
    ds_read_b64 v[76:77], v59 offset:0
    ds_read_b64 v[78:79], v59 offset:512
    ds_read_b64 v[100:101], v59 offset:2560
    ds_read_b64 v[102:103], v59 offset:3072
    ds_read_b64 v[124:125], v59 offset:5120
    ds_read_b64 v[126:127], v59 offset:5632
    ds_read_b64 v[84:85], v59 offset:7680
    buffer_load_dwordx4 v68, s[20:23], s3 offen offset:1024 lds
    ds_read_b64 v[86:87], v59 offset:8192
    s_waitcnt vmcnt(7)
    s_add_u32 s93, s47, 0
    buffer_load_dwordx4 v[40:43], v3, s[40:43], s93 offen sc1
    s_add_u32 s94, s47, 12288
    buffer_load_dwordx4 v[120:123], v3, s[40:43], s94 offen sc1
    s_waitcnt lgkmcnt(4)
    v_mfma_f32_16x16x32_bf16 v[204:207], v[100:103], v[92:95], 0
    s_waitcnt lgkmcnt(2)
    ds_read_b64_tr_b16 a[0:1], v71 offset:0
    ds_read_b64_tr_b16 a[2:3], v71 offset:2048
    v_mfma_f32_16x16x32_bf16 v[200:203], v[124:127], v[92:95], 0
    ds_read_b64_tr_b16 a[4:5], v72 offset:0
    ds_read_b64_tr_b16 a[6:7], v72 offset:2048
    ds_read_b64_tr_b16 a[8:9], v73 offset:0
    ds_read_b64_tr_b16 a[10:11], v73 offset:2048
    ds_read_b64_tr_b16 a[12:13], v74 offset:0
    ds_read_b64_tr_b16 a[14:15], v74 offset:2048
    ds_read_b64_tr_b16 a[16:17], v71 offset:4096
    ds_read_b64_tr_b16 a[18:19], v71 offset:6144
    ds_read_b64_tr_b16 a[20:21], v72 offset:4096
    ds_read_b64_tr_b16 a[22:23], v72 offset:6144
    ds_read_b64_tr_b16 a[24:25], v73 offset:4096
    ds_read_b64_tr_b16 a[26:27], v73 offset:6144
    ds_read_b64_tr_b16 a[28:29], v74 offset:4096
    ds_read_b64_tr_b16 a[30:31], v74 offset:6144
    ds_read_b64_tr_b16 a[32:33], v71 offset:8192
    ds_read_b64_tr_b16 a[34:35], v71 offset:10240
    buffer_load_dwordx4 v69, s[20:23], s3 offen offset:2048 lds
    ds_read_b64_tr_b16 a[36:37], v72 offset:8192
    ds_read_b64_tr_b16 a[38:39], v72 offset:10240
    ds_read_b64_tr_b16 a[40:41], v73 offset:8192
    ds_read_b64_tr_b16 a[42:43], v73 offset:10240
    ds_read_b64_tr_b16 a[44:45], v74 offset:8192
    ds_read_b64_tr_b16 a[46:47], v74 offset:10240
    ds_read_b64_tr_b16 a[48:49], v71 offset:12288
    ds_read_b64_tr_b16 a[50:51], v71 offset:14336
    ds_read_b64_tr_b16 a[52:53], v72 offset:12288
    buffer_load_dwordx4 v70, s[20:23], s3 offen offset:3072 lds
    ds_read_b64_tr_b16 a[54:55], v72 offset:14336
    ds_read_b64_tr_b16 a[56:57], v73 offset:12288
    ds_read_b64_tr_b16 a[58:59], v73 offset:14336
    ds_read_b64_tr_b16 a[60:61], v74 offset:12288
    ds_read_b64_tr_b16 a[62:63], v74 offset:14336
    ds_read_b64_tr_b16 a[64:65], v71 offset:16384
    ds_read_b64_tr_b16 a[66:67], v71 offset:18432
    ds_read_b64_tr_b16 a[68:69], v72 offset:16384
    s_add_u32 m0, s73, 49152
    s_add_u32 s3, s72, 688128
    buffer_load_dwordx4 v67, s[20:23], s3 offen offset:0 lds
    ds_read_b64_tr_b16 a[70:71], v72 offset:18432
    ds_read_b64_tr_b16 a[72:73], v73 offset:16384
    ds_read_b64_tr_b16 a[74:75], v73 offset:18432
    ds_read_b64_tr_b16 a[76:77], v74 offset:16384
    ds_read_b64_tr_b16 a[78:79], v74 offset:18432
    ds_read_b64_tr_b16 a[80:81], v71 offset:20480
    ds_read_b64_tr_b16 a[82:83], v71 offset:22528
    ds_read_b64_tr_b16 a[84:85], v72 offset:20480
    buffer_load_dwordx4 v68, s[20:23], s3 offen offset:1024 lds
    ds_read_b64_tr_b16 a[86:87], v72 offset:22528
    ds_read_b64_tr_b16 a[88:89], v73 offset:20480
    ds_read_b64_tr_b16 a[90:91], v73 offset:22528
    ds_read_b64_tr_b16 a[92:93], v74 offset:20480
    ds_read_b64_tr_b16 a[94:95], v74 offset:22528
    v_cvt_pk_bf16_f32 v204, v204, v205
    v_cvt_pk_bf16_f32 v205, v206, v207
    v_cvt_pk_bf16_f32 v172, v200, v201
    v_cvt_pk_bf16_f32 v173, v202, v203
    buffer_load_dwordx4 v69, s[20:23], s3 offen offset:2048 lds
    buffer_load_dwordx4 v70, s[20:23], s3 offen offset:3072 lds
    s_add_u32 m0, s73, 65536
    s_add_u32 s3, s72, 917504
    buffer_load_dwordx4 v67, s[20:23], s3 offen offset:0 lds
    s_waitcnt vmcnt(8)
    v_cmp_ne_u32 vcc, s68, v41
    v_cmp_ne_u32 s[6:7], s69, v43
    s_nop 0
    s_or_b64 vcc, vcc, s[6:7]
    s_waitcnt vmcnt(7)
    v_cmp_ne_u32 s[4:5], s68, v121
    v_cmp_ne_u32 s[6:7], s69, v123
    s_or_b64 vcc, vcc, s[4:5]
    s_or_b64 vcc, vcc, s[6:7]
    s_cbranch_scc1 Lxd_10
Lxk_8:
    buffer_load_dwordx4 v68, s[20:23], s3 offen offset:1024 lds
    v_add_f32 v88, v88, v40
    v_add_f32 v90, v90, v42
    v_add_f32 v160, v160, v120
    v_add_f32 v162, v162, v122
    v_mul_f32 v88, v88, v8
    v_mul_f32 v90, v90, v9
    v_max_f32 v80, v88, v90
    v_mul_f32 v160, v160, v8
    v_mul_f32 v162, v162, v9
    v_max_f32 v152, v160, v162
    s_nop 1
    v_permlane16_swap_b32 v80, v152
    v_max_f32 v80, v80, v152
    v_mov_b32 v152, v80
    s_nop 1
    v_permlane32_swap_b32 v80, v152
    buffer_load_dwordx4 v69, s[20:23], s3 offen offset:2048 lds
    v_max_f32 v80, v80, v152
    v_mov_b32 v152, v80
    s_nop 1
    v_permlane16_swap_b32 v80, v152
    v_sub_f32 v88, v88, v80
    v_sub_f32 v90, v90, v80
    v_sub_f32 v160, v160, v152
    v_sub_f32 v162, v162, v152
    v_exp_f32 v88, v88
    v_exp_f32 v90, v90
    v_exp_f32 v160, v160
    v_exp_f32 v162, v162
    v_add_f32 v80, v88, v90
    v_add_f32 v152, v160, v162
    buffer_load_dwordx4 v70, s[20:23], s3 offen offset:3072 lds
    v_mul_f32 v88, v88, v60
    v_mul_f32 v90, v90, v61
    v_permlane16_swap_b32 v80, v152
    v_add_f32 v80, v80, v152
    v_mov_b32 v152, v80
    v_mul_f32 v160, v160, v60
    v_mul_f32 v162, v162, v61
    v_permlane32_swap_b32 v80, v152
    v_add_f32 v80, v80, v152
    v_mov_b32 v152, v80
    s_nop 1
    v_permlane16_swap_b32 v80, v152
    v_rcp_f32 v80, v80
    v_rcp_f32 v152, v152
    v_mul_f32 v88, v88, v80
    v_mul_f32 v90, v90, v80
    v_cvt_pk_bf16_f32 v88, v88, v88
    v_cvt_pk_bf16_f32 v90, v90, v90
    v_and_b32 v24, v88, v52
    v_and_b32 v25, v90, v53
    v_and_b32 v26, v88, v54
    v_and_b32 v27, v90, v55
    s_nop 1
    v_mfma_f32_16x16x32_bf16 v[212:215], v[76:79], v[24:27], 0
    v_mul_f32 v160, v160, v152
    v_mul_f32 v162, v162, v152
    v_cvt_pk_bf16_f32 v160, v160, v160
    v_cvt_pk_bf16_f32 v162, v162, v162
    v_mfma_f32_16x16x32_bf16 v[208:211], v[100:103], v[24:27], 0
    v_and_b32 v116, v160, v52
    v_and_b32 v117, v162, v53
    v_and_b32 v118, v160, v54
    v_and_b32 v119, v162, v55
    s_waitcnt lgkmcnt(15)
    s_nop 0
    v_mfma_f32_16x16x32_bf16 v[108:111], v[84:87], v[116:119], 0
    v_cvt_pk_bf16_f32 v168, v212, v213
    v_cvt_pk_bf16_f32 v169, v214, v215
    v_cvt_pk_bf16_f32 v170, v208, v209
    v_cvt_pk_bf16_f32 v171, v210, v211
    s_nop 3
    v_cvt_pk_bf16_f32 v174, v108, v109
    v_cvt_pk_bf16_f32 v175, v110, v111
    v_cndmask_b32 v170, v170, v204, s[78:79]
    v_cndmask_b32 v171, v171, v205, s[78:79]
    buffer_store_dwordx4 v[168:171], v3, s[40:43], s48 offen offset:0 sc1
    buffer_store_dwordx4 v[172:175], v3, s[40:43], s48 offen offset:1024 sc1
    s_waitcnt lgkmcnt(0)
    s_barrier
    s_mul_i32 s52, s65, 512
    s_add_u32 s52, s52, 507904
    s_mul_i32 s49, s66, 64
    s_add_u32 s49, s49, s52
    s_mul_i32 s50, s65, 128
    s_mul_i32 s95, s66, 8
    s_add_u32 s50, s50, s95
    s_add_u32 s50, s50, 512000
    s_mul_i32 s45, s67, 11264
    s_add_u32 s45, s45, 114688
    s_mul_i32 s0, s67, 7168
    v_min_u32 v5, 6, v2
    v_lshlrev_b32 v8, 3, v5
    v_mul_u32_u24 v5, 64, v5
    v_add_u32 v9, 1, v2
    v_lshrrev_b32 v9, 2, v9
    v_min_u32 v9, 1, v9
    v_lshlrev_b32 v9, 20, v9
    v_add_lshl_u32 v9, v9, v2, 10
    v_min_u32 v10, 1, v2
    v_lshlrev_b32 v10, 30, v10
    v_bfe_u32 v14, v2, 4, 1
    v_lshlrev_b32 v25, 5, v14
    v_and_b32 v14, 3, v2
    v_lshl_add_u32 v25, v14, 3, v25
    v_bfe_u32 v11, v2, 2, 2
    v_lshrrev_b32 v14, 5, v2
    v_lshl_add_u32 v14, v14, 2, v11
    v_xor_b32 v11, s67, v11
    s_add_u32 m0, s73, 81920
    s_add_u32 s3, s72, 1146880
    buffer_load_dwordx4 v67, s[20:23], s3 offen offset:0 lds
    v_lshl_add_u32 v11, v11, 6, v25
    v_lshl_add_u32 v19, v14, 8, v11
    v_add_u32 v24, 57344, v19
    v_lshl_add_u32 v11, v14, 7, v25
    v_bfe_u32 v14, v2, 3, 1
    v_lshl_add_u32 v11, v14, 6, v11
    v_xor_b32 v14, 64, v11
    v_add_u32 v15, s45, v11
    v_add_u32 v16, s45, v14
    v_add_u32 v17, s0, v11
    v_add_u32 v18, s0, v14
    s_mul_i32 s92, s96, 256
    s_mul_i32 s95, s67, 64
    s_add_u32 s92, s92, s95
    v_and_b32 v11, 31, v2
    buffer_load_dwordx4 v68, s[20:23], s3 offen offset:1024 lds
    v_lshl_add_u32 v26, v11, 1, s92
    s_lshl_b32 s93, s66, 7
    v_and_b32 v14, 0x70, v3
    v_add_u32 v28, s93, v14
    ds_read_b64_tr_b16 a[96:97], v71 offset:24576
    ds_read_b64_tr_b16 a[98:99], v71 offset:26624
    s_lshr_b32 s93, s67, 1
    ds_read_b64_tr_b16 a[100:101], v72 offset:24576
    s_and_b32 s94, s67, 1
    ds_read_b64_tr_b16 a[102:103], v72 offset:26624
    s_mul_i32 s55, s65, 57344
    ds_read_b64_tr_b16 a[104:105], v73 offset:24576
    buffer_load_dwordx4 v69, s[20:23], s3 offen offset:2048 lds
    s_mul_i32 s95, s93, 28672
    ds_read_b64_tr_b16 a[106:107], v73 offset:26624
    s_add_u32 s55, s55, s95
    ds_read_b64_tr_b16 a[108:109], v74 offset:24576
    ds_read_b64_tr_b16 a[110:111], v74 offset:26624
    s_mul_i32 s95, s66, 4096
    ds_read_b64_tr_b16 a[112:113], v71 offset:28672
    s_add_u32 s55, s55, s95
    ds_read_b64_tr_b16 a[114:115], v71 offset:30720
    s_mul_i32 s95, s94, 256
    ds_read_b64_tr_b16 a[116:117], v72 offset:28672
    buffer_load_dwordx4 v70, s[20:23], s3 offen offset:3072 lds
    s_add_u32 s55, s55, s95
    ds_read_b64_tr_b16 a[118:119], v72 offset:30720
    s_add_u32 s55, s55, 262144
    ds_read_b64_tr_b16 a[120:121], v73 offset:28672
    ds_read_b64_tr_b16 a[122:123], v73 offset:30720
    s_mul_i32 s56, s65, 4096
    ds_read_b64_tr_b16 a[124:125], v74 offset:28672
    s_mul_i32 s95, s93, 2048
    ds_read_b64_tr_b16 a[126:127], v74 offset:30720
    s_add_u32 s56, s56, s95
    ds_read_b64_tr_b16 a[128:129], v71 offset:32768
    buffer_load_ushort v26, v26, s[28:31], 0 offen
    s_mul_i32 s95, s66, 256
    ds_read_b64_tr_b16 a[130:131], v71 offset:34816
    s_add_u32 s56, s56, s95
    ds_read_b64_tr_b16 a[132:133], v72 offset:32768
    s_mul_i32 s95, s94, 128
    ds_read_b64_tr_b16 a[134:135], v72 offset:34816
    ds_read_b64_tr_b16 a[136:137], v73 offset:32768
    s_add_u32 s56, s56, s95
    ds_read_b64_tr_b16 a[138:139], v73 offset:34816
    s_add_u32 s56, s56, 491520
    ds_read_b64_tr_b16 a[140:141], v74 offset:32768
    buffer_load_dwordx4 v[28:31], v28, s[32:35], 0 offen
    s_and_b32 s92, s65, 1
    ds_read_b64_tr_b16 a[142:143], v74 offset:34816
    s_xor_b32 s93, s92, 1
    ds_read_b64_tr_b16 a[144:145], v71 offset:36864
    s_mul_i32 s94, s67, 14336
    ds_read_b64_tr_b16 a[146:147], v71 offset:38912
    ds_read_b64_tr_b16 a[148:149], v72 offset:36864
    s_mul_i32 s95, s66, 128
    ds_read_b64_tr_b16 a[150:151], v72 offset:38912
    s_add_u32 s94, s94, s95
    ds_read_b64_tr_b16 a[152:153], v73 offset:36864
    s_mul_i32 s44, s92, 114688
    ds_read_b64_tr_b16 a[154:155], v73 offset:38912
    s_add_u32 s44, s44, s94
    ds_read_b64_tr_b16 a[156:157], v74 offset:36864
    s_mul_i32 s74, s93, 114688
    ds_read_b64_tr_b16 a[158:159], v74 offset:38912
    s_add_u32 s74, s74, s94
    v_lshlrev_b32 v164, 16, v32
    v_and_b32 v165, 0xffff0000, v32
    v_lshlrev_b32 v166, 16, v33
    v_and_b32 v167, 0xffff0000, v33
    v_lshlrev_b32 v176, 16, v34
    v_and_b32 v177, 0xffff0000, v34
    v_lshlrev_b32 v178, 16, v35
    v_and_b32 v179, 0xffff0000, v35
    v_lshlrev_b32 v180, 16, v36
    v_and_b32 v181, 0xffff0000, v36
    v_lshlrev_b32 v182, 16, v37
    v_and_b32 v183, 0xffff0000, v37
    v_lshlrev_b32 v184, 16, v38
    v_and_b32 v185, 0xffff0000, v38
    v_lshlrev_b32 v186, 16, v39
    v_and_b32 v187, 0xffff0000, v39
    v_and_b32 v14, 15, v2
    v_lshlrev_b32 v14, 3, v14
    v_lshrrev_b32 v11, 4, v2
    v_lshlrev_b32 v11, 9, v11
    v_lshl_add_u32 v11, v14, 1, v11
    s_waitcnt vmcnt(6)
    s_barrier
    s_cmp_lg_u32 s67, 0
    s_cbranch_scc1 Lg_11
    buffer_store_dwordx2 v[6:7], v10, s[40:43], s49 offen
Lg_11:
    s_branch Ljoin
Lvar2:
Lst5:
    s_cbranch_execz Lback
    v_mfma_f32_16x16x32_bf16 v[88:91], v[160:163], a[232:235], v[88:91]
    v_mfma_f32_16x16x32_bf16 v[92:95], v[160:163], a[236:239], v[92:95]
    s_waitcnt vmcnt(16)
    s_waitcnt lgkmcnt(0)
    s_barrier
    ds_read_b64_tr_b16 v[152:153], v17 offset:53280
    ds_read_b64_tr_b16 v[154:155], v17 offset:53792
    ds_read_b64_tr_b16 v[156:157], v17 offset:55328
    ds_read_b64_tr_b16 v[158:159], v17 offset:55840
    s_add_u32 m0, s71, 49152
    s_sub_u32 s3, s70, 57344
    v_mfma_f32_16x16x32_bf16 v[96:99], v[164:167], a[220:223], v[96:99]
    s_nop 3
    buffer_load_dwordx4 v64, s[16:19], s3 offen lds
    ds_read_b64_tr_b16 v[160:161], v17 offset:61472
    ds_read_b64_tr_b16 v[162:163], v17 offset:61984
    v_mfma_f32_16x16x32_bf16 v[100:103], v[164:167], a[224:227], v[100:103]
    v_cndmask_b32 v15, v116, v117, s[84:85]
    v_cndmask_b32 v15, v15, v118, s[86:87]
    v_cndmask_b32 v15, v15, v119, s[88:89]
    v_mfma_f32_16x16x32_bf16 v[104:107], v[164:167], a[228:231], v[104:107]
    s_add_u32 m0, s71, 53248
    s_sub_u32 s3, s70, 28672
    v_mul_f32 v14, 0xbb124925, v124
    v_mov_b32_dpp v40, v120 row_newbcast:0 row_mask:0xf bank_mask:0xf
    v_mov_b32_dpp v41, v121 row_newbcast:0 row_mask:0xf bank_mask:0xf
    v_mfma_f32_16x16x32_bf16 v[108:111], v[164:167], a[232:235], v[108:111]
    buffer_load_dwordx4 v64, s[16:19], s3 offen lds
    v_mfma_f32_16x16x32_bf16 v[112:115], v[164:167], a[236:239], v[112:115]
    s_waitcnt lgkmcnt(4)
    v_mov_b32_dpp v42, v122 row_newbcast:0 row_mask:0xf bank_mask:0xf
    v_mov_b32_dpp v43, v123 row_newbcast:0 row_mask:0xf bank_mask:0xf
    v_cndmask_b32 v25, v120, v121, s[84:85]
    v_cndmask_b32 v25, v25, v122, s[86:87]
    v_mfma_f32_16x16x32_bf16 v[76:79], v[152:155], a[240:243], v[76:79]
    ds_read_b64_tr_b16 v[164:165], v17 offset:63520
    ds_read_b64_tr_b16 v[166:167], v17 offset:64032
    v_cndmask_b32 v25, v25, v123, s[88:89]
    v_mfma_f32_16x16x32_bf16 v[80:83], v[152:155], a[244:247], v[80:83]
    s_add_u32 m0, s71, 28672
    s_add_u32 s3, s70, 200704
    v_cndmask_b32 v24, v40, v41, s[84:85]
    v_cndmask_b32 v24, v24, v42, s[86:87]
    v_cndmask_b32 v24, v24, v43, s[88:89]
    v_mfma_f32_16x16x32_bf16 v[84:87], v[152:155], a[248:251], v[84:87]
    buffer_load_dwordx4 v64, s[16:19], s3 offen lds
    v_mfma_f32_16x16x32_bf16 v[88:91], v[152:155], a[252:255], v[88:91]
    v_mul_f32 v24, 0xbb124925, v24
    v_mul_f32 v15, 0x3b124925, v15
    v_fma_f32 v15, -v14, v14, v15
    v_max_f32 v15, 0, v15
    v_mfma_f32_16x16x32_bf16 v[92:95], v[152:155], v[128:131], v[92:95]
    s_waitcnt lgkmcnt(2)
    v_add_f32 v15, 0x3727c5ac, v15
    v_rsq_f32 v15, v15
    v_mfma_f32_16x16x32_bf16 v[76:79], v[160:163], v[132:135], v[76:79]
    s_add_u32 m0, s71, 32768
    s_add_u32 s3, s70, 229376
    v_mul_f32 v25, 0x3b124925, v25
    v_fma_f32 v25, -v24, v24, v25
    v_max_f32 v25, 0, v25
    v_mfma_f32_16x16x32_bf16 v[80:83], v[160:163], v[136:139], v[80:83]
    buffer_load_dwordx4 v64, s[16:19], s3 offen lds
    v_mfma_f32_16x16x32_bf16 v[84:87], v[160:163], v[140:143], v[84:87]
    v_add_f32 v25, 0x3727c5ac, v25
    v_rsq_f32 v25, v25
    v_mfma_f32_16x16x32_bf16 v[88:91], v[160:163], v[144:147], v[88:91]
    ds_write2_b32 v62, v14, v15 offset0:0 offset1:80
    v_mfma_f32_16x16x32_bf16 v[92:95], v[160:163], v[148:151], v[92:95]
    s_add_u32 m0, s71, 36864
    s_add_u32 s3, s70, 258048
    ds_write2_b32 v63, v24, v25 offset0:0 offset1:80
    v_mfma_f32_16x16x32_bf16 v[96:99], v[156:159], a[240:243], v[96:99]
    buffer_load_dwordx4 v64, s[16:19], s3 offen lds
    v_mfma_f32_16x16x32_bf16 v[100:103], v[156:159], a[244:247], v[100:103]
    v_mfma_f32_16x16x32_bf16 v[104:107], v[156:159], a[248:251], v[104:107]
    s_waitcnt vmcnt(13)
    s_waitcnt lgkmcnt(0)
    s_barrier
    ds_read2_b32 v[26:27], v29 offset0:16 offset1:32
    ds_read2_b32 v[176:177], v29 offset0:48 offset1:64
    v_mfma_f32_16x16x32_bf16 v[108:111], v[156:159], a[252:255], v[108:111]
    s_add_u32 m0, s71, 40960
    s_sub_u32 s3, s70, 114688
    ds_read_b32 v5, v29
    ds_read_b32 v9, v30 offset:320
    v_mfma_f32_16x16x32_bf16 v[112:115], v[156:159], v[128:131], v[112:115]
    buffer_load_dwordx4 v64, s[16:19], s3 offen lds
    ds_read_b32 v60, v60
    ds_read_b32 v61, v61
    v_mfma_f32_16x16x32_bf16 v[96:99], v[164:167], v[132:135], v[96:99]
    ds_read_b64_tr_b16 v[200:201], v18 offset:0
    ds_read_b64_tr_b16 v[202:203], v18 offset:512
    v_mfma_f32_16x16x32_bf16 v[100:103], v[164:167], v[136:139], v[100:103]
    ds_read_b64_tr_b16 v[204:205], v18 offset:4096
    ds_read_b64_tr_b16 v[206:207], v18 offset:4608
    s_waitcnt lgkmcnt(9)
    v_fmac_f32_dpp v80, v76, v26 row_newbcast:0 row_mask:0xf bank_mask:0xf
    v_mfma_f32_16x16x32_bf16 v[104:107], v[164:167], v[140:143], v[104:107]
    s_add_u32 m0, s71, 0
    s_add_u32 s3, s70, 0
    ds_read_b64_tr_b16 v[208:209], v18 offset:8192
    ds_read_b64_tr_b16 v[210:211], v18 offset:8704
    v_fmac_f32_dpp v81, v77, v26 row_newbcast:0 row_mask:0xf bank_mask:0xf
    v_fmac_f32_dpp v82, v78, v26 row_newbcast:0 row_mask:0xf bank_mask:0xf
    v_mfma_f32_16x16x32_bf16 v[108:111], v[164:167], v[144:147], v[108:111]
    buffer_load_dwordx4 v64, s[16:19], s3 offen lds
    v_mfma_f32_16x16x32_bf16 v[112:115], v[164:167], v[148:151], v[112:115]
    s_waitcnt lgkmcnt(4)
    v_fmac_f32_dpp v83, v79, v26 row_newbcast:0 row_mask:0xf bank_mask:0xf
    v_cvt_pk_bf16_f32 v80, v80, v81
    v_cvt_pk_bf16_f32 v81, v82, v83
    v_mfma_f32_16x16x32_bf16 v[180:183], a[0:3], v[200:203], 0
    s_add_u32 m0, s71, 4096
    s_add_u32 s3, s70, 28672
    ds_write_b64 v56, v[80:81] offset:0
    ds_read_b64_tr_b16 v[212:213], v18 offset:12288
    ds_read_b64_tr_b16 v[214:215], v18 offset:12800
    v_fmac_f32_dpp v84, v76, v27 row_newbcast:0 row_mask:0xf bank_mask:0xf
    v_mfma_f32_16x16x32_bf16 v[184:187], a[4:7], v[200:203], 0
    buffer_load_dwordx4 v64, s[16:19], s3 offen lds
    v_fmac_f32_dpp v85, v77, v27 row_newbcast:0 row_mask:0xf bank_mask:0xf
    v_mfma_f32_16x16x32_bf16 v[188:191], a[8:11], v[200:203], 0
    v_fmac_f32_dpp v86, v78, v27 row_newbcast:0 row_mask:0xf bank_mask:0xf
    v_fmac_f32_dpp v87, v79, v27 row_newbcast:0 row_mask:0xf bank_mask:0xf
    v_cvt_pk_bf16_f32 v84, v84, v85
    v_mfma_f32_16x16x32_bf16 v[192:195], a[12:15], v[200:203], 0
    v_cvt_pk_bf16_f32 v85, v86, v87
    v_fmac_f32_dpp v88, v76, v176 row_newbcast:0 row_mask:0xf bank_mask:0xf
    v_fmac_f32_dpp v89, v77, v176 row_newbcast:0 row_mask:0xf bank_mask:0xf
    v_mfma_f32_16x16x32_bf16 v[196:199], a[16:19], v[200:203], 0
    s_waitcnt lgkmcnt(5)
    s_add_u32 m0, s71, 8192
    s_add_u32 s3, s70, 57344
    ds_write_b64 v56, v[84:85] offset:2176
    v_fmac_f32_dpp v90, v78, v176 row_newbcast:0 row_mask:0xf bank_mask:0xf
    v_fmac_f32_dpp v91, v79, v176 row_newbcast:0 row_mask:0xf bank_mask:0xf
    v_cvt_pk_bf16_f32 v88, v88, v89
    v_mfma_f32_16x16x32_bf16 v[180:183], a[20:23], v[204:207], v[180:183]
    buffer_load_dwordx4 v64, s[16:19], s3 offen lds
    ds_read_b64_tr_b16 v[200:201], v18 offset:16384
    ds_read_b64_tr_b16 v[202:203], v18 offset:16896
    v_mfma_f32_16x16x32_bf16 v[184:187], a[24:27], v[204:207], v[184:187]
    v_cvt_pk_bf16_f32 v89, v90, v91
    v_fmac_f32_dpp v92, v76, v177 row_newbcast:0 row_mask:0xf bank_mask:0xf
    v_mfma_f32_16x16x32_bf16 v[188:191], a[28:31], v[204:207], v[188:191]
    ds_write_b64 v56, v[88:89] offset:4352
    v_fmac_f32_dpp v93, v77, v177 row_newbcast:0 row_mask:0xf bank_mask:0xf
    v_fmac_f32_dpp v94, v78, v177 row_newbcast:0 row_mask:0xf bank_mask:0xf
    v_fmac_f32_dpp v95, v79, v177 row_newbcast:0 row_mask:0xf bank_mask:0xf
    v_cvt_pk_bf16_f32 v92, v92, v93
    v_mfma_f32_16x16x32_bf16 v[192:195], a[32:35], v[204:207], v[192:195]
    s_add_u32 m0, s71, 12288
    s_add_u32 s3, s70, 86016
    v_cvt_pk_bf16_f32 v93, v94, v95
    v_fmac_f32_dpp v100, v96, v26 row_newbcast:0 row_mask:0xf bank_mask:0xf
    v_mfma_f32_16x16x32_bf16 v[196:199], a[36:39], v[204:207], v[196:199]
    s_waitcnt lgkmcnt(7)
    buffer_load_dwordx4 v64, s[16:19], s3 offen lds
    ds_write_b64 v56, v[92:93] offset:6528
    v_fmac_f32_dpp v101, v97, v26 row_newbcast:0 row_mask:0xf bank_mask:0xf
    v_mfma_f32_16x16x32_bf16 v[180:183], a[40:43], v[208:211], v[180:183]
    ds_read_b64_tr_b16 v[204:205], v18 offset:20480
    ds_read_b64_tr_b16 v[206:207], v18 offset:20992
    v_fmac_f32_dpp v102, v98, v26 row_newbcast:0 row_mask:0xf bank_mask:0xf
    v_mfma_f32_16x16x32_bf16 v[184:187], a[44:47], v[208:211], v[184:187]
    v_fmac_f32_dpp v103, v99, v26 row_newbcast:0 row_mask:0xf bank_mask:0xf
    v_cvt_pk_bf16_f32 v100, v100, v101
    v_cvt_pk_bf16_f32 v101, v102, v103
    v_mfma_f32_16x16x32_bf16 v[188:191], a[48:51], v[208:211], v[188:191]
    s_add_u32 m0, s71, 16384
    s_add_u32 s3, s70, 114688
    ds_write_b64 v56, v[100:101] offset:10880
    v_fmac_f32_dpp v104, v96, v27 row_newbcast:0 row_mask:0xf bank_mask:0xf
    v_fmac_f32_dpp v105, v97, v27 row_newbcast:0 row_mask:0xf bank_mask:0xf
    v_fmac_f32_dpp v106, v98, v27 row_newbcast:0 row_mask:0xf bank_mask:0xf
    v_mfma_f32_16x16x32_bf16 v[192:195], a[52:55], v[208:211], v[192:195]
    buffer_load_dwordx4 v64, s[16:19], s3 offen lds
    v_fmac_f32_dpp v107, v99, v27 row_newbcast:0 row_mask:0xf bank_mask:0xf
    v_mfma_f32_16x16x32_bf16 v[196:199], a[56:59], v[208:211], v[196:199]
    s_waitcnt lgkmcnt(8)
    v_cvt_pk_bf16_f32 v104, v104, v105
    v_cvt_pk_bf16_f32 v105, v106, v107
    v_mfma_f32_16x16x32_bf16 v[180:183], a[60:63], v[212:215], v[180:183]
    ds_write_b64 v56, v[104:105] offset:13056
    ds_read_b64_tr_b16 v[208:209], v18 offset:24576
    ds_read_b64_tr_b16 v[210:211], v18 offset:25088
    v_fmac_f32_dpp v108, v96, v176 row_newbcast:0 row_mask:0xf bank_mask:0xf
    v_fmac_f32_dpp v109, v97, v176 row_newbcast:0 row_mask:0xf bank_mask:0xf
    v_mfma_f32_16x16x32_bf16 v[184:187], a[64:67], v[212:215], v[184:187]
    s_add_u32 m0, s71, 20480
    s_add_u32 s3, s70, 143360
    v_fmac_f32_dpp v110, v98, v176 row_newbcast:0 row_mask:0xf bank_mask:0xf
    v_fmac_f32_dpp v111, v99, v176 row_newbcast:0 row_mask:0xf bank_mask:0xf
    v_cvt_pk_bf16_f32 v108, v108, v109
    v_mfma_f32_16x16x32_bf16 v[188:191], a[68:71], v[212:215], v[188:191]
    buffer_load_dwordx4 v64, s[16:19], s3 offen lds
    v_cvt_pk_bf16_f32 v109, v110, v111
    v_mfma_f32_16x16x32_bf16 v[192:195], a[72:75], v[212:215], v[192:195]
    ds_write_b64 v56, v[108:109] offset:15232
    v_fmac_f32_dpp v112, v96, v177 row_newbcast:0 row_mask:0xf bank_mask:0xf
    v_fmac_f32_dpp v113, v97, v177 row_newbcast:0 row_mask:0xf bank_mask:0xf
    v_mfma_f32_16x16x32_bf16 v[196:199], a[76:79], v[212:215], v[196:199]
    s_waitcnt lgkmcnt(9)
    v_fmac_f32_dpp v114, v98, v177 row_newbcast:0 row_mask:0xf bank_mask:0xf
    v_fmac_f32_dpp v115, v99, v177 row_newbcast:0 row_mask:0xf bank_mask:0xf
    v_cvt_pk_bf16_f32 v112, v112, v113
    v_cvt_pk_bf16_f32 v113, v114, v115
    v_mfma_f32_16x16x32_bf16 v[180:183], a[80:83], v[200:203], v[180:183]
    ds_read_b64_tr_b16 v[212:213], v18 offset:28672
    ds_read_b64_tr_b16 v[214:215], v18 offset:29184
    ds_write_b64 v56, v[112:113] offset:17408
    v_mfma_f32_16x16x32_bf16 v[184:187], a[84:87], v[200:203], v[184:187]
    v_fmac_f32_dpp v96, v96, v5 row_newbcast:0 row_mask:0xf bank_mask:0xf
    v_fmac_f32_dpp v97, v97, v5 row_newbcast:0 row_mask:0xf bank_mask:0xf
    v_fmac_f32_dpp v98, v98, v5 row_newbcast:0 row_mask:0xf bank_mask:0xf
    v_fmac_f32_dpp v99, v99, v5 row_newbcast:0 row_mask:0xf bank_mask:0xf
    v_mfma_f32_16x16x32_bf16 v[188:191], a[88:91], v[200:203], v[188:191]
    v_cvt_pk_bf16_f32 v96, v96, v97
    v_cvt_pk_bf16_f32 v97, v98, v99
    v_mfma_f32_16x16x32_bf16 v[192:195], a[92:95], v[200:203], v[192:195]
    ds_write_b64 v56, v[96:97] offset:8704
    v_mul_f32 v9, 0x3e8b97f6, v9
    v_mul_f32 v8, v9, v60
    v_mul_f32 v9, v9, v61
    v_mfma_f32_16x16x32_bf16 v[196:199], a[96:99], v[200:203], v[196:199]
    s_waitcnt vmcnt(14)
    s_waitcnt lgkmcnt(0)
    s_barrier
    ds_read_b64 v[24:25], v57 offset:0
    ds_read_b64 v[40:41], v57 offset:8704
    ds_read_b64 v[76:77], v57 offset:10880
    ds_read_b64 v[116:117], v57 offset:64
    ds_read_b64 v[118:119], v57 offset:96
    ds_read_b64 v[120:121], v57 offset:8768
    ds_read_b64 v[122:123], v57 offset:8800
    ds_read_b64 v[124:125], v57 offset:10944
    ds_read_b64 v[126:127], v57 offset:10976
    v_mfma_f32_16x16x32_bf16 v[180:183], a[100:103], v[204:207], v[180:183]
    ds_read_b64_tr_b16 v[200:201], v18 offset:32768
    ds_read_b64_tr_b16 v[202:203], v18 offset:33280
    v_mov_b32 v26, 0
    v_mov_b32 v27, 0
    v_mov_b32 v42, 0
    v_mfma_f32_16x16x32_bf16 v[184:187], a[104:107], v[204:207], v[184:187]
    s_add_u32 m0, s73, 0
    s_add_u32 s3, s72, 0
    v_mov_b32 v43, 0
    v_mov_b32 v78, 0
    v_mov_b32 v79, 0
    v_mov_b32 v89, s68
    v_mov_b32 v91, s69
    v_mfma_f32_16x16x32_bf16 v[188:191], a[108:111], v[204:207], v[188:191]
    buffer_load_dwordx4 v67, s[20:23], s3 offen offset:0 lds
    v_mov_b32 v161, s68
    v_mov_b32 v163, s69
    v_mfma_f32_16x16x32_bf16 v[192:195], a[112:115], v[204:207], v[192:195]
    ds_read_b64 v[92:93], v57 offset:24
    s_waitcnt lgkmcnt(11)
    v_cndmask_b32 v24, v24, v4, s[90:91]
    v_cndmask_b32 v25, v25, v4, s[90:91]
    s_waitcnt lgkmcnt(8)
    v_cndmask_b32 v116, v4, v116, s[98:99]
    v_cndmask_b32 v117, v4, v117, s[98:99]
    v_mfma_f32_16x16x32_bf16 v[196:199], a[116:119], v[204:207], v[196:199]
    ds_read_b64 v[94:95], v57 offset:56
    v_mfma_f32_16x16x32_bf16 v[80:83], v[40:43], v[24:27], v[44:47]
    ds_read_b64 v[96:97], v57 offset:8728
    v_mfma_f32_16x16x32_bf16 v[84:87], v[76:79], v[24:27], v[48:51]
    s_waitcnt lgkmcnt(7)
    ds_read_b64 v[98:99], v57 offset:8760
    v_mfma_f32_16x16x32_bf16 v[152:155], v[120:123], v[116:119], v[44:47]
    s_waitcnt lgkmcnt(6)
    ds_read_b64 v[100:101], v57 offset:10904
    v_mfma_f32_16x16x32_bf16 v[156:159], v[124:127], v[116:119], v[48:51]
    buffer_load_dwordx4 v68, s[20:23], s3 offen offset:1024 lds
Lst6:
Lv2_1:
Lv2_2:
    s_cbranch_execz Lback
    ds_read_b64 v[102:103], v57 offset:10936
    v_mfma_f32_16x16x32_bf16 v[180:183], a[120:123], v[208:211], v[180:183]
    ds_read_b64_tr_b16 v[204:205], v18 offset:36864
    ds_read_b64_tr_b16 v[206:207], v18 offset:37376
    v_mfma_f32_16x16x32_bf16 v[184:187], a[124:127], v[208:211], v[184:187]
    v_max3_f32 v88, v80, v81, v84
    v_max3_f32 v90, v82, v83, v86
    v_max_f32 v88, v88, v85
    v_max_f32 v90, v90, v87
    v_mfma_f32_16x16x32_bf16 v[188:191], a[128:131], v[208:211], v[188:191]
    v_max3_f32 v160, v152, v153, v156
    v_max3_f32 v162, v154, v155, v158
    v_max_f32 v160, v160, v157
    v_max_f32 v162, v162, v159
    v_mfma_f32_16x16x32_bf16 v[192:195], a[132:135], v[208:211], v[192:195]
    s_add_u32 s92, s47, 12288
    s_waitcnt lgkmcnt(6)
    v_cndmask_b32 v94, v94, v4, s[90:91]
    v_cndmask_b32 v95, v95, v4, s[90:91]
    v_mfma_f32_16x16x32_bf16 v[196:199], a[136:139], v[208:211], v[196:199]
    s_waitcnt lgkmcnt(4)
    buffer_store_dwordx4 v[88:91], v3, s[40:43], s92 offen sc1
    v_mfma_f32_16x16x32_bf16 v[104:107], v[96:99], v[92:95], v[44:47]
    s_waitcnt lgkmcnt(2)
    buffer_load_dwordx4 v69, s[20:23], s3 offen offset:2048 lds
    s_add_u32 s95, s47, 16384
    buffer_store_dwordx4 v[160:163], v3, s[40:43], s95 offen sc1
    v_mfma_f32_16x16x32_bf16 v[108:111], v[100:103], v[92:95], v[48:51]
    v_mfma_f32_16x16x32_bf16 v[180:183], a[140:143], v[212:215], v[180:183]
    ds_read_b64_tr_b16 v[208:209], v18 offset:40960
    ds_read_b64_tr_b16 v[210:211], v18 offset:41472
    v_mfma_f32_16x16x32_bf16 v[184:187], a[144:147], v[212:215], v[184:187]
    v_mfma_f32_16x16x32_bf16 v[188:191], a[148:151], v[212:215], v[188:191]
    s_nop 2
    v_max3_f32 v112, v104, v105, v108
    v_max3_f32 v114, v106, v107, v110
    v_mfma_f32_16x16x32_bf16 v[192:195], a[152:155], v[212:215], v[192:195]
    v_max_f32 v112, v112, v109
    v_max_f32 v114, v114, v111
    v_mul_f32 v112, v112, v8
    v_mfma_f32_16x16x32_bf16 v[196:199], a[156:159], v[212:215], v[196:199]
    buffer_load_dwordx4 v70, s[20:23], s3 offen offset:3072 lds
    v_mfma_f32_16x16x32_bf16 v[180:183], a[160:163], v[200:203], v[180:183]
    ds_read_b64_tr_b16 v[212:213], v18 offset:45056
    ds_read_b64_tr_b16 v[214:215], v18 offset:45568
    v_mul_f32 v114, v114, v9
    v_mfma_f32_16x16x32_bf16 v[184:187], a[164:167], v[200:203], v[184:187]
    v_max_f32 v104, v112, v114
    v_mov_b32 v105, v104
    v_mfma_f32_16x16x32_bf16 v[188:191], a[168:171], v[200:203], v[188:191]
    s_nop 0
    v_permlane16_swap_b32 v104, v105
    v_max_f32 v104, v104, v105
    v_mov_b32 v105, v104
    v_mfma_f32_16x16x32_bf16 v[192:195], a[172:175], v[200:203], v[192:195]
    s_nop 0
    v_permlane32_swap_b32 v104, v105
    v_max_f32 v104, v104, v105
    v_mfma_f32_16x16x32_bf16 v[196:199], a[176:179], v[200:203], v[196:199]
    s_waitcnt lgkmcnt(4)
    s_add_u32 m0, s73, 16384
    s_add_u32 s3, s72, 229376
    v_sub_f32 v112, v112, v104
    v_sub_f32 v114, v114, v104
    v_mfma_f32_16x16x32_bf16 v[180:183], a[180:183], v[204:207], v[180:183]
    buffer_load_dwordx4 v67, s[20:23], s3 offen offset:0 lds
    ds_read_b64_tr_b16 v[200:201], v18 offset:49152
    ds_read_b64_tr_b16 v[202:203], v18 offset:49664
    v_mfma_f32_16x16x32_bf16 v[184:187], a[184:187], v[204:207], v[184:187]
    v_exp_f32 v112, v112
    v_mfma_f32_16x16x32_bf16 v[188:191], a[188:191], v[204:207], v[188:191]
    v_exp_f32 v114, v114
    s_nop 0
    v_add_f32 v104, v112, v114
    v_mfma_f32_16x16x32_bf16 v[192:195], a[192:195], v[204:207], v[192:195]
    v_mov_b32 v105, v104
    v_mul_f32 v112, v112, v60
    v_mfma_f32_16x16x32_bf16 v[196:199], a[196:199], v[204:207], v[196:199]
    s_waitcnt lgkmcnt(4)
    v_mul_f32 v114, v114, v61
    v_permlane16_swap_b32 v104, v105
    v_add_f32 v104, v104, v105
    v_mfma_f32_16x16x32_bf16 v[180:183], a[200:203], v[208:211], v[180:183]
    ds_read_b64_tr_b16 v[204:205], v18 offset:53248
    ds_read_b64_tr_b16 v[206:207], v18 offset:53760
    v_mfma_f32_16x16x32_bf16 v[184:187], a[204:207], v[208:211], v[184:187]
    buffer_load_dwordx4 v68, s[20:23], s3 offen offset:1024 lds
    v_mov_b32 v105, v104
    v_mfma_f32_16x16x32_bf16 v[188:191], a[208:211], v[208:211], v[188:191]
    s_nop 0
    v_permlane32_swap_b32 v104, v105
    v_add_f32 v104, v104, v105
    v_mfma_f32_16x16x32_bf16 v[192:195], a[212:215], v[208:211], v[192:195]
    v_rcp_f32 v104, v104
    s_nop 0
    v_mul_f32 v112, v112, v104
    v_mfma_f32_16x16x32_bf16 v[196:199], a[216:219], v[208:211], v[196:199]
    s_waitcnt lgkmcnt(4)
    ds_read_b128 v[76:79], v31 offset:0
    v_mul_f32 v114, v114, v104
    v_mfma_f32_16x16x32_bf16 v[180:183], a[220:223], v[212:215], v[180:183]
    s_waitcnt lgkmcnt(3)
    ds_read_b128 v[100:103], v31 offset:64
    v_cvt_pk_bf16_f32 v112, v112, v112
    v_cvt_pk_bf16_f32 v114, v114, v114
    v_mfma_f32_16x16x32_bf16 v[180:183], a[240:243], v[200:203], v[180:183]
    s_waitcnt lgkmcnt(2)
    ds_read_b128 v[124:127], v31 offset:128
    v_and_b32 v92, v112, v52
    v_mfma_f32_16x16x32_bf16 v[180:183], v[132:135], v[204:207], v[180:183]
    buffer_load_dwordx4 v69, s[20:23], s3 offen offset:2048 lds
    ds_read_b128 v[84:87], v31 offset:192
    v_mfma_f32_16x16x32_bf16 v[184:187], a[224:227], v[212:215], v[184:187]
    ds_read_b128 v[108:111], v31 offset:256
    v_and_b32 v93, v114, v53
    v_mfma_f32_16x16x32_bf16 v[184:187], a[244:247], v[200:203], v[184:187]
    v_and_b32 v94, v112, v54
    v_and_b32 v95, v114, v55
    v_mfma_f32_16x16x32_bf16 v[184:187], v[136:139], v[204:207], v[184:187]
    v_mfma_f32_16x16x32_bf16 v[188:191], a[228:231], v[212:215], v[188:191]
    v_mov_b32 v14, v180
    v_mov_b32 v15, v180
    v_mfma_f32_16x16x32_bf16 v[188:191], a[248:251], v[200:203], v[188:191]
    s_nop 0
    v_permlane16_swap_b32 v14, v15
    v_mov_b32 v15, v14
    s_nop 1
    v_permlane32_swap_b32 v14, v15
    v_mfma_f32_16x16x32_bf16 v[188:191], v[140:143], v[204:207], v[188:191]
    buffer_load_dwordx4 v70, s[20:23], s3 offen offset:3072 lds
    v_mfma_f32_16x16x32_bf16 v[192:195], a[232:235], v[212:215], v[192:195]
    s_waitcnt lgkmcnt(4)
    v_fmac_f32 v180, v76, v14
    v_fmac_f32 v181, v77, v14
    v_fmac_f32 v182, v78, v14
    v_mfma_f32_16x16x32_bf16 v[192:195], a[252:255], v[200:203], v[192:195]
    v_fmac_f32 v183, v79, v14
    v_cvt_pk_bf16_f32 v180, v180, v181
    v_mfma_f32_16x16x32_bf16 v[192:195], v[144:147], v[204:207], v[192:195]
    v_cvt_pk_bf16_f32 v181, v182, v183
    s_waitcnt lgkmcnt(3)
    v_fmac_f32 v184, v100, v14
    v_mfma_f32_16x16x32_bf16 v[196:199], a[236:239], v[212:215], v[196:199]
    ds_write_b64 v58, v[180:181] offset:0
    v_fmac_f32 v185, v101, v14
    v_fmac_f32 v186, v102, v14
    v_mfma_f32_16x16x32_bf16 v[196:199], v[128:131], v[200:203], v[196:199]
    v_fmac_f32 v187, v103, v14
    v_cvt_pk_bf16_f32 v184, v184, v185
    v_cvt_pk_bf16_f32 v185, v186, v187
    v_mfma_f32_16x16x32_bf16 v[196:199], v[148:151], v[204:207], v[196:199]
    ds_write_b64 v58, v[184:185] offset:512
    s_waitcnt lgkmcnt(4)
    v_fmac_f32 v188, v124, v14
    v_fmac_f32 v189, v125, v14
    v_fmac_f32 v190, v126, v14
    v_fmac_f32 v191, v127, v14
    v_cvt_pk_bf16_f32 v188, v188, v189
    v_cvt_pk_bf16_f32 v189, v190, v191
    ds_write_b64 v58, v[188:189] offset:1024
    s_waitcnt lgkmcnt(4)
    v_pk_fma_f32 v[192:193], v[84:85], v[14:15], v[192:193] op_sel_hi:[1,0,1]
    v_pk_fma_f32 v[194:195], v[86:87], v[14:15], v[194:195] op_sel_hi:[1,0,1]
    v_cvt_pk_bf16_f32 v192, v192, v193
    v_cvt_pk_bf16_f32 v193, v194, v195
    ds_write_b64 v58, v[192:193] offset:1536
    s_waitcnt lgkmcnt(4)
    v_pk_fma_f32 v[196:197], v[108:109], v[14:15], v[196:197] op_sel_hi:[1,0,1]
    v_pk_fma_f32 v[198:199], v[110:111], v[14:15], v[198:199] op_sel_hi:[1,0,1]
    v_cvt_pk_bf16_f32 v196, v196, v197
    v_cvt_pk_bf16_f32 v197, v198, v199
    ds_write_b64 v58, v[196:197] offset:2048
    s_waitcnt vmcnt(10)
    s_waitcnt lgkmcnt(0)
    s_barrier
    s_add_u32 m0, s73, 32768
    s_add_u32 s3, s72, 458752
    buffer_load_dwordx4 v67, s[20:23], s3 offen offset:0 lds
    ds_read_b64 v[76:77], v59 offset:0
    ds_read_b64 v[78:79], v59 offset:512
    ds_read_b64 v[100:101], v59 offset:2560
    ds_read_b64 v[102:103], v59 offset:3072
    ds_read_b64 v[124:125], v59 offset:5120
    ds_read_b64 v[126:127], v59 offset:5632
    ds_read_b64 v[84:85], v59 offset:7680
    buffer_load_dwordx4 v68, s[20:23], s3 offen offset:1024 lds
    ds_read_b64 v[86:87], v59 offset:8192
    s_waitcnt vmcnt(7)
    s_add_u32 s93, s47, 8192
    buffer_load_dwordx4 v[40:43], v3, s[40:43], s93 offen sc1
    s_add_u32 s94, s47, 20480
    buffer_load_dwordx4 v[120:123], v3, s[40:43], s94 offen sc1
    s_waitcnt lgkmcnt(6)
    v_mfma_f32_16x16x32_bf16 v[208:211], v[76:79], v[92:95], 0
    s_waitcnt lgkmcnt(4)
    ds_read_b64_tr_b16 a[0:1], v71 offset:0
    ds_read_b64_tr_b16 a[2:3], v71 offset:2048
    v_mfma_f32_16x16x32_bf16 v[204:207], v[100:103], v[92:95], 0
    s_waitcnt lgkmcnt(4)
    ds_read_b64_tr_b16 a[4:5], v72 offset:0
    ds_read_b64_tr_b16 a[6:7], v72 offset:2048
    v_mfma_f32_16x16x32_bf16 v[200:203], v[124:127], v[92:95], 0
    ds_read_b64_tr_b16 a[8:9], v73 offset:0
    ds_read_b64_tr_b16 a[10:11], v73 offset:2048
    ds_read_b64_tr_b16 a[12:13], v74 offset:0
    ds_read_b64_tr_b16 a[14:15], v74 offset:2048
    ds_read_b64_tr_b16 a[16:17], v71 offset:4096
    ds_read_b64_tr_b16 a[18:19], v71 offset:6144
    ds_read_b64_tr_b16 a[20:21], v72 offset:4096
    ds_read_b64_tr_b16 a[22:23], v72 offset:6144
    ds_read_b64_tr_b16 a[24:25], v73 offset:4096
    ds_read_b64_tr_b16 a[26:27], v73 offset:6144
    ds_read_b64_tr_b16 a[28:29], v74 offset:4096
    ds_read_b64_tr_b16 a[30:31], v74 offset:6144
    buffer_load_dwordx4 v69, s[20:23], s3 offen offset:2048 lds
    ds_read_b64_tr_b16 a[32:33], v71 offset:8192
    ds_read_b64_tr_b16 a[34:35], v71 offset:10240
    ds_read_b64_tr_b16 a[36:37], v72 offset:8192
    ds_read_b64_tr_b16 a[38:39], v72 offset:10240
    ds_read_b64_tr_b16 a[40:41], v73 offset:8192
    ds_read_b64_tr_b16 a[42:43], v73 offset:10240
    ds_read_b64_tr_b16 a[44:45], v74 offset:8192
    ds_read_b64_tr_b16 a[46:47], v74 offset:10240
    buffer_load_dwordx4 v70, s[20:23], s3 offen offset:3072 lds
    ds_read_b64_tr_b16 a[48:49], v71 offset:12288
    ds_read_b64_tr_b16 a[50:51], v71 offset:14336
    ds_read_b64_tr_b16 a[52:53], v72 offset:12288
    ds_read_b64_tr_b16 a[54:55], v72 offset:14336
    ds_read_b64_tr_b16 a[56:57], v73 offset:12288
    ds_read_b64_tr_b16 a[58:59], v73 offset:14336
    ds_read_b64_tr_b16 a[60:61], v74 offset:12288
    ds_read_b64_tr_b16 a[62:63], v74 offset:14336
    ds_read_b64_tr_b16 a[64:65], v71 offset:16384
    s_add_u32 m0, s73, 49152
    s_add_u32 s3, s72, 688128
    buffer_load_dwordx4 v67, s[20:23], s3 offen offset:0 lds
    ds_read_b64_tr_b16 a[66:67], v71 offset:18432
    ds_read_b64_tr_b16 a[68:69], v72 offset:16384
    ds_read_b64_tr_b16 a[70:71], v72 offset:18432
    ds_read_b64_tr_b16 a[72:73], v73 offset:16384
    ds_read_b64_tr_b16 a[74:75], v73 offset:18432
    ds_read_b64_tr_b16 a[76:77], v74 offset:16384
    ds_read_b64_tr_b16 a[78:79], v74 offset:18432
    buffer_load_dwordx4 v68, s[20:23], s3 offen offset:1024 lds
    ds_read_b64_tr_b16 a[80:81], v71 offset:20480
    ds_read_b64_tr_b16 a[82:83], v71 offset:22528
    ds_read_b64_tr_b16 a[84:85], v72 offset:20480
    ds_read_b64_tr_b16 a[86:87], v72 offset:22528
    ds_read_b64_tr_b16 a[88:89], v73 offset:20480
    ds_read_b64_tr_b16 a[90:91], v73 offset:22528
    ds_read_b64_tr_b16 a[92:93], v74 offset:20480
    ds_read_b64_tr_b16 a[94:95], v74 offset:22528
    v_cvt_pk_bf16_f32 v208, v208, v209
    buffer_load_dwordx4 v69, s[20:23], s3 offen offset:2048 lds
    v_cvt_pk_bf16_f32 v209, v210, v211
    v_cvt_pk_bf16_f32 v170, v204, v205
    v_cvt_pk_bf16_f32 v171, v206, v207
    v_cvt_pk_bf16_f32 v172, v200, v201
    v_cvt_pk_bf16_f32 v173, v202, v203
    buffer_load_dwordx4 v70, s[20:23], s3 offen offset:3072 lds
    s_add_u32 m0, s73, 65536
    s_add_u32 s3, s72, 917504
    buffer_load_dwordx4 v67, s[20:23], s3 offen offset:0 lds
    buffer_load_dwordx4 v68, s[20:23], s3 offen offset:1024 lds
    s_waitcnt vmcnt(9)
    v_cmp_ne_u32 vcc, s68, v41
    v_cmp_ne_u32 s[6:7], s69, v43
    s_nop 0
    s_or_b64 vcc, vcc, s[6:7]
    s_waitcnt vmcnt(8)
    v_cmp_ne_u32 s[4:5], s68, v121
    v_cmp_ne_u32 s[6:7], s69, v123
    s_or_b64 vcc, vcc, s[4:5]
    s_or_b64 vcc, vcc, s[6:7]
    s_cbranch_scc1 Lxd_14
Lxk_12:
    buffer_load_dwordx4 v69, s[20:23], s3 offen offset:2048 lds
    v_add_f32 v88, v88, v40
    v_add_f32 v90, v90, v42
    v_add_f32 v160, v160, v120
    v_add_f32 v162, v162, v122
    v_mul_f32 v88, v88, v8
    v_mul_f32 v90, v90, v9
    v_max_f32 v80, v88, v90
    v_mul_f32 v160, v160, v8
    v_mul_f32 v162, v162, v9
    v_max_f32 v152, v160, v162
    s_nop 1
    v_permlane16_swap_b32 v80, v152
    v_max_f32 v80, v80, v152
    v_mov_b32 v152, v80
    s_nop 1
    v_permlane32_swap_b32 v80, v152
    buffer_load_dwordx4 v70, s[20:23], s3 offen offset:3072 lds
    v_max_f32 v80, v80, v152
    v_mov_b32 v152, v80
    s_nop 1
    v_permlane16_swap_b32 v80, v152
    v_sub_f32 v88, v88, v80
    v_sub_f32 v90, v90, v80
    v_sub_f32 v160, v160, v152
    v_sub_f32 v162, v162, v152
    v_exp_f32 v88, v88
    v_exp_f32 v90, v90
    v_exp_f32 v160, v160
    v_exp_f32 v162, v162
    v_add_f32 v80, v88, v90
    v_add_f32 v152, v160, v162
    v_mul_f32 v88, v88, v60
    v_mul_f32 v90, v90, v61
    v_permlane16_swap_b32 v80, v152
    v_add_f32 v80, v80, v152
    v_mov_b32 v152, v80
    v_mul_f32 v160, v160, v60
    v_mul_f32 v162, v162, v61
    v_permlane32_swap_b32 v80, v152
    v_add_f32 v80, v80, v152
    v_mov_b32 v152, v80
    s_nop 1
    v_permlane16_swap_b32 v80, v152
    v_rcp_f32 v80, v80
    v_rcp_f32 v152, v152
    v_mul_f32 v88, v88, v80
    v_mul_f32 v90, v90, v80
    v_cvt_pk_bf16_f32 v88, v88, v88
    v_cvt_pk_bf16_f32 v90, v90, v90
    v_and_b32 v24, v88, v52
    v_and_b32 v25, v90, v53
    v_and_b32 v26, v88, v54
    v_and_b32 v27, v90, v55
    s_nop 1
    v_mfma_f32_16x16x32_bf16 v[212:215], v[76:79], v[24:27], 0
    v_mul_f32 v160, v160, v152
    v_mul_f32 v162, v162, v152
    v_cvt_pk_bf16_f32 v160, v160, v160
    v_cvt_pk_bf16_f32 v162, v162, v162
    v_and_b32 v116, v160, v52
    v_and_b32 v117, v162, v53
    v_and_b32 v118, v160, v54
    v_and_b32 v119, v162, v55
    s_nop 1
    v_mfma_f32_16x16x32_bf16 v[108:111], v[124:127], v[116:119], 0
    s_waitcnt lgkmcnt(15)
    v_mfma_f32_16x16x32_bf16 v[216:219], v[84:87], v[116:119], 0
    v_cvt_pk_bf16_f32 v168, v212, v213
    v_cvt_pk_bf16_f32 v169, v214, v215
    s_nop 3
    v_cvt_pk_bf16_f32 v108, v108, v109
    v_cvt_pk_bf16_f32 v109, v110, v111
    v_cvt_pk_bf16_f32 v174, v216, v217
    v_cvt_pk_bf16_f32 v175, v218, v219
    v_cndmask_b32 v168, v168, v208, s[90:91]
    v_cndmask_b32 v169, v169, v209, s[90:91]
    v_cndmask_b32 v172, v172, v108, s[98:99]
    v_cndmask_b32 v173, v173, v109, s[98:99]
    buffer_store_dwordx4 v[168:171], v3, s[40:43], s48 offen offset:0 sc1
    buffer_store_dwordx4 v[172:175], v3, s[40:43], s48 offen offset:1024 sc1
    s_waitcnt lgkmcnt(0)
    s_barrier
    s_mul_i32 s52, s65, 512
    s_add_u32 s52, s52, 507904
    s_mul_i32 s49, s66, 64
    s_add_u32 s49, s49, s52
    s_mul_i32 s50, s65, 128
    s_mul_i32 s95, s66, 8
    s_add_u32 s50, s50, s95
    s_add_u32 s50, s50, 512000
    s_mul_i32 s45, s67, 11264
    s_add_u32 s45, s45, 114688
    s_mul_i32 s0, s67, 7168
    v_min_u32 v5, 6, v2
    v_lshlrev_b32 v8, 3, v5
    v_mul_u32_u24 v5, 64, v5
    v_add_u32 v9, 1, v2
    v_lshrrev_b32 v9, 2, v9
    v_min_u32 v9, 1, v9
    v_lshlrev_b32 v9, 20, v9
    v_add_lshl_u32 v9, v9, v2, 10
    v_min_u32 v10, 1, v2
    v_lshlrev_b32 v10, 30, v10
    v_bfe_u32 v14, v2, 4, 1
    v_lshlrev_b32 v25, 5, v14
    v_and_b32 v14, 3, v2
    v_lshl_add_u32 v25, v14, 3, v25
    v_bfe_u32 v11, v2, 2, 2
    v_lshrrev_b32 v14, 5, v2
    v_lshl_add_u32 v14, v14, 2, v11
    v_xor_b32 v11, s67, v11
    s_add_u32 m0, s73, 81920
    s_add_u32 s3, s72, 1146880
    buffer_load_dwordx4 v67, s[20:23], s3 offen offset:0 lds
    v_lshl_add_u32 v11, v11, 6, v25
    v_lshl_add_u32 v19, v14, 8, v11
    v_add_u32 v24, 57344, v19
    v_lshl_add_u32 v11, v14, 7, v25
    v_bfe_u32 v14, v2, 3, 1
    v_lshl_add_u32 v11, v14, 6, v11
    v_xor_b32 v14, 64, v11
    v_add_u32 v15, s45, v11
    v_add_u32 v16, s45, v14
    v_add_u32 v17, s0, v11
    v_add_u32 v18, s0, v14
    s_mul_i32 s92, s96, 256
    s_mul_i32 s95, s67, 64
    s_add_u32 s92, s92, s95
    v_and_b32 v11, 31, v2
    buffer_load_dwordx4 v68, s[20:23], s3 offen offset:1024 lds
    v_lshl_add_u32 v26, v11, 1, s92
    s_lshl_b32 s93, s66, 7
    v_and_b32 v14, 0x70, v3
    v_add_u32 v28, s93, v14
    ds_read_b64_tr_b16 a[96:97], v71 offset:24576
    ds_read_b64_tr_b16 a[98:99], v71 offset:26624
    s_lshr_b32 s93, s67, 1
    ds_read_b64_tr_b16 a[100:101], v72 offset:24576
    s_and_b32 s94, s67, 1
    ds_read_b64_tr_b16 a[102:103], v72 offset:26624
    s_mul_i32 s55, s65, 57344
    ds_read_b64_tr_b16 a[104:105], v73 offset:24576
    buffer_load_dwordx4 v69, s[20:23], s3 offen offset:2048 lds
    s_mul_i32 s95, s93, 28672
    ds_read_b64_tr_b16 a[106:107], v73 offset:26624
    s_add_u32 s55, s55, s95
    ds_read_b64_tr_b16 a[108:109], v74 offset:24576
    ds_read_b64_tr_b16 a[110:111], v74 offset:26624
    s_mul_i32 s95, s66, 4096
    ds_read_b64_tr_b16 a[112:113], v71 offset:28672
    s_add_u32 s55, s55, s95
    ds_read_b64_tr_b16 a[114:115], v71 offset:30720
    s_mul_i32 s95, s94, 256
    ds_read_b64_tr_b16 a[116:117], v72 offset:28672
    buffer_load_dwordx4 v70, s[20:23], s3 offen offset:3072 lds
    s_add_u32 s55, s55, s95
    ds_read_b64_tr_b16 a[118:119], v72 offset:30720
    s_add_u32 s55, s55, 262144
    ds_read_b64_tr_b16 a[120:121], v73 offset:28672
    ds_read_b64_tr_b16 a[122:123], v73 offset:30720
    s_mul_i32 s56, s65, 4096
    ds_read_b64_tr_b16 a[124:125], v74 offset:28672
    s_mul_i32 s95, s93, 2048
    ds_read_b64_tr_b16 a[126:127], v74 offset:30720
    s_add_u32 s56, s56, s95
    ds_read_b64_tr_b16 a[128:129], v71 offset:32768
    buffer_load_ushort v26, v26, s[28:31], 0 offen
    s_mul_i32 s95, s66, 256
    ds_read_b64_tr_b16 a[130:131], v71 offset:34816
    s_add_u32 s56, s56, s95
    ds_read_b64_tr_b16 a[132:133], v72 offset:32768
    s_mul_i32 s95, s94, 128
    ds_read_b64_tr_b16 a[134:135], v72 offset:34816
    ds_read_b64_tr_b16 a[136:137], v73 offset:32768
    s_add_u32 s56, s56, s95
    ds_read_b64_tr_b16 a[138:139], v73 offset:34816
    s_add_u32 s56, s56, 491520
    ds_read_b64_tr_b16 a[140:141], v74 offset:32768
    buffer_load_dwordx4 v[28:31], v28, s[32:35], 0 offen
    s_and_b32 s92, s65, 1
    ds_read_b64_tr_b16 a[142:143], v74 offset:34816
    s_xor_b32 s93, s92, 1
    ds_read_b64_tr_b16 a[144:145], v71 offset:36864
    s_mul_i32 s94, s67, 14336
    ds_read_b64_tr_b16 a[146:147], v71 offset:38912
    ds_read_b64_tr_b16 a[148:149], v72 offset:36864
    s_mul_i32 s95, s66, 128
    ds_read_b64_tr_b16 a[150:151], v72 offset:38912
    s_add_u32 s94, s94, s95
    ds_read_b64_tr_b16 a[152:153], v73 offset:36864
    s_mul_i32 s44, s92, 114688
    ds_read_b64_tr_b16 a[154:155], v73 offset:38912
    s_add_u32 s44, s44, s94
    ds_read_b64_tr_b16 a[156:157], v74 offset:36864
    s_mul_i32 s74, s93, 114688
    ds_read_b64_tr_b16 a[158:159], v74 offset:38912
    s_add_u32 s74, s74, s94
    v_lshlrev_b32 v164, 16, v32
    v_and_b32 v165, 0xffff0000, v32
    v_lshlrev_b32 v166, 16, v33
    v_and_b32 v167, 0xffff0000, v33
    v_lshlrev_b32 v176, 16, v34
    v_and_b32 v177, 0xffff0000, v34
    v_lshlrev_b32 v178, 16, v35
    v_and_b32 v179, 0xffff0000, v35
    v_lshlrev_b32 v180, 16, v36
    v_and_b32 v181, 0xffff0000, v36
    v_lshlrev_b32 v182, 16, v37
    v_and_b32 v183, 0xffff0000, v37
    v_lshlrev_b32 v184, 16, v38
    v_and_b32 v185, 0xffff0000, v38
    v_lshlrev_b32 v186, 16, v39
    v_and_b32 v187, 0xffff0000, v39
    v_and_b32 v14, 15, v2
    v_lshlrev_b32 v14, 3, v14
    v_lshrrev_b32 v11, 4, v2
    v_lshlrev_b32 v11, 9, v11
    v_lshl_add_u32 v11, v14, 1, v11
    s_waitcnt vmcnt(6)
    s_barrier
    s_cmp_lg_u32 s67, 0
    s_cbranch_scc1 Lg_15
    buffer_store_dwordx2 v[6:7], v10, s[40:43], s49 offen
Lg_15:
    s_branch Ljoin
Lvar3:
Lst7:
    s_cbranch_execz Lback
    v_mfma_f32_16x16x32_bf16 v[92:95], v[160:163], a[236:239], v[92:95]
    s_waitcnt vmcnt(16)
    s_waitcnt lgkmcnt(0)
    s_barrier
    ds_read_b64_tr_b16 v[152:153], v17 offset:53280
    ds_read_b64_tr_b16 v[154:155], v17 offset:53792
    ds_read_b64_tr_b16 v[156:157], v17 offset:55328
    ds_read_b64_tr_b16 v[158:159], v17 offset:55840
    s_add_u32 m0, s71, 49152
    s_sub_u32 s3, s70, 57344
    v_mfma_f32_16x16x32_bf16 v[96:99], v[164:167], a[220:223], v[96:99]
    s_nop 3
    buffer_load_dwordx4 v64, s[16:19], s3 offen lds
    ds_read_b64_tr_b16 v[160:161], v17 offset:61472
    ds_read_b64_tr_b16 v[162:163], v17 offset:61984
    v_mfma_f32_16x16x32_bf16 v[100:103], v[164:167], a[224:227], v[100:103]
    v_cndmask_b32 v15, v116, v117, s[84:85]
    v_cndmask_b32 v15, v15, v118, s[86:87]
    v_cndmask_b32 v15, v15, v119, s[88:89]
    v_mfma_f32_16x16x32_bf16 v[104:107], v[164:167], a[228:231], v[104:107]
    s_add_u32 m0, s71, 53248
    s_sub_u32 s3, s70, 28672
    v_mul_f32 v14, 0xbb124925, v124
    v_mov_b32_dpp v40, v120 row_newbcast:0 row_mask:0xf bank_mask:0xf
    v_mov_b32_dpp v41, v121 row_newbcast:0 row_mask:0xf bank_mask:0xf
    v_mfma_f32_16x16x32_bf16 v[108:111], v[164:167], a[232:235], v[108:111]
    buffer_load_dwordx4 v64, s[16:19], s3 offen lds
    v_mfma_f32_16x16x32_bf16 v[112:115], v[164:167], a[236:239], v[112:115]
    s_waitcnt lgkmcnt(4)
    v_mov_b32_dpp v42, v122 row_newbcast:0 row_mask:0xf bank_mask:0xf
    v_mov_b32_dpp v43, v123 row_newbcast:0 row_mask:0xf bank_mask:0xf
    v_cndmask_b32 v25, v120, v121, s[84:85]
    v_cndmask_b32 v25, v25, v122, s[86:87]
    v_mfma_f32_16x16x32_bf16 v[76:79], v[152:155], a[240:243], v[76:79]
    ds_read_b64_tr_b16 v[164:165], v17 offset:63520
    ds_read_b64_tr_b16 v[166:167], v17 offset:64032
    v_cndmask_b32 v25, v25, v123, s[88:89]
    v_mfma_f32_16x16x32_bf16 v[80:83], v[152:155], a[244:247], v[80:83]
    s_add_u32 m0, s71, 28672
    s_add_u32 s3, s70, 200704
    v_cndmask_b32 v24, v40, v41, s[84:85]
    v_cndmask_b32 v24, v24, v42, s[86:87]
    v_cndmask_b32 v24, v24, v43, s[88:89]
    v_mfma_f32_16x16x32_bf16 v[84:87], v[152:155], a[248:251], v[84:87]
    buffer_load_dwordx4 v64, s[16:19], s3 offen lds
    v_mfma_f32_16x16x32_bf16 v[88:91], v[152:155], a[252:255], v[88:91]
    v_mul_f32 v24, 0xbb124925, v24
    v_mul_f32 v15, 0x3b124925, v15
    v_fma_f32 v15, -v14, v14, v15
    v_max_f32 v15, 0, v15
    v_mfma_f32_16x16x32_bf16 v[92:95], v[152:155], v[128:131], v[92:95]
    s_waitcnt lgkmcnt(2)
    v_add_f32 v15, 0x3727c5ac, v15
    v_rsq_f32 v15, v15
    v_mfma_f32_16x16x32_bf16 v[76:79], v[160:163], v[132:135], v[76:79]
    s_add_u32 m0, s71, 32768
    s_sub_u32 s3, s70, 172032
    v_mul_f32 v25, 0x3b124925, v25
    v_fma_f32 v25, -v24, v24, v25
    v_max_f32 v25, 0, v25
    v_mfma_f32_16x16x32_bf16 v[80:83], v[160:163], v[136:139], v[80:83]
    buffer_load_dwordx4 v64, s[16:19], s3 offen lds
    v_mfma_f32_16x16x32_bf16 v[84:87], v[160:163], v[140:143], v[84:87]
    v_add_f32 v25, 0x3727c5ac, v25
    v_rsq_f32 v25, v25
    v_mfma_f32_16x16x32_bf16 v[88:91], v[160:163], v[144:147], v[88:91]
    ds_write2_b32 v62, v14, v15 offset0:0 offset1:80
    v_mfma_f32_16x16x32_bf16 v[92:95], v[160:163], v[148:151], v[92:95]
    s_add_u32 m0, s71, 36864
    s_sub_u32 s3, s70, 143360
    ds_write2_b32 v63, v24, v25 offset0:0 offset1:80
    v_mfma_f32_16x16x32_bf16 v[96:99], v[156:159], a[240:243], v[96:99]
    buffer_load_dwordx4 v64, s[16:19], s3 offen lds
    v_mfma_f32_16x16x32_bf16 v[100:103], v[156:159], a[244:247], v[100:103]
    v_mfma_f32_16x16x32_bf16 v[104:107], v[156:159], a[248:251], v[104:107]
    s_waitcnt vmcnt(13)
    s_waitcnt lgkmcnt(0)
    s_barrier
    ds_read2_b32 v[26:27], v29 offset0:16 offset1:32
    ds_read2_b32 v[176:177], v29 offset0:48 offset1:64
    v_mfma_f32_16x16x32_bf16 v[108:111], v[156:159], a[252:255], v[108:111]
    s_add_u32 m0, s71, 40960
    s_sub_u32 s3, s70, 114688
    ds_read_b32 v5, v29
    ds_read_b32 v9, v30 offset:320
    v_mfma_f32_16x16x32_bf16 v[112:115], v[156:159], v[128:131], v[112:115]
    buffer_load_dwordx4 v64, s[16:19], s3 offen lds
    ds_read_b32 v60, v60
    ds_read_b32 v61, v61
    v_mfma_f32_16x16x32_bf16 v[96:99], v[164:167], v[132:135], v[96:99]
    ds_read_b64_tr_b16 v[200:201], v18 offset:0
    ds_read_b64_tr_b16 v[202:203], v18 offset:512
    v_mfma_f32_16x16x32_bf16 v[100:103], v[164:167], v[136:139], v[100:103]
    ds_read_b64_tr_b16 v[204:205], v18 offset:4096
    ds_read_b64_tr_b16 v[206:207], v18 offset:4608
    s_waitcnt lgkmcnt(9)
    v_fmac_f32_dpp v80, v76, v26 row_newbcast:0 row_mask:0xf bank_mask:0xf
    v_mfma_f32_16x16x32_bf16 v[104:107], v[164:167], v[140:143], v[104:107]
    s_add_u32 m0, s71, 0
    s_add_u32 s3, s70, 0
    ds_read_b64_tr_b16 v[208:209], v18 offset:8192
    ds_read_b64_tr_b16 v[210:211], v18 offset:8704
    v_fmac_f32_dpp v81, v77, v26 row_newbcast:0 row_mask:0xf bank_mask:0xf
    v_fmac_f32_dpp v82, v78, v26 row_newbcast:0 row_mask:0xf bank_mask:0xf
    v_mfma_f32_16x16x32_bf16 v[108:111], v[164:167], v[144:147], v[108:111]
    buffer_load_dwordx4 v64, s[16:19], s3 offen lds
    v_mfma_f32_16x16x32_bf16 v[112:115], v[164:167], v[148:151], v[112:115]
    s_waitcnt lgkmcnt(4)
    v_fmac_f32_dpp v83, v79, v26 row_newbcast:0 row_mask:0xf bank_mask:0xf
    v_cvt_pk_bf16_f32 v80, v80, v81
    v_cvt_pk_bf16_f32 v81, v82, v83
    v_mfma_f32_16x16x32_bf16 v[180:183], a[0:3], v[200:203], 0
    s_add_u32 m0, s71, 4096
    s_add_u32 s3, s70, 28672
    ds_write_b64 v56, v[80:81] offset:0
    ds_read_b64_tr_b16 v[212:213], v18 offset:12288
    ds_read_b64_tr_b16 v[214:215], v18 offset:12800
    v_fmac_f32_dpp v84, v76, v27 row_newbcast:0 row_mask:0xf bank_mask:0xf
    v_mfma_f32_16x16x32_bf16 v[184:187], a[4:7], v[200:203], 0
    buffer_load_dwordx4 v64, s[16:19], s3 offen lds
    v_fmac_f32_dpp v85, v77, v27 row_newbcast:0 row_mask:0xf bank_mask:0xf
    v_mfma_f32_16x16x32_bf16 v[188:191], a[8:11], v[200:203], 0
    v_fmac_f32_dpp v86, v78, v27 row_newbcast:0 row_mask:0xf bank_mask:0xf
Lst8:
Lv3_1:
    s_cbranch_execz Lback
    v_fmac_f32_dpp v87, v79, v27 row_newbcast:0 row_mask:0xf bank_mask:0xf
    v_cvt_pk_bf16_f32 v84, v84, v85
    v_mfma_f32_16x16x32_bf16 v[192:195], a[12:15], v[200:203], 0
    v_cvt_pk_bf16_f32 v85, v86, v87
    v_fmac_f32_dpp v88, v76, v176 row_newbcast:0 row_mask:0xf bank_mask:0xf
    v_fmac_f32_dpp v89, v77, v176 row_newbcast:0 row_mask:0xf bank_mask:0xf
    v_mfma_f32_16x16x32_bf16 v[196:199], a[16:19], v[200:203], 0
    s_waitcnt lgkmcnt(5)
    s_add_u32 m0, s71, 8192
    s_add_u32 s3, s70, 57344
    ds_write_b64 v56, v[84:85] offset:2176
    v_fmac_f32_dpp v90, v78, v176 row_newbcast:0 row_mask:0xf bank_mask:0xf
    v_fmac_f32_dpp v91, v79, v176 row_newbcast:0 row_mask:0xf bank_mask:0xf
    v_cvt_pk_bf16_f32 v88, v88, v89
    v_mfma_f32_16x16x32_bf16 v[180:183], a[20:23], v[204:207], v[180:183]
    buffer_load_dwordx4 v64, s[16:19], s3 offen lds
    ds_read_b64_tr_b16 v[200:201], v18 offset:16384
    ds_read_b64_tr_b16 v[202:203], v18 offset:16896
    v_mfma_f32_16x16x32_bf16 v[184:187], a[24:27], v[204:207], v[184:187]
    v_cvt_pk_bf16_f32 v89, v90, v91
    v_fmac_f32_dpp v92, v76, v177 row_newbcast:0 row_mask:0xf bank_mask:0xf
    v_mfma_f32_16x16x32_bf16 v[188:191], a[28:31], v[204:207], v[188:191]
    ds_write_b64 v56, v[88:89] offset:4352
    v_fmac_f32_dpp v93, v77, v177 row_newbcast:0 row_mask:0xf bank_mask:0xf
    v_fmac_f32_dpp v94, v78, v177 row_newbcast:0 row_mask:0xf bank_mask:0xf
    v_fmac_f32_dpp v95, v79, v177 row_newbcast:0 row_mask:0xf bank_mask:0xf
    v_cvt_pk_bf16_f32 v92, v92, v93
    v_mfma_f32_16x16x32_bf16 v[192:195], a[32:35], v[204:207], v[192:195]
    s_add_u32 m0, s71, 12288
    s_add_u32 s3, s70, 86016
    v_cvt_pk_bf16_f32 v93, v94, v95
    v_fmac_f32_dpp v100, v96, v26 row_newbcast:0 row_mask:0xf bank_mask:0xf
    v_mfma_f32_16x16x32_bf16 v[196:199], a[36:39], v[204:207], v[196:199]
    s_waitcnt lgkmcnt(7)
    buffer_load_dwordx4 v64, s[16:19], s3 offen lds
    ds_write_b64 v56, v[92:93] offset:6528
    v_fmac_f32_dpp v101, v97, v26 row_newbcast:0 row_mask:0xf bank_mask:0xf
    v_mfma_f32_16x16x32_bf16 v[180:183], a[40:43], v[208:211], v[180:183]
    ds_read_b64_tr_b16 v[204:205], v18 offset:20480
    ds_read_b64_tr_b16 v[206:207], v18 offset:20992
    v_fmac_f32_dpp v102, v98, v26 row_newbcast:0 row_mask:0xf bank_mask:0xf
    v_mfma_f32_16x16x32_bf16 v[184:187], a[44:47], v[208:211], v[184:187]
    v_fmac_f32_dpp v103, v99, v26 row_newbcast:0 row_mask:0xf bank_mask:0xf
    v_cvt_pk_bf16_f32 v100, v100, v101
    v_cvt_pk_bf16_f32 v101, v102, v103
    v_mfma_f32_16x16x32_bf16 v[188:191], a[48:51], v[208:211], v[188:191]
    s_add_u32 m0, s71, 16384
    s_add_u32 s3, s70, 114688
    ds_write_b64 v56, v[100:101] offset:10880
    v_fmac_f32_dpp v104, v96, v27 row_newbcast:0 row_mask:0xf bank_mask:0xf
    v_fmac_f32_dpp v105, v97, v27 row_newbcast:0 row_mask:0xf bank_mask:0xf
    v_fmac_f32_dpp v106, v98, v27 row_newbcast:0 row_mask:0xf bank_mask:0xf
    v_mfma_f32_16x16x32_bf16 v[192:195], a[52:55], v[208:211], v[192:195]
    buffer_load_dwordx4 v64, s[16:19], s3 offen lds
    v_fmac_f32_dpp v107, v99, v27 row_newbcast:0 row_mask:0xf bank_mask:0xf
    v_mfma_f32_16x16x32_bf16 v[196:199], a[56:59], v[208:211], v[196:199]
    s_waitcnt lgkmcnt(8)
    v_cvt_pk_bf16_f32 v104, v104, v105
    v_cvt_pk_bf16_f32 v105, v106, v107
    v_mfma_f32_16x16x32_bf16 v[180:183], a[60:63], v[212:215], v[180:183]
    ds_write_b64 v56, v[104:105] offset:13056
    ds_read_b64_tr_b16 v[208:209], v18 offset:24576
    ds_read_b64_tr_b16 v[210:211], v18 offset:25088
    v_fmac_f32_dpp v108, v96, v176 row_newbcast:0 row_mask:0xf bank_mask:0xf
    v_fmac_f32_dpp v109, v97, v176 row_newbcast:0 row_mask:0xf bank_mask:0xf
    v_mfma_f32_16x16x32_bf16 v[184:187], a[64:67], v[212:215], v[184:187]
    s_add_u32 m0, s71, 20480
    s_add_u32 s3, s70, 143360
    v_fmac_f32_dpp v110, v98, v176 row_newbcast:0 row_mask:0xf bank_mask:0xf
    v_fmac_f32_dpp v111, v99, v176 row_newbcast:0 row_mask:0xf bank_mask:0xf
    v_cvt_pk_bf16_f32 v108, v108, v109
    v_mfma_f32_16x16x32_bf16 v[188:191], a[68:71], v[212:215], v[188:191]
    buffer_load_dwordx4 v64, s[16:19], s3 offen lds
    v_cvt_pk_bf16_f32 v109, v110, v111
    v_mfma_f32_16x16x32_bf16 v[192:195], a[72:75], v[212:215], v[192:195]
    ds_write_b64 v56, v[108:109] offset:15232
    v_fmac_f32_dpp v112, v96, v177 row_newbcast:0 row_mask:0xf bank_mask:0xf
    v_fmac_f32_dpp v113, v97, v177 row_newbcast:0 row_mask:0xf bank_mask:0xf
    v_mfma_f32_16x16x32_bf16 v[196:199], a[76:79], v[212:215], v[196:199]
    s_waitcnt lgkmcnt(9)
    v_fmac_f32_dpp v114, v98, v177 row_newbcast:0 row_mask:0xf bank_mask:0xf
    v_fmac_f32_dpp v115, v99, v177 row_newbcast:0 row_mask:0xf bank_mask:0xf
    v_cvt_pk_bf16_f32 v112, v112, v113
    v_cvt_pk_bf16_f32 v113, v114, v115
    v_mfma_f32_16x16x32_bf16 v[180:183], a[80:83], v[200:203], v[180:183]
    ds_read_b64_tr_b16 v[212:213], v18 offset:28672
    ds_read_b64_tr_b16 v[214:215], v18 offset:29184
    ds_write_b64 v56, v[112:113] offset:17408
    v_mfma_f32_16x16x32_bf16 v[184:187], a[84:87], v[200:203], v[184:187]
    v_fmac_f32_dpp v96, v96, v5 row_newbcast:0 row_mask:0xf bank_mask:0xf
    v_fmac_f32_dpp v97, v97, v5 row_newbcast:0 row_mask:0xf bank_mask:0xf
    v_fmac_f32_dpp v98, v98, v5 row_newbcast:0 row_mask:0xf bank_mask:0xf
    v_fmac_f32_dpp v99, v99, v5 row_newbcast:0 row_mask:0xf bank_mask:0xf
    v_mfma_f32_16x16x32_bf16 v[188:191], a[88:91], v[200:203], v[188:191]
    v_cvt_pk_bf16_f32 v96, v96, v97
    v_cvt_pk_bf16_f32 v97, v98, v99
    v_mfma_f32_16x16x32_bf16 v[192:195], a[92:95], v[200:203], v[192:195]
    ds_write_b64 v56, v[96:97] offset:8704
    v_mul_f32 v9, 0x3e8b97f6, v9
    v_mul_f32 v8, v9, v60
    v_mul_f32 v9, v9, v61
    v_mfma_f32_16x16x32_bf16 v[196:199], a[96:99], v[200:203], v[196:199]
    s_waitcnt vmcnt(14)
    s_waitcnt lgkmcnt(0)
    s_barrier
    ds_read_b64 v[24:25], v57 offset:0
    ds_read_b64 v[40:41], v57 offset:8704
    ds_read_b64 v[76:77], v57 offset:10880
    ds_read_b64 v[166:167], v57 offset:96
    ds_read_b64 v[178:179], v57 offset:8800
    ds_read_b64 v[218:219], v57 offset:10976
    v_mfma_f32_16x16x32_bf16 v[180:183], a[100:103], v[204:207], v[180:183]
    ds_read_b64_tr_b16 v[200:201], v18 offset:32768
    ds_read_b64_tr_b16 v[202:203], v18 offset:33280
    v_mov_b32 v26, 0
    v_mov_b32 v27, 0
    v_mov_b32 v42, 0
    v_mov_b32 v43, 0
    v_mfma_f32_16x16x32_bf16 v[184:187], a[104:107], v[204:207], v[184:187]
    s_add_u32 m0, s73, 0
    s_add_u32 s3, s72, 0
    v_mov_b32 v78, 0
    v_mov_b32 v79, 0
    v_mov_b32 v164, 0
    v_mov_b32 v165, 0
    v_mov_b32 v176, 0
    v_mov_b32 v177, 0
    v_mov_b32 v216, 0
    v_mfma_f32_16x16x32_bf16 v[188:191], a[108:111], v[204:207], v[188:191]
    buffer_load_dwordx4 v67, s[20:23], s3 offen offset:0 lds
    v_mov_b32 v217, 0
    v_mov_b32 v89, s68
    v_mov_b32 v91, s69
    v_mov_b32 v229, s68
    v_mfma_f32_16x16x32_bf16 v[192:195], a[112:115], v[204:207], v[192:195]
    ds_read_b64 v[92:93], v57 offset:8
    ds_read_b64 v[94:95], v57 offset:40
    v_mov_b32 v231, s69
    s_waitcnt lgkmcnt(9)
    v_cndmask_b32 v24, v24, v4, s[78:79]
    v_cndmask_b32 v25, v25, v4, s[78:79]
    s_waitcnt lgkmcnt(6)
    v_cndmask_b32 v166, v4, v166, s[90:91]
    v_cndmask_b32 v167, v4, v167, s[90:91]
    v_mfma_f32_16x16x32_bf16 v[196:199], a[116:119], v[204:207], v[196:199]
    ds_read_b64 v[96:97], v57 offset:8712
    ds_read_b64 v[98:99], v57 offset:8744
    v_mfma_f32_16x16x32_bf16 v[80:83], v[40:43], v[24:27], v[44:47]
    ds_read_b64 v[100:101], v57 offset:10888
    ds_read_b64 v[102:103], v57 offset:10920
    v_mfma_f32_16x16x32_bf16 v[84:87], v[76:79], v[24:27], v[48:51]
    s_waitcnt lgkmcnt(9)
    ds_read_b64 v[116:117], v57 offset:64
    v_mfma_f32_16x16x32_bf16 v[220:223], v[176:179], v[164:167], v[44:47]
    s_waitcnt lgkmcnt(9)
    ds_read_b64 v[118:119], v57 offset:96
    ds_read_b64 v[120:121], v57 offset:8768
    v_mfma_f32_16x16x32_bf16 v[224:227], v[216:219], v[164:167], v[48:51]
    buffer_load_dwordx4 v68, s[20:23], s3 offen offset:1024 lds
    ds_read_b64 v[122:123], v57 offset:8800
    ds_read_b64 v[124:125], v57 offset:10944
    v_mfma_f32_16x16x32_bf16 v[180:183], a[120:123], v[208:211], v[180:183]
    ds_read_b64 v[126:127], v57 offset:10976
    ds_read_b64_tr_b16 v[204:205], v18 offset:36864
    ds_read_b64_tr_b16 v[206:207], v18 offset:37376
    v_mfma_f32_16x16x32_bf16 v[184:187], a[124:127], v[208:211], v[184:187]
    v_max3_f32 v88, v80, v81, v84
    v_max3_f32 v90, v82, v83, v86
    v_max_f32 v88, v88, v85
    v_max_f32 v90, v90, v87
    v_mfma_f32_16x16x32_bf16 v[188:191], a[128:131], v[208:211], v[188:191]
    v_max3_f32 v228, v220, v221, v224
    v_max3_f32 v230, v222, v223, v226
    v_max_f32 v228, v228, v225
    v_max_f32 v230, v230, v227
    v_mfma_f32_16x16x32_bf16 v[192:195], a[132:135], v[208:211], v[192:195]
    s_add_u32 s92, s47, 20480
    s_waitcnt lgkmcnt(12)
    v_cndmask_b32 v94, v94, v4, s[90:91]
    v_cndmask_b32 v95, v95, v4, s[90:91]
    s_waitcnt lgkmcnt(6)
    v_cndmask_b32 v118, v118, v4, s[90:91]
    v_cndmask_b32 v119, v119, v4, s[90:91]
    v_mfma_f32_16x16x32_bf16 v[196:199], a[136:139], v[208:211], v[196:199]
    buffer_store_dwordx4 v[88:91], v3, s[40:43], s92 offen sc1
    v_mfma_f32_16x16x32_bf16 v[104:107], v[96:99], v[92:95], v[44:47]
    buffer_load_dwordx4 v69, s[20:23], s3 offen offset:2048 lds
    s_add_u32 s95, s47, 24576
    buffer_store_dwordx4 v[228:231], v3, s[40:43], s95 offen sc1
    v_mfma_f32_16x16x32_bf16 v[108:111], v[100:103], v[92:95], v[48:51]
    s_waitcnt lgkmcnt(4)
    v_mfma_f32_16x16x32_bf16 v[152:155], v[120:123], v[116:119], v[44:47]
    s_waitcnt lgkmcnt(2)
    v_mfma_f32_16x16x32_bf16 v[156:159], v[124:127], v[116:119], v[48:51]
    v_mfma_f32_16x16x32_bf16 v[180:183], a[140:143], v[212:215], v[180:183]
    ds_read_b64_tr_b16 v[208:209], v18 offset:40960
    ds_read_b64_tr_b16 v[210:211], v18 offset:41472
    v_mfma_f32_16x16x32_bf16 v[184:187], a[144:147], v[212:215], v[184:187]
    v_mfma_f32_16x16x32_bf16 v[188:191], a[148:151], v[212:215], v[188:191]
    v_max3_f32 v112, v104, v105, v108
    v_max3_f32 v114, v106, v107, v110
    v_max_f32 v112, v112, v109
    v_mfma_f32_16x16x32_bf16 v[192:195], a[152:155], v[212:215], v[192:195]
    buffer_load_dwordx4 v70, s[20:23], s3 offen offset:3072 lds
    v_max_f32 v114, v114, v111
    v_mfma_f32_16x16x32_bf16 v[196:199], a[156:159], v[212:215], v[196:199]
    v_max3_f32 v160, v152, v153, v156
    v_max3_f32 v162, v154, v155, v158
    v_max_f32 v160, v160, v157
    v_mfma_f32_16x16x32_bf16 v[180:183], a[160:163], v[200:203], v[180:183]
    ds_read_b64_tr_b16 v[212:213], v18 offset:45056
    ds_read_b64_tr_b16 v[214:215], v18 offset:45568
    v_max_f32 v162, v162, v159
    v_mfma_f32_16x16x32_bf16 v[184:187], a[164:167], v[200:203], v[184:187]
    v_mul_f32 v112, v112, v8
    v_mul_f32 v114, v114, v9
    v_max_f32 v104, v112, v114
    v_mfma_f32_16x16x32_bf16 v[188:191], a[168:171], v[200:203], v[188:191]
    v_mul_f32 v160, v160, v8
    v_mul_f32 v162, v162, v9
    v_max_f32 v152, v160, v162
    v_mfma_f32_16x16x32_bf16 v[192:195], a[172:175], v[200:203], v[192:195]
    s_add_u32 m0, s73, 16384
    s_add_u32 s3, s72, 229376
    v_permlane16_swap_b32 v104, v152
    v_max_f32 v104, v104, v152
    v_mov_b32 v152, v104
    v_mfma_f32_16x16x32_bf16 v[196:199], a[176:179], v[200:203], v[196:199]
    s_waitcnt lgkmcnt(4)
    buffer_load_dwordx4 v67, s[20:23], s3 offen offset:0 lds
    v_mfma_f32_16x16x32_bf16 v[180:183], a[180:183], v[204:207], v[180:183]
    ds_read_b64_tr_b16 v[200:201], v18 offset:49152
    ds_read_b64_tr_b16 v[202:203], v18 offset:49664
    v_permlane32_swap_b32 v104, v152
    v_mfma_f32_16x16x32_bf16 v[184:187], a[184:187], v[204:207], v[184:187]
    v_max_f32 v104, v104, v152
    v_mov_b32 v152, v104
    s_nop 1
    v_permlane16_swap_b32 v104, v152
    v_mfma_f32_16x16x32_bf16 v[188:191], a[188:191], v[204:207], v[188:191]
    v_sub_f32 v112, v112, v104
    v_sub_f32 v114, v114, v104
    v_sub_f32 v160, v160, v152
    v_mfma_f32_16x16x32_bf16 v[192:195], a[192:195], v[204:207], v[192:195]
    v_sub_f32 v162, v162, v152
    v_exp_f32 v112, v112
    v_mfma_f32_16x16x32_bf16 v[196:199], a[196:199], v[204:207], v[196:199]
    s_waitcnt lgkmcnt(4)
    v_exp_f32 v114, v114
    v_mfma_f32_16x16x32_bf16 v[180:183], a[200:203], v[208:211], v[180:183]
    buffer_load_dwordx4 v68, s[20:23], s3 offen offset:1024 lds
    ds_read_b64_tr_b16 v[204:205], v18 offset:53248
    ds_read_b64_tr_b16 v[206:207], v18 offset:53760
    v_mfma_f32_16x16x32_bf16 v[184:187], a[204:207], v[208:211], v[184:187]
    v_exp_f32 v160, v160
    v_mfma_f32_16x16x32_bf16 v[188:191], a[208:211], v[208:211], v[188:191]
    v_exp_f32 v162, v162
    v_add_f32 v104, v112, v114
    v_mfma_f32_16x16x32_bf16 v[192:195], a[212:215], v[208:211], v[192:195]
    v_add_f32 v152, v160, v162
    v_mul_f32 v112, v112, v60
    v_mul_f32 v114, v114, v61
    v_mfma_f32_16x16x32_bf16 v[196:199], a[216:219], v[208:211], v[196:199]
    s_waitcnt lgkmcnt(4)
    ds_read_b128 v[76:79], v31 offset:0
    v_permlane16_swap_b32 v104, v152
    v_add_f32 v104, v104, v152
    v_mfma_f32_16x16x32_bf16 v[180:183], a[220:223], v[212:215], v[180:183]
    s_waitcnt lgkmcnt(3)
    ds_read_b128 v[100:103], v31 offset:64
    v_mov_b32 v152, v104
    v_mul_f32 v160, v160, v60
    v_mfma_f32_16x16x32_bf16 v[180:183], a[240:243], v[200:203], v[180:183]
    s_waitcnt lgkmcnt(2)
    ds_read_b128 v[124:127], v31 offset:128
    v_mul_f32 v162, v162, v61
    v_permlane32_swap_b32 v104, v152
    v_mfma_f32_16x16x32_bf16 v[180:183], v[132:135], v[204:207], v[180:183]
    buffer_load_dwordx4 v69, s[20:23], s3 offen offset:2048 lds
    ds_read_b128 v[216:219], v31 offset:192
    v_mfma_f32_16x16x32_bf16 v[184:187], a[224:227], v[212:215], v[184:187]
    ds_read_b128 v[84:87], v31 offset:256
    v_add_f32 v104, v104, v152
    v_mov_b32 v152, v104
    v_mfma_f32_16x16x32_bf16 v[184:187], a[244:247], v[200:203], v[184:187]
    s_nop 0
    v_permlane16_swap_b32 v104, v152
    v_mfma_f32_16x16x32_bf16 v[184:187], v[136:139], v[204:207], v[184:187]
    v_mfma_f32_16x16x32_bf16 v[188:191], a[228:231], v[212:215], v[188:191]
    v_mov_b32 v14, v180
    v_mov_b32 v15, v180
    v_mfma_f32_16x16x32_bf16 v[188:191], a[248:251], v[200:203], v[188:191]
    s_nop 0
    v_permlane16_swap_b32 v14, v15
    v_mov_b32 v15, v14
    s_nop 1
    v_permlane32_swap_b32 v14, v15
    v_mfma_f32_16x16x32_bf16 v[188:191], v[140:143], v[204:207], v[188:191]
    buffer_load_dwordx4 v70, s[20:23], s3 offen offset:3072 lds
    v_mfma_f32_16x16x32_bf16 v[192:195], a[232:235], v[212:215], v[192:195]
    s_waitcnt lgkmcnt(4)
    v_fmac_f32 v180, v76, v14
    v_fmac_f32 v181, v77, v14
    v_fmac_f32 v182, v78, v14
    v_mfma_f32_16x16x32_bf16 v[192:195], a[252:255], v[200:203], v[192:195]
    v_fmac_f32 v183, v79, v14
    v_cvt_pk_bf16_f32 v180, v180, v181
    v_mfma_f32_16x16x32_bf16 v[192:195], v[144:147], v[204:207], v[192:195]
    v_cvt_pk_bf16_f32 v181, v182, v183
    s_waitcnt lgkmcnt(3)
    v_fmac_f32 v184, v100, v14
    v_mfma_f32_16x16x32_bf16 v[196:199], a[236:239], v[212:215], v[196:199]
    ds_write_b64 v58, v[180:181] offset:0
    v_fmac_f32 v185, v101, v14
    v_fmac_f32 v186, v102, v14
    v_mfma_f32_16x16x32_bf16 v[196:199], v[128:131], v[200:203], v[196:199]
    v_fmac_f32 v187, v103, v14
    v_cvt_pk_bf16_f32 v184, v184, v185
    v_cvt_pk_bf16_f32 v185, v186, v187
    v_mfma_f32_16x16x32_bf16 v[196:199], v[148:151], v[204:207], v[196:199]
    ds_write_b64 v58, v[184:185] offset:512
    s_waitcnt lgkmcnt(4)
    v_fmac_f32 v188, v124, v14
    v_fmac_f32 v189, v125, v14
    v_fmac_f32 v190, v126, v14
    v_fmac_f32 v191, v127, v14
    v_cvt_pk_bf16_f32 v188, v188, v189
    v_cvt_pk_bf16_f32 v189, v190, v191
    ds_write_b64 v58, v[188:189] offset:1024
    s_waitcnt lgkmcnt(4)
    v_pk_fma_f32 v[192:193], v[216:217], v[14:15], v[192:193] op_sel_hi:[1,0,1]
    v_pk_fma_f32 v[194:195], v[218:219], v[14:15], v[194:195] op_sel_hi:[1,0,1]
    v_cvt_pk_bf16_f32 v192, v192, v193
    v_cvt_pk_bf16_f32 v193, v194, v195
    ds_write_b64 v58, v[192:193] offset:1536
    s_waitcnt lgkmcnt(4)
    v_pk_fma_f32 v[196:197], v[84:85], v[14:15], v[196:197] op_sel_hi:[1,0,1]
    v_pk_fma_f32 v[198:199], v[86:87], v[14:15], v[198:199] op_sel_hi:[1,0,1]
    v_cvt_pk_bf16_f32 v196, v196, v197
    v_cvt_pk_bf16_f32 v197, v198, v199
    ds_write_b64 v58, v[196:197] offset:2048
    s_waitcnt vmcnt(10)
    s_waitcnt lgkmcnt(0)
    s_barrier
    s_add_u32 m0, s73, 32768
    s_add_u32 s3, s72, 458752
    buffer_load_dwordx4 v67, s[20:23], s3 offen offset:0 lds
    ds_read_b64 v[76:77], v59 offset:0
    ds_read_b64 v[78:79], v59 offset:512
    ds_read_b64 v[100:101], v59 offset:2560
    ds_read_b64 v[102:103], v59 offset:3072
    ds_read_b64 v[124:125], v59 offset:5120
    ds_read_b64 v[126:127], v59 offset:5632
    ds_read_b64 v[216:217], v59 offset:7680
    buffer_load_dwordx4 v68, s[20:23], s3 offen offset:1024 lds
    ds_read_b64 v[218:219], v59 offset:8192
    v_rcp_f32 v104, v104
    v_rcp_f32 v152, v152
    v_mul_f32 v112, v112, v104
    v_mul_f32 v114, v114, v104
    v_cvt_pk_bf16_f32 v112, v112, v112
    v_cvt_pk_bf16_f32 v114, v114, v114
    v_and_b32 v92, v112, v52
    v_and_b32 v93, v114, v53
    v_and_b32 v94, v112, v54
    v_and_b32 v95, v114, v55
    v_mul_f32 v160, v160, v152
    v_mul_f32 v162, v162, v152
    v_cvt_pk_bf16_f32 v160, v160, v160
    buffer_load_dwordx4 v69, s[20:23], s3 offen offset:2048 lds
    v_cvt_pk_bf16_f32 v162, v162, v162
    v_and_b32 v116, v160, v52
    v_and_b32 v117, v162, v53
    v_and_b32 v118, v160, v54
    v_and_b32 v119, v162, v55
    s_waitcnt vmcnt(8)
    s_add_u32 s93, s47, 16384
    buffer_load_dwordx4 v[40:43], v3, s[40:43], s93 offen sc1
    s_add_u32 s94, s47, 28672
    buffer_load_dwordx4 v[176:179], v3, s[40:43], s94 offen sc1
    s_waitcnt lgkmcnt(6)
    v_mfma_f32_16x16x32_bf16 v[208:211], v[76:79], v[92:95], 0
    s_waitcnt lgkmcnt(4)
    ds_read_b64_tr_b16 a[0:1], v71 offset:0
    ds_read_b64_tr_b16 a[2:3], v71 offset:2048
    v_mfma_f32_16x16x32_bf16 v[204:207], v[100:103], v[92:95], 0
    s_waitcnt lgkmcnt(4)
    ds_read_b64_tr_b16 a[4:5], v72 offset:0
    ds_read_b64_tr_b16 a[6:7], v72 offset:2048
    v_mfma_f32_16x16x32_bf16 v[200:203], v[124:127], v[116:119], 0
    s_waitcnt lgkmcnt(4)
    ds_read_b64_tr_b16 a[8:9], v73 offset:0
    ds_read_b64_tr_b16 a[10:11], v73 offset:2048
    v_mfma_f32_16x16x32_bf16 v[84:87], v[216:219], v[116:119], 0
    ds_read_b64_tr_b16 a[12:13], v74 offset:0
    ds_read_b64_tr_b16 a[14:15], v74 offset:2048
    ds_read_b64_tr_b16 a[16:17], v71 offset:4096
    ds_read_b64_tr_b16 a[18:19], v71 offset:6144
    ds_read_b64_tr_b16 a[20:21], v72 offset:4096
    ds_read_b64_tr_b16 a[22:23], v72 offset:6144
    buffer_load_dwordx4 v70, s[20:23], s3 offen offset:3072 lds
    ds_read_b64_tr_b16 a[24:25], v73 offset:4096
    ds_read_b64_tr_b16 a[26:27], v73 offset:6144
    ds_read_b64_tr_b16 a[28:29], v74 offset:4096
    ds_read_b64_tr_b16 a[30:31], v74 offset:6144
    ds_read_b64_tr_b16 a[32:33], v71 offset:8192
    ds_read_b64_tr_b16 a[34:35], v71 offset:10240
    ds_read_b64_tr_b16 a[36:37], v72 offset:8192
    ds_read_b64_tr_b16 a[38:39], v72 offset:10240
    s_add_u32 m0, s73, 49152
    s_add_u32 s3, s72, 688128
    buffer_load_dwordx4 v67, s[20:23], s3 offen offset:0 lds
    ds_read_b64_tr_b16 a[40:41], v73 offset:8192
    ds_read_b64_tr_b16 a[42:43], v73 offset:10240
    ds_read_b64_tr_b16 a[44:45], v74 offset:8192
    ds_read_b64_tr_b16 a[46:47], v74 offset:10240
    ds_read_b64_tr_b16 a[48:49], v71 offset:12288
    ds_read_b64_tr_b16 a[50:51], v71 offset:14336
    ds_read_b64_tr_b16 a[52:53], v72 offset:12288
    ds_read_b64_tr_b16 a[54:55], v72 offset:14336
    buffer_load_dwordx4 v68, s[20:23], s3 offen offset:1024 lds
    ds_read_b64_tr_b16 a[56:57], v73 offset:12288
    ds_read_b64_tr_b16 a[58:59], v73 offset:14336
    ds_read_b64_tr_b16 a[60:61], v74 offset:12288
    ds_read_b64_tr_b16 a[62:63], v74 offset:14336
    ds_read_b64_tr_b16 a[64:65], v71 offset:16384
    ds_read_b64_tr_b16 a[66:67], v71 offset:18432
    ds_read_b64_tr_b16 a[68:69], v72 offset:16384
    ds_read_b64_tr_b16 a[70:71], v72 offset:18432
    buffer_load_dwordx4 v69, s[20:23], s3 offen offset:2048 lds
    ds_read_b64_tr_b16 a[72:73], v73 offset:16384
    ds_read_b64_tr_b16 a[74:75], v73 offset:18432
    ds_read_b64_tr_b16 a[76:77], v74 offset:16384
    ds_read_b64_tr_b16 a[78:79], v74 offset:18432
    ds_read_b64_tr_b16 a[80:81], v71 offset:20480
    ds_read_b64_tr_b16 a[82:83], v71 offset:22528
    ds_read_b64_tr_b16 a[84:85], v72 offset:20480
    ds_read_b64_tr_b16 a[86:87], v72 offset:22528
    ds_read_b64_tr_b16 a[88:89], v73 offset:20480
    buffer_load_dwordx4 v70, s[20:23], s3 offen offset:3072 lds
    ds_read_b64_tr_b16 a[90:91], v73 offset:22528
    ds_read_b64_tr_b16 a[92:93], v74 offset:20480
    ds_read_b64_tr_b16 a[94:95], v74 offset:22528
    v_cvt_pk_bf16_f32 v208, v208, v209
    v_cvt_pk_bf16_f32 v209, v210, v211
    v_cvt_pk_bf16_f32 v170, v204, v205
    v_cvt_pk_bf16_f32 v171, v206, v207
    v_cvt_pk_bf16_f32 v172, v200, v201
    v_cvt_pk_bf16_f32 v173, v202, v203
    v_cvt_pk_bf16_f32 v174, v84, v85
    v_cvt_pk_bf16_f32 v175, v86, v87
    s_add_u32 m0, s73, 65536
    s_add_u32 s3, s72, 917504
    buffer_load_dwordx4 v67, s[20:23], s3 offen offset:0 lds
    buffer_load_dwordx4 v68, s[20:23], s3 offen offset:1024 lds
    buffer_load_dwordx4 v69, s[20:23], s3 offen offset:2048 lds
    s_waitcnt vmcnt(9)
    v_cmp_ne_u32 vcc, s68, v41
    v_cmp_ne_u32 s[6:7], s69, v43
    s_nop 0
    s_or_b64 vcc, vcc, s[6:7]
    s_waitcnt vmcnt(8)
    v_cmp_ne_u32 s[4:5], s68, v177
    v_cmp_ne_u32 s[6:7], s69, v179
    s_or_b64 vcc, vcc, s[4:5]
    s_or_b64 vcc, vcc, s[6:7]
    s_cbranch_scc1 Lxd_18
Lxk_16:
    buffer_load_dwordx4 v70, s[20:23], s3 offen offset:3072 lds
    v_add_f32 v88, v88, v40
    v_add_f32 v90, v90, v42
    v_add_f32 v228, v228, v176
    v_add_f32 v230, v230, v178
    v_mul_f32 v88, v88, v8
    v_mul_f32 v90, v90, v9
    v_max_f32 v80, v88, v90
    v_mul_f32 v228, v228, v8
    v_mul_f32 v230, v230, v9
    v_max_f32 v220, v228, v230
    s_nop 1
    v_permlane16_swap_b32 v80, v220
    v_max_f32 v80, v80, v220
    v_mov_b32 v220, v80
    s_nop 1
    v_permlane32_swap_b32 v80, v220
    v_max_f32 v80, v80, v220
    v_mov_b32 v220, v80
    s_nop 1
    v_permlane16_swap_b32 v80, v220
    v_sub_f32 v88, v88, v80
    v_sub_f32 v90, v90, v80
    v_sub_f32 v228, v228, v220
    v_sub_f32 v230, v230, v220
    v_exp_f32 v88, v88
    v_exp_f32 v90, v90
    v_exp_f32 v228, v228
    v_exp_f32 v230, v230
    v_add_f32 v80, v88, v90
    v_add_f32 v220, v228, v230
    v_mul_f32 v88, v88, v60
    v_mul_f32 v90, v90, v61
    v_permlane16_swap_b32 v80, v220
    v_add_f32 v80, v80, v220
    v_mov_b32 v220, v80
    v_mul_f32 v228, v228, v60
    v_mul_f32 v230, v230, v61
    v_permlane32_swap_b32 v80, v220
    v_add_f32 v80, v80, v220
    v_mov_b32 v220, v80
    s_nop 1
    v_permlane16_swap_b32 v80, v220
    v_rcp_f32 v80, v80
    v_rcp_f32 v220, v220
    v_mul_f32 v88, v88, v80
    v_mul_f32 v90, v90, v80
    v_cvt_pk_bf16_f32 v88, v88, v88
    v_cvt_pk_bf16_f32 v90, v90, v90
    v_and_b32 v24, v88, v52
    v_and_b32 v25, v90, v53
    v_and_b32 v26, v88, v54
    v_and_b32 v27, v90, v55
    s_nop 1
    v_mfma_f32_16x16x32_bf16 v[212:215], v[76:79], v[24:27], 0
    v_mul_f32 v228, v228, v220
    v_mul_f32 v230, v230, v220
    v_cvt_pk_bf16_f32 v228, v228, v228
    v_cvt_pk_bf16_f32 v230, v230, v230
    v_and_b32 v164, v228, v52
    v_and_b32 v165, v230, v53
    v_and_b32 v166, v228, v54
    v_and_b32 v167, v230, v55
    s_nop 1
    v_mfma_f32_16x16x32_bf16 v[120:123], v[216:219], v[164:167], 0
    v_cvt_pk_bf16_f32 v168, v212, v213
    v_cvt_pk_bf16_f32 v169, v214, v215
    s_nop 5
    v_cvt_pk_bf16_f32 v120, v120, v121
    v_cvt_pk_bf16_f32 v121, v122, v123
    v_cndmask_b32 v168, v168, v208, s[78:79]
    v_cndmask_b32 v169, v169, v209, s[78:79]
    v_cndmask_b32 v174, v174, v120, s[90:91]
    v_cndmask_b32 v175, v175, v121, s[90:91]
    buffer_store_dwordx4 v[168:171], v3, s[40:43], s48 offen offset:0 sc1
    buffer_store_dwordx4 v[172:175], v3, s[40:43], s48 offen offset:1024 sc1
    s_waitcnt lgkmcnt(0)
    s_barrier
    s_mul_i32 s52, s65, 512
    s_add_u32 s52, s52, 507904
    s_mul_i32 s49, s66, 64
    s_add_u32 s49, s49, s52
    s_mul_i32 s50, s65, 128
    s_mul_i32 s95, s66, 8
    s_add_u32 s50, s50, s95
    s_add_u32 s50, s50, 512000
    s_mul_i32 s45, s67, 11264
    s_add_u32 s45, s45, 114688
    s_mul_i32 s0, s67, 7168
    v_min_u32 v5, 6, v2
    v_lshlrev_b32 v8, 3, v5
    v_mul_u32_u24 v5, 64, v5
    v_add_u32 v9, 1, v2
    v_lshrrev_b32 v9, 2, v9
    v_min_u32 v9, 1, v9
    v_lshlrev_b32 v9, 20, v9
    v_add_lshl_u32 v9, v9, v2, 10
    v_min_u32 v10, 1, v2
    v_lshlrev_b32 v10, 30, v10
    v_bfe_u32 v14, v2, 4, 1
    v_lshlrev_b32 v25, 5, v14
    v_and_b32 v14, 3, v2
    v_lshl_add_u32 v25, v14, 3, v25
    v_bfe_u32 v11, v2, 2, 2
    v_lshrrev_b32 v14, 5, v2
    v_lshl_add_u32 v14, v14, 2, v11
    v_xor_b32 v11, s67, v11
    s_add_u32 m0, s73, 81920
    s_add_u32 s3, s72, 1146880
    buffer_load_dwordx4 v67, s[20:23], s3 offen offset:0 lds
    v_lshl_add_u32 v11, v11, 6, v25
    v_lshl_add_u32 v19, v14, 8, v11
    v_add_u32 v24, 57344, v19
    v_lshl_add_u32 v11, v14, 7, v25
    v_bfe_u32 v14, v2, 3, 1
    v_lshl_add_u32 v11, v14, 6, v11
    v_xor_b32 v14, 64, v11
    v_add_u32 v15, s45, v11
    v_add_u32 v16, s45, v14
    v_add_u32 v17, s0, v11
    v_add_u32 v18, s0, v14
    s_mul_i32 s92, s96, 256
    s_mul_i32 s95, s67, 64
    s_add_u32 s92, s92, s95
    v_and_b32 v11, 31, v2
    buffer_load_dwordx4 v68, s[20:23], s3 offen offset:1024 lds
    v_lshl_add_u32 v26, v11, 1, s92
    s_lshl_b32 s93, s66, 7
    v_and_b32 v14, 0x70, v3
    v_add_u32 v28, s93, v14
    ds_read_b64_tr_b16 a[96:97], v71 offset:24576
    ds_read_b64_tr_b16 a[98:99], v71 offset:26624
    s_lshr_b32 s93, s67, 1
    ds_read_b64_tr_b16 a[100:101], v72 offset:24576
    s_and_b32 s94, s67, 1
    ds_read_b64_tr_b16 a[102:103], v72 offset:26624
    s_mul_i32 s55, s65, 57344
    ds_read_b64_tr_b16 a[104:105], v73 offset:24576
    buffer_load_dwordx4 v69, s[20:23], s3 offen offset:2048 lds
    s_mul_i32 s95, s93, 28672
    ds_read_b64_tr_b16 a[106:107], v73 offset:26624
    s_add_u32 s55, s55, s95
    ds_read_b64_tr_b16 a[108:109], v74 offset:24576
    ds_read_b64_tr_b16 a[110:111], v74 offset:26624
    s_mul_i32 s95, s66, 4096
    ds_read_b64_tr_b16 a[112:113], v71 offset:28672
    s_add_u32 s55, s55, s95
    ds_read_b64_tr_b16 a[114:115], v71 offset:30720
    s_mul_i32 s95, s94, 256
    ds_read_b64_tr_b16 a[116:117], v72 offset:28672
    buffer_load_dwordx4 v70, s[20:23], s3 offen offset:3072 lds
    s_add_u32 s55, s55, s95
    ds_read_b64_tr_b16 a[118:119], v72 offset:30720
    s_add_u32 s55, s55, 262144
    ds_read_b64_tr_b16 a[120:121], v73 offset:28672
    ds_read_b64_tr_b16 a[122:123], v73 offset:30720
    s_mul_i32 s56, s65, 4096
    ds_read_b64_tr_b16 a[124:125], v74 offset:28672
    s_mul_i32 s95, s93, 2048
    ds_read_b64_tr_b16 a[126:127], v74 offset:30720
Lst9:
Lv3_2:
    s_cbranch_execz Lback
    s_add_u32 s56, s56, s95
    ds_read_b64_tr_b16 a[128:129], v71 offset:32768
    buffer_load_ushort v26, v26, s[28:31], 0 offen
    s_mul_i32 s95, s66, 256
    ds_read_b64_tr_b16 a[130:131], v71 offset:34816
    s_add_u32 s56, s56, s95
    ds_read_b64_tr_b16 a[132:133], v72 offset:32768
    s_mul_i32 s95, s94, 128
    ds_read_b64_tr_b16 a[134:135], v72 offset:34816
    ds_read_b64_tr_b16 a[136:137], v73 offset:32768
    s_add_u32 s56, s56, s95
    ds_read_b64_tr_b16 a[138:139], v73 offset:34816
    s_add_u32 s56, s56, 491520
    ds_read_b64_tr_b16 a[140:141], v74 offset:32768
    buffer_load_dwordx4 v[28:31], v28, s[32:35], 0 offen
    s_and_b32 s92, s65, 1
    ds_read_b64_tr_b16 a[142:143], v74 offset:34816
    s_xor_b32 s93, s92, 1
    ds_read_b64_tr_b16 a[144:145], v71 offset:36864
    s_mul_i32 s94, s67, 14336
    ds_read_b64_tr_b16 a[146:147], v71 offset:38912
    ds_read_b64_tr_b16 a[148:149], v72 offset:36864
    s_mul_i32 s95, s66, 128
    ds_read_b64_tr_b16 a[150:151], v72 offset:38912
    s_add_u32 s94, s94, s95
    ds_read_b64_tr_b16 a[152:153], v73 offset:36864
    s_mul_i32 s44, s92, 114688
    ds_read_b64_tr_b16 a[154:155], v73 offset:38912
    s_add_u32 s44, s44, s94
    ds_read_b64_tr_b16 a[156:157], v74 offset:36864
    s_mul_i32 s74, s93, 114688
    ds_read_b64_tr_b16 a[158:159], v74 offset:38912
    s_add_u32 s74, s74, s94
    v_lshlrev_b32 v164, 16, v32
    v_and_b32 v165, 0xffff0000, v32
    v_lshlrev_b32 v166, 16, v33
    v_and_b32 v167, 0xffff0000, v33
    v_lshlrev_b32 v176, 16, v34
    v_and_b32 v177, 0xffff0000, v34
    v_lshlrev_b32 v178, 16, v35
    v_and_b32 v179, 0xffff0000, v35
    v_lshlrev_b32 v180, 16, v36
    v_and_b32 v181, 0xffff0000, v36
    v_lshlrev_b32 v182, 16, v37
    v_and_b32 v183, 0xffff0000, v37
    v_lshlrev_b32 v184, 16, v38
    v_and_b32 v185, 0xffff0000, v38
    v_lshlrev_b32 v186, 16, v39
    v_and_b32 v187, 0xffff0000, v39
    v_and_b32 v14, 15, v2
    v_lshlrev_b32 v14, 3, v14
    v_lshrrev_b32 v11, 4, v2
    v_lshlrev_b32 v11, 9, v11
    v_lshl_add_u32 v11, v14, 1, v11
    s_waitcnt vmcnt(6)
    s_barrier
    s_cmp_lg_u32 s67, 0
    s_cbranch_scc1 Lg_19
    buffer_store_dwordx2 v[6:7], v10, s[40:43], s49 offen
Lg_19:
    s_branch Ljoin
Lvar4:
Lst10:
    s_cbranch_execz Lback
    v_mfma_f32_16x16x32_bf16 v[92:95], v[160:163], a[236:239], v[92:95]
    s_waitcnt vmcnt(16)
    s_waitcnt lgkmcnt(0)
    s_barrier
    ds_read_b64_tr_b16 v[152:153], v17 offset:53280
    ds_read_b64_tr_b16 v[154:155], v17 offset:53792
    ds_read_b64_tr_b16 v[156:157], v17 offset:55328
    ds_read_b64_tr_b16 v[158:159], v17 offset:55840
    s_add_u32 m0, s71, 49152
    s_sub_u32 s3, s70, 57344
    v_mfma_f32_16x16x32_bf16 v[96:99], v[164:167], a[220:223], v[96:99]
    s_nop 3
    buffer_load_dwordx4 v64, s[16:19], s3 offen lds
    ds_read_b64_tr_b16 v[160:161], v17 offset:61472
    ds_read_b64_tr_b16 v[162:163], v17 offset:61984
    v_mfma_f32_16x16x32_bf16 v[100:103], v[164:167], a[224:227], v[100:103]
    v_cndmask_b32 v15, v116, v117, s[84:85]
    v_cndmask_b32 v15, v15, v118, s[86:87]
    v_cndmask_b32 v15, v15, v119, s[88:89]
    v_mfma_f32_16x16x32_bf16 v[104:107], v[164:167], a[228:231], v[104:107]
    s_add_u32 m0, s71, 53248
    s_sub_u32 s3, s70, 28672
    v_mul_f32 v14, 0xbb124925, v124
    v_mov_b32_dpp v40, v120 row_newbcast:0 row_mask:0xf bank_mask:0xf
    v_mov_b32_dpp v41, v121 row_newbcast:0 row_mask:0xf bank_mask:0xf
    v_mfma_f32_16x16x32_bf16 v[108:111], v[164:167], a[232:235], v[108:111]
    buffer_load_dwordx4 v64, s[16:19], s3 offen lds
    v_mfma_f32_16x16x32_bf16 v[112:115], v[164:167], a[236:239], v[112:115]
    s_waitcnt lgkmcnt(4)
    v_mov_b32_dpp v42, v122 row_newbcast:0 row_mask:0xf bank_mask:0xf
    v_mov_b32_dpp v43, v123 row_newbcast:0 row_mask:0xf bank_mask:0xf
    v_cndmask_b32 v25, v120, v121, s[84:85]
    v_cndmask_b32 v25, v25, v122, s[86:87]
    v_mfma_f32_16x16x32_bf16 v[76:79], v[152:155], a[240:243], v[76:79]
    ds_read_b64_tr_b16 v[164:165], v17 offset:63520
    ds_read_b64_tr_b16 v[166:167], v17 offset:64032
    v_cndmask_b32 v25, v25, v123, s[88:89]
    v_mfma_f32_16x16x32_bf16 v[80:83], v[152:155], a[244:247], v[80:83]
    s_add_u32 m0, s71, 28672
    s_sub_u32 s3, s70, 200704
    v_cndmask_b32 v24, v40, v41, s[84:85]
    v_cndmask_b32 v24, v24, v42, s[86:87]
    v_cndmask_b32 v24, v24, v43, s[88:89]
    v_mfma_f32_16x16x32_bf16 v[84:87], v[152:155], a[248:251], v[84:87]
    buffer_load_dwordx4 v64, s[16:19], s3 offen lds
    v_mfma_f32_16x16x32_bf16 v[88:91], v[152:155], a[252:255], v[88:91]
    v_mul_f32 v24, 0xbb124925, v24
    v_mul_f32 v15, 0x3b124925, v15
    v_fma_f32 v15, -v14, v14, v15
    v_max_f32 v15, 0, v15
    v_mfma_f32_16x16x32_bf16 v[92:95], v[152:155], v[128:131], v[92:95]
    s_waitcnt lgkmcnt(2)
    v_add_f32 v15, 0x3727c5ac, v15
    v_rsq_f32 v15, v15
    v_mfma_f32_16x16x32_bf16 v[76:79], v[160:163], v[132:135], v[76:79]
    s_add_u32 m0, s71, 32768
    s_sub_u32 s3, s70, 172032
    v_mul_f32 v25, 0x3b124925, v25
    v_fma_f32 v25, -v24, v24, v25
    v_max_f32 v25, 0, v25
    v_mfma_f32_16x16x32_bf16 v[80:83], v[160:163], v[136:139], v[80:83]
    buffer_load_dwordx4 v64, s[16:19], s3 offen lds
    v_mfma_f32_16x16x32_bf16 v[84:87], v[160:163], v[140:143], v[84:87]
    v_add_f32 v25, 0x3727c5ac, v25
    v_rsq_f32 v25, v25
    v_mfma_f32_16x16x32_bf16 v[88:91], v[160:163], v[144:147], v[88:91]
    ds_write2_b32 v62, v14, v15 offset0:0 offset1:80
    v_mfma_f32_16x16x32_bf16 v[92:95], v[160:163], v[148:151], v[92:95]
    s_add_u32 m0, s71, 36864
    s_sub_u32 s3, s70, 143360
    ds_write2_b32 v63, v24, v25 offset0:0 offset1:80
    v_mfma_f32_16x16x32_bf16 v[96:99], v[156:159], a[240:243], v[96:99]
    buffer_load_dwordx4 v64, s[16:19], s3 offen lds
    v_mfma_f32_16x16x32_bf16 v[100:103], v[156:159], a[244:247], v[100:103]
    v_mfma_f32_16x16x32_bf16 v[104:107], v[156:159], a[248:251], v[104:107]
    s_waitcnt vmcnt(13)
    s_waitcnt lgkmcnt(0)
    s_barrier
    ds_read2_b32 v[26:27], v29 offset0:16 offset1:32
    ds_read2_b32 v[176:177], v29 offset0:48 offset1:64
    v_mfma_f32_16x16x32_bf16 v[108:111], v[156:159], a[252:255], v[108:111]
    s_add_u32 m0, s71, 40960
    s_sub_u32 s3, s70, 114688
    ds_read_b32 v5, v29
    ds_read_b32 v9, v30 offset:320
    v_mfma_f32_16x16x32_bf16 v[112:115], v[156:159], v[128:131], v[112:115]
    buffer_load_dwordx4 v64, s[16:19], s3 offen lds
    ds_read_b32 v60, v60
    ds_read_b32 v61, v61
    v_mfma_f32_16x16x32_bf16 v[96:99], v[164:167], v[132:135], v[96:99]
    ds_read_b64_tr_b16 v[200:201], v18 offset:0
    ds_read_b64_tr_b16 v[202:203], v18 offset:512
    v_mfma_f32_16x16x32_bf16 v[100:103], v[164:167], v[136:139], v[100:103]
    ds_read_b64_tr_b16 v[204:205], v18 offset:4096
    ds_read_b64_tr_b16 v[206:207], v18 offset:4608
    s_waitcnt lgkmcnt(9)
    v_fmac_f32_dpp v80, v76, v26 row_newbcast:0 row_mask:0xf bank_mask:0xf
    v_mfma_f32_16x16x32_bf16 v[104:107], v[164:167], v[140:143], v[104:107]
    s_add_u32 m0, s71, 0
    s_add_u32 s3, s70, 0
    ds_read_b64_tr_b16 v[208:209], v18 offset:8192
    ds_read_b64_tr_b16 v[210:211], v18 offset:8704
    v_fmac_f32_dpp v81, v77, v26 row_newbcast:0 row_mask:0xf bank_mask:0xf
    v_fmac_f32_dpp v82, v78, v26 row_newbcast:0 row_mask:0xf bank_mask:0xf
    v_mfma_f32_16x16x32_bf16 v[108:111], v[164:167], v[144:147], v[108:111]
    buffer_load_dwordx4 v64, s[16:19], s3 offen lds
    v_mfma_f32_16x16x32_bf16 v[112:115], v[164:167], v[148:151], v[112:115]
    s_waitcnt lgkmcnt(4)
    v_fmac_f32_dpp v83, v79, v26 row_newbcast:0 row_mask:0xf bank_mask:0xf
    v_cvt_pk_bf16_f32 v80, v80, v81
    v_cvt_pk_bf16_f32 v81, v82, v83
    v_mfma_f32_16x16x32_bf16 v[180:183], a[0:3], v[200:203], 0
    s_add_u32 m0, s71, 4096
    s_add_u32 s3, s70, 28672
    ds_write_b64 v56, v[80:81] offset:0
    ds_read_b64_tr_b16 v[212:213], v18 offset:12288
    ds_read_b64_tr_b16 v[214:215], v18 offset:12800
    v_fmac_f32_dpp v84, v76, v27 row_newbcast:0 row_mask:0xf bank_mask:0xf
    v_mfma_f32_16x16x32_bf16 v[184:187], a[4:7], v[200:203], 0
    buffer_load_dwordx4 v64, s[16:19], s3 offen lds
    v_fmac_f32_dpp v85, v77, v27 row_newbcast:0 row_mask:0xf bank_mask:0xf
    v_mfma_f32_16x16x32_bf16 v[188:191], a[8:11], v[200:203], 0
    v_fmac_f32_dpp v86, v78, v27 row_newbcast:0 row_mask:0xf bank_mask:0xf
    v_fmac_f32_dpp v87, v79, v27 row_newbcast:0 row_mask:0xf bank_mask:0xf
    v_cvt_pk_bf16_f32 v84, v84, v85
    v_mfma_f32_16x16x32_bf16 v[192:195], a[12:15], v[200:203], 0
    v_cvt_pk_bf16_f32 v85, v86, v87
    v_fmac_f32_dpp v88, v76, v176 row_newbcast:0 row_mask:0xf bank_mask:0xf
    v_fmac_f32_dpp v89, v77, v176 row_newbcast:0 row_mask:0xf bank_mask:0xf
    v_mfma_f32_16x16x32_bf16 v[196:199], a[16:19], v[200:203], 0
    s_waitcnt lgkmcnt(5)
    s_add_u32 m0, s71, 8192
    s_add_u32 s3, s70, 57344
    ds_write_b64 v56, v[84:85] offset:2176
    v_fmac_f32_dpp v90, v78, v176 row_newbcast:0 row_mask:0xf bank_mask:0xf
    v_fmac_f32_dpp v91, v79, v176 row_newbcast:0 row_mask:0xf bank_mask:0xf
    v_cvt_pk_bf16_f32 v88, v88, v89
    v_mfma_f32_16x16x32_bf16 v[180:183], a[20:23], v[204:207], v[180:183]
    buffer_load_dwordx4 v64, s[16:19], s3 offen lds
    ds_read_b64_tr_b16 v[200:201], v18 offset:16384
    ds_read_b64_tr_b16 v[202:203], v18 offset:16896
    v_mfma_f32_16x16x32_bf16 v[184:187], a[24:27], v[204:207], v[184:187]
    v_cvt_pk_bf16_f32 v89, v90, v91
    v_fmac_f32_dpp v92, v76, v177 row_newbcast:0 row_mask:0xf bank_mask:0xf
    v_mfma_f32_16x16x32_bf16 v[188:191], a[28:31], v[204:207], v[188:191]
    ds_write_b64 v56, v[88:89] offset:4352
    v_fmac_f32_dpp v93, v77, v177 row_newbcast:0 row_mask:0xf bank_mask:0xf
    v_fmac_f32_dpp v94, v78, v177 row_newbcast:0 row_mask:0xf bank_mask:0xf
    v_fmac_f32_dpp v95, v79, v177 row_newbcast:0 row_mask:0xf bank_mask:0xf
    v_cvt_pk_bf16_f32 v92, v92, v93
    v_mfma_f32_16x16x32_bf16 v[192:195], a[32:35], v[204:207], v[192:195]
    s_add_u32 m0, s71, 12288
    s_add_u32 s3, s70, 86016
    v_cvt_pk_bf16_f32 v93, v94, v95
    v_fmac_f32_dpp v100, v96, v26 row_newbcast:0 row_mask:0xf bank_mask:0xf
    v_mfma_f32_16x16x32_bf16 v[196:199], a[36:39], v[204:207], v[196:199]
    s_waitcnt lgkmcnt(7)
    buffer_load_dwordx4 v64, s[16:19], s3 offen lds
    ds_write_b64 v56, v[92:93] offset:6528
    v_fmac_f32_dpp v101, v97, v26 row_newbcast:0 row_mask:0xf bank_mask:0xf
    v_mfma_f32_16x16x32_bf16 v[180:183], a[40:43], v[208:211], v[180:183]
    ds_read_b64_tr_b16 v[204:205], v18 offset:20480
    ds_read_b64_tr_b16 v[206:207], v18 offset:20992
    v_fmac_f32_dpp v102, v98, v26 row_newbcast:0 row_mask:0xf bank_mask:0xf
    v_mfma_f32_16x16x32_bf16 v[184:187], a[44:47], v[208:211], v[184:187]
    v_fmac_f32_dpp v103, v99, v26 row_newbcast:0 row_mask:0xf bank_mask:0xf
    v_cvt_pk_bf16_f32 v100, v100, v101
    v_cvt_pk_bf16_f32 v101, v102, v103
    v_mfma_f32_16x16x32_bf16 v[188:191], a[48:51], v[208:211], v[188:191]
    s_add_u32 m0, s71, 16384
    s_add_u32 s3, s70, 114688
    ds_write_b64 v56, v[100:101] offset:10880
    v_fmac_f32_dpp v104, v96, v27 row_newbcast:0 row_mask:0xf bank_mask:0xf
    v_fmac_f32_dpp v105, v97, v27 row_newbcast:0 row_mask:0xf bank_mask:0xf
    v_fmac_f32_dpp v106, v98, v27 row_newbcast:0 row_mask:0xf bank_mask:0xf
    v_mfma_f32_16x16x32_bf16 v[192:195], a[52:55], v[208:211], v[192:195]
    buffer_load_dwordx4 v64, s[16:19], s3 offen lds
    v_fmac_f32_dpp v107, v99, v27 row_newbcast:0 row_mask:0xf bank_mask:0xf
    v_mfma_f32_16x16x32_bf16 v[196:199], a[56:59], v[208:211], v[196:199]
    s_waitcnt lgkmcnt(8)
    v_cvt_pk_bf16_f32 v104, v104, v105
    v_cvt_pk_bf16_f32 v105, v106, v107
    v_mfma_f32_16x16x32_bf16 v[180:183], a[60:63], v[212:215], v[180:183]
    ds_write_b64 v56, v[104:105] offset:13056
    ds_read_b64_tr_b16 v[208:209], v18 offset:24576
    ds_read_b64_tr_b16 v[210:211], v18 offset:25088
    v_fmac_f32_dpp v108, v96, v176 row_newbcast:0 row_mask:0xf bank_mask:0xf
    v_fmac_f32_dpp v109, v97, v176 row_newbcast:0 row_mask:0xf bank_mask:0xf
    v_mfma_f32_16x16x32_bf16 v[184:187], a[64:67], v[212:215], v[184:187]
    s_add_u32 m0, s71, 20480
    s_add_u32 s3, s70, 143360
    v_fmac_f32_dpp v110, v98, v176 row_newbcast:0 row_mask:0xf bank_mask:0xf
    v_fmac_f32_dpp v111, v99, v176 row_newbcast:0 row_mask:0xf bank_mask:0xf
    v_cvt_pk_bf16_f32 v108, v108, v109
    v_mfma_f32_16x16x32_bf16 v[188:191], a[68:71], v[212:215], v[188:191]
    buffer_load_dwordx4 v64, s[16:19], s3 offen lds
    v_cvt_pk_bf16_f32 v109, v110, v111
    v_mfma_f32_16x16x32_bf16 v[192:195], a[72:75], v[212:215], v[192:195]
    ds_write_b64 v56, v[108:109] offset:15232
    v_fmac_f32_dpp v112, v96, v177 row_newbcast:0 row_mask:0xf bank_mask:0xf
    v_fmac_f32_dpp v113, v97, v177 row_newbcast:0 row_mask:0xf bank_mask:0xf
    v_mfma_f32_16x16x32_bf16 v[196:199], a[76:79], v[212:215], v[196:199]
    s_waitcnt lgkmcnt(9)
    v_fmac_f32_dpp v114, v98, v177 row_newbcast:0 row_mask:0xf bank_mask:0xf
    v_fmac_f32_dpp v115, v99, v177 row_newbcast:0 row_mask:0xf bank_mask:0xf
    v_cvt_pk_bf16_f32 v112, v112, v113
    v_cvt_pk_bf16_f32 v113, v114, v115
    v_mfma_f32_16x16x32_bf16 v[180:183], a[80:83], v[200:203], v[180:183]
    ds_read_b64_tr_b16 v[212:213], v18 offset:28672
    ds_read_b64_tr_b16 v[214:215], v18 offset:29184
    ds_write_b64 v56, v[112:113] offset:17408
    v_mfma_f32_16x16x32_bf16 v[184:187], a[84:87], v[200:203], v[184:187]
    v_fmac_f32_dpp v96, v96, v5 row_newbcast:0 row_mask:0xf bank_mask:0xf
    v_fmac_f32_dpp v97, v97, v5 row_newbcast:0 row_mask:0xf bank_mask:0xf
    v_fmac_f32_dpp v98, v98, v5 row_newbcast:0 row_mask:0xf bank_mask:0xf
    v_fmac_f32_dpp v99, v99, v5 row_newbcast:0 row_mask:0xf bank_mask:0xf
    v_mfma_f32_16x16x32_bf16 v[188:191], a[88:91], v[200:203], v[188:191]
    v_cvt_pk_bf16_f32 v96, v96, v97
    v_cvt_pk_bf16_f32 v97, v98, v99
    v_mfma_f32_16x16x32_bf16 v[192:195], a[92:95], v[200:203], v[192:195]
    ds_write_b64 v56, v[96:97] offset:8704
    v_mul_f32 v9, 0x3e8b97f6, v9
    v_mul_f32 v8, v9, v60
    v_mul_f32 v9, v9, v61
    v_mfma_f32_16x16x32_bf16 v[196:199], a[96:99], v[200:203], v[196:199]
    s_waitcnt vmcnt(14)
    s_waitcnt lgkmcnt(0)
    s_barrier
    ds_read_b64 v[24:25], v57 offset:0
    ds_read_b64 v[26:27], v57 offset:32
    ds_read_b64 v[40:41], v57 offset:8704
    ds_read_b64 v[42:43], v57 offset:8736
    ds_read_b64 v[76:77], v57 offset:10880
    ds_read_b64 v[78:79], v57 offset:10912
    ds_read_b64 v[118:119], v57 offset:96
    ds_read_b64 v[122:123], v57 offset:8800
    ds_read_b64 v[126:127], v57 offset:10976
    v_mfma_f32_16x16x32_bf16 v[180:183], a[100:103], v[204:207], v[180:183]
    ds_read_b64_tr_b16 v[200:201], v18 offset:32768
    ds_read_b64_tr_b16 v[202:203], v18 offset:33280
    v_mov_b32 v116, 0
    v_mov_b32 v117, 0
    v_mov_b32 v120, 0
    v_mfma_f32_16x16x32_bf16 v[184:187], a[104:107], v[204:207], v[184:187]
    s_add_u32 m0, s73, 0
    s_add_u32 s3, s72, 0
    v_mov_b32 v121, 0
    v_mov_b32 v124, 0
    v_mov_b32 v125, 0
    v_mov_b32 v89, s68
    v_mov_b32 v91, s69
    v_mfma_f32_16x16x32_bf16 v[188:191], a[108:111], v[204:207], v[188:191]
    buffer_load_dwordx4 v67, s[20:23], s3 offen offset:0 lds
    v_mov_b32 v161, s68
    v_mov_b32 v163, s69
    v_mfma_f32_16x16x32_bf16 v[192:195], a[112:115], v[204:207], v[192:195]
    ds_read_b64 v[92:93], v57 offset:48
    s_waitcnt lgkmcnt(10)
    v_cndmask_b32 v26, v26, v4, s[98:99]
    v_cndmask_b32 v27, v27, v4, s[98:99]
    s_waitcnt lgkmcnt(5)
    v_cndmask_b32 v118, v4, v118, s[78:79]
    v_cndmask_b32 v119, v4, v119, s[78:79]
    v_mfma_f32_16x16x32_bf16 v[196:199], a[116:119], v[204:207], v[196:199]
    ds_read_b64 v[94:95], v57 offset:80
    v_mfma_f32_16x16x32_bf16 v[80:83], v[40:43], v[24:27], v[44:47]
    ds_read_b64 v[96:97], v57 offset:8752
    v_mfma_f32_16x16x32_bf16 v[84:87], v[76:79], v[24:27], v[48:51]
    s_waitcnt lgkmcnt(6)
    ds_read_b64 v[98:99], v57 offset:8784
    v_mfma_f32_16x16x32_bf16 v[152:155], v[120:123], v[116:119], v[44:47]
    s_waitcnt lgkmcnt(6)
    ds_read_b64 v[100:101], v57 offset:10928
    v_mfma_f32_16x16x32_bf16 v[156:159], v[124:127], v[116:119], v[48:51]
    buffer_load_dwordx4 v68, s[20:23], s3 offen offset:1024 lds
    ds_read_b64 v[102:103], v57 offset:10960
    v_mfma_f32_16x16x32_bf16 v[180:183], a[120:123], v[208:211], v[180:183]
    ds_read_b64_tr_b16 v[204:205], v18 offset:36864
    ds_read_b64_tr_b16 v[206:207], v18 offset:37376
    v_mfma_f32_16x16x32_bf16 v[184:187], a[124:127], v[208:211], v[184:187]
    v_max3_f32 v88, v80, v81, v84
    v_max3_f32 v90, v82, v83, v86
    v_max_f32 v88, v88, v85
    v_max_f32 v90, v90, v87
    v_mfma_f32_16x16x32_bf16 v[188:191], a[128:131], v[208:211], v[188:191]
    v_max3_f32 v160, v152, v153, v156
    v_max3_f32 v162, v154, v155, v158
    v_max_f32 v160, v160, v157
    v_max_f32 v162, v162, v159
    v_mfma_f32_16x16x32_bf16 v[192:195], a[132:135], v[208:211], v[192:195]
    s_add_u32 s92, s47, 28672
    s_waitcnt lgkmcnt(6)
    v_cndmask_b32 v94, v94, v4, s[90:91]
    v_cndmask_b32 v95, v95, v4, s[90:91]
    v_mfma_f32_16x16x32_bf16 v[196:199], a[136:139], v[208:211], v[196:199]
    s_waitcnt lgkmcnt(4)
    buffer_store_dwordx4 v[88:91], v3, s[40:43], s92 offen sc1
    v_mfma_f32_16x16x32_bf16 v[104:107], v[96:99], v[92:95], v[44:47]
    s_waitcnt lgkmcnt(2)
    buffer_load_dwordx4 v69, s[20:23], s3 offen offset:2048 lds
    s_add_u32 s95, s47, 32768
    buffer_store_dwordx4 v[160:163], v3, s[40:43], s95 offen sc1
    v_mfma_f32_16x16x32_bf16 v[108:111], v[100:103], v[92:95], v[48:51]
    v_mfma_f32_16x16x32_bf16 v[180:183], a[140:143], v[212:215], v[180:183]
    ds_read_b64_tr_b16 v[208:209], v18 offset:40960
    ds_read_b64_tr_b16 v[210:211], v18 offset:41472
    v_mfma_f32_16x16x32_bf16 v[184:187], a[144:147], v[212:215], v[184:187]
    v_mfma_f32_16x16x32_bf16 v[188:191], a[148:151], v[212:215], v[188:191]
    s_nop 2
    v_max3_f32 v112, v104, v105, v108
    v_max3_f32 v114, v106, v107, v110
    v_mfma_f32_16x16x32_bf16 v[192:195], a[152:155], v[212:215], v[192:195]
    v_max_f32 v112, v112, v109
    v_max_f32 v114, v114, v111
    v_mul_f32 v112, v112, v8
    v_mfma_f32_16x16x32_bf16 v[196:199], a[156:159], v[212:215], v[196:199]
    buffer_load_dwordx4 v70, s[20:23], s3 offen offset:3072 lds
    v_mfma_f32_16x16x32_bf16 v[180:183], a[160:163], v[200:203], v[180:183]
    ds_read_b64_tr_b16 v[212:213], v18 offset:45056
    ds_read_b64_tr_b16 v[214:215], v18 offset:45568
    v_mul_f32 v114, v114, v9
    v_mfma_f32_16x16x32_bf16 v[184:187], a[164:167], v[200:203], v[184:187]
    v_max_f32 v104, v112, v114
    v_mov_b32 v105, v104
    v_mfma_f32_16x16x32_bf16 v[188:191], a[168:171], v[200:203], v[188:191]
    s_nop 0
    v_permlane16_swap_b32 v104, v105
    v_max_f32 v104, v104, v105
    v_mov_b32 v105, v104
    v_mfma_f32_16x16x32_bf16 v[192:195], a[172:175], v[200:203], v[192:195]
    s_nop 0
    v_permlane32_swap_b32 v104, v105
    v_max_f32 v104, v104, v105
    v_mfma_f32_16x16x32_bf16 v[196:199], a[176:179], v[200:203], v[196:199]
    s_waitcnt lgkmcnt(4)
    s_add_u32 m0, s73, 16384
    s_add_u32 s3, s72, 229376
    v_sub_f32 v112, v112, v104
    v_sub_f32 v114, v114, v104
    v_mfma_f32_16x16x32_bf16 v[180:183], a[180:183], v[204:207], v[180:183]
    buffer_load_dwordx4 v67, s[20:23], s3 offen offset:0 lds
    ds_read_b64_tr_b16 v[200:201], v18 offset:49152
    ds_read_b64_tr_b16 v[202:203], v18 offset:49664
    v_mfma_f32_16x16x32_bf16 v[184:187], a[184:187], v[204:207], v[184:187]
    v_exp_f32 v112, v112
    v_mfma_f32_16x16x32_bf16 v[188:191], a[188:191], v[204:207], v[188:191]
    v_exp_f32 v114, v114
    s_nop 0
    v_add_f32 v104, v112, v114
    v_mfma_f32_16x16x32_bf16 v[192:195], a[192:195], v[204:207], v[192:195]
    v_mov_b32 v105, v104
    v_mul_f32 v112, v112, v60
    v_mfma_f32_16x16x32_bf16 v[196:199], a[196:199], v[204:207], v[196:199]
    s_waitcnt lgkmcnt(4)
    v_mul_f32 v114, v114, v61
    v_permlane16_swap_b32 v104, v105
    v_add_f32 v104, v104, v105
    v_mfma_f32_16x16x32_bf16 v[180:183], a[200:203], v[208:211], v[180:183]
    ds_read_b64_tr_b16 v[204:205], v18 offset:53248
    ds_read_b64_tr_b16 v[206:207], v18 offset:53760
    v_mfma_f32_16x16x32_bf16 v[184:187], a[204:207], v[208:211], v[184:187]
    buffer_load_dwordx4 v68, s[20:23], s3 offen offset:1024 lds
    v_mov_b32 v105, v104
    v_mfma_f32_16x16x32_bf16 v[188:191], a[208:211], v[208:211], v[188:191]
    s_nop 0
    v_permlane32_swap_b32 v104, v105
    v_add_f32 v104, v104, v105
    v_mfma_f32_16x16x32_bf16 v[192:195], a[212:215], v[208:211], v[192:195]
    v_rcp_f32 v104, v104
    s_nop 0
    v_mul_f32 v112, v112, v104
    v_mfma_f32_16x16x32_bf16 v[196:199], a[216:219], v[208:211], v[196:199]
    s_waitcnt lgkmcnt(4)
    ds_read_b128 v[76:79], v31 offset:0
    v_mul_f32 v114, v114, v104
    v_mfma_f32_16x16x32_bf16 v[180:183], a[220:223], v[212:215], v[180:183]
    s_waitcnt lgkmcnt(3)
    ds_read_b128 v[100:103], v31 offset:64
    v_cvt_pk_bf16_f32 v112, v112, v112
    v_cvt_pk_bf16_f32 v114, v114, v114
    v_mfma_f32_16x16x32_bf16 v[180:183], a[240:243], v[200:203], v[180:183]
    s_waitcnt lgkmcnt(2)
    ds_read_b128 v[124:127], v31 offset:128
    v_and_b32 v92, v112, v52
    v_mfma_f32_16x16x32_bf16 v[180:183], v[132:135], v[204:207], v[180:183]
    buffer_load_dwordx4 v69, s[20:23], s3 offen offset:2048 lds
    ds_read_b128 v[84:87], v31 offset:192
    v_mfma_f32_16x16x32_bf16 v[184:187], a[224:227], v[212:215], v[184:187]
    ds_read_b128 v[108:111], v31 offset:256
    v_and_b32 v93, v114, v53
    v_mfma_f32_16x16x32_bf16 v[184:187], a[244:247], v[200:203], v[184:187]
    v_and_b32 v94, v112, v54
    v_and_b32 v95, v114, v55
    v_mfma_f32_16x16x32_bf16 v[184:187], v[136:139], v[204:207], v[184:187]
    v_mfma_f32_16x16x32_bf16 v[188:191], a[228:231], v[212:215], v[188:191]
    v_mov_b32 v14, v180
    v_mov_b32 v15, v180
    v_mfma_f32_16x16x32_bf16 v[188:191], a[248:251], v[200:203], v[188:191]
    s_nop 0
    v_permlane16_swap_b32 v14, v15
    v_mov_b32 v15, v14
    s_nop 1
    v_permlane32_swap_b32 v14, v15
    v_mfma_f32_16x16x32_bf16 v[188:191], v[140:143], v[204:207], v[188:191]
    buffer_load_dwordx4 v70, s[20:23], s3 offen offset:3072 lds
    v_mfma_f32_16x16x32_bf16 v[192:195], a[232:235], v[212:215], v[192:195]
    s_waitcnt lgkmcnt(4)
    v_fmac_f32 v180, v76, v14
    v_fmac_f32 v181, v77, v14
    v_fmac_f32 v182, v78, v14
    v_mfma_f32_16x16x32_bf16 v[192:195], a[252:255], v[200:203], v[192:195]
    v_fmac_f32 v183, v79, v14
    v_cvt_pk_bf16_f32 v180, v180, v181
    v_mfma_f32_16x16x32_bf16 v[192:195], v[144:147], v[204:207], v[192:195]
    v_cvt_pk_bf16_f32 v181, v182, v183
    s_waitcnt lgkmcnt(3)
    v_fmac_f32 v184, v100, v14
    v_mfma_f32_16x16x32_bf16 v[196:199], a[236:239], v[212:215], v[196:199]
    ds_write_b64 v58, v[180:181] offset:0
    v_fmac_f32 v185, v101, v14
    v_fmac_f32 v186, v102, v14
    v_mfma_f32_16x16x32_bf16 v[196:199], v[128:131], v[200:203], v[196:199]
    v_fmac_f32 v187, v103, v14
    v_cvt_pk_bf16_f32 v184, v184, v185
    v_cvt_pk_bf16_f32 v185, v186, v187
    v_mfma_f32_16x16x32_bf16 v[196:199], v[148:151], v[204:207], v[196:199]
    ds_write_b64 v58, v[184:185] offset:512
    s_waitcnt lgkmcnt(4)
    v_fmac_f32 v188, v124, v14
    v_fmac_f32 v189, v125, v14
    v_fmac_f32 v190, v126, v14
    v_fmac_f32 v191, v127, v14
    v_cvt_pk_bf16_f32 v188, v188, v189
    v_cvt_pk_bf16_f32 v189, v190, v191
    ds_write_b64 v58, v[188:189] offset:1024
    s_waitcnt lgkmcnt(4)
    v_pk_fma_f32 v[192:193], v[84:85], v[14:15], v[192:193] op_sel_hi:[1,0,1]
    v_pk_fma_f32 v[194:195], v[86:87], v[14:15], v[194:195] op_sel_hi:[1,0,1]
    v_cvt_pk_bf16_f32 v192, v192, v193
    v_cvt_pk_bf16_f32 v193, v194, v195
    ds_write_b64 v58, v[192:193] offset:1536
    s_waitcnt lgkmcnt(4)
    v_pk_fma_f32 v[196:197], v[108:109], v[14:15], v[196:197] op_sel_hi:[1,0,1]
    v_pk_fma_f32 v[198:199], v[110:111], v[14:15], v[198:199] op_sel_hi:[1,0,1]
    v_cvt_pk_bf16_f32 v196, v196, v197
    v_cvt_pk_bf16_f32 v197, v198, v199
    ds_write_b64 v58, v[196:197] offset:2048
    s_waitcnt vmcnt(10)
    s_waitcnt lgkmcnt(0)
    s_barrier
    s_add_u32 m0, s73, 32768
    s_add_u32 s3, s72, 458752
    buffer_load_dwordx4 v67, s[20:23], s3 offen offset:0 lds
    ds_read_b64 v[76:77], v59 offset:0
    ds_read_b64 v[78:79], v59 offset:512
    ds_read_b64 v[100:101], v59 offset:2560
    ds_read_b64 v[102:103], v59 offset:3072
    ds_read_b64 v[124:125], v59 offset:5120
    ds_read_b64 v[126:127], v59 offset:5632
    ds_read_b64 v[84:85], v59 offset:7680
    buffer_load_dwordx4 v68, s[20:23], s3 offen offset:1024 lds
    ds_read_b64 v[86:87], v59 offset:8192
    s_waitcnt vmcnt(7)
    s_add_u32 s93, s47, 24576
    buffer_load_dwordx4 v[40:43], v3, s[40:43], s93 offen sc1
    s_add_u32 s94, s47, 36864
    buffer_load_dwordx4 v[120:123], v3, s[40:43], s94 offen sc1
    s_waitcnt lgkmcnt(4)
    v_mfma_f32_16x16x32_bf16 v[204:207], v[100:103], v[92:95], 0
    s_waitcnt lgkmcnt(2)
    ds_read_b64_tr_b16 a[0:1], v71 offset:0
    ds_read_b64_tr_b16 a[2:3], v71 offset:2048
    v_mfma_f32_16x16x32_bf16 v[200:203], v[124:127], v[92:95], 0
    s_waitcnt lgkmcnt(2)
    ds_read_b64_tr_b16 a[4:5], v72 offset:0
    ds_read_b64_tr_b16 a[6:7], v72 offset:2048
    v_mfma_f32_16x16x32_bf16 v[108:111], v[84:87], v[92:95], 0
    ds_read_b64_tr_b16 a[8:9], v73 offset:0
    ds_read_b64_tr_b16 a[10:11], v73 offset:2048
    ds_read_b64_tr_b16 a[12:13], v74 offset:0
    ds_read_b64_tr_b16 a[14:15], v74 offset:2048
    ds_read_b64_tr_b16 a[16:17], v71 offset:4096
    ds_read_b64_tr_b16 a[18:19], v71 offset:6144
    ds_read_b64_tr_b16 a[20:21], v72 offset:4096
    ds_read_b64_tr_b16 a[22:23], v72 offset:6144
    ds_read_b64_tr_b16 a[24:25], v73 offset:4096
    ds_read_b64_tr_b16 a[26:27], v73 offset:6144
    ds_read_b64_tr_b16 a[28:29], v74 offset:4096
    ds_read_b64_tr_b16 a[30:31], v74 offset:6144
    buffer_load_dwordx4 v69, s[20:23], s3 offen offset:2048 lds
    ds_read_b64_tr_b16 a[32:33], v71 offset:8192
    ds_read_b64_tr_b16 a[34:35], v71 offset:10240
    ds_read_b64_tr_b16 a[36:37], v72 offset:8192
    ds_read_b64_tr_b16 a[38:39], v72 offset:10240
    ds_read_b64_tr_b16 a[40:41], v73 offset:8192
    ds_read_b64_tr_b16 a[42:43], v73 offset:10240
    ds_read_b64_tr_b16 a[44:45], v74 offset:8192
    ds_read_b64_tr_b16 a[46:47], v74 offset:10240
    buffer_load_dwordx4 v70, s[20:23], s3 offen offset:3072 lds
    ds_read_b64_tr_b16 a[48:49], v71 offset:12288
    ds_read_b64_tr_b16 a[50:51], v71 offset:14336
    ds_read_b64_tr_b16 a[52:53], v72 offset:12288
    ds_read_b64_tr_b16 a[54:55], v72 offset:14336
    ds_read_b64_tr_b16 a[56:57], v73 offset:12288
    ds_read_b64_tr_b16 a[58:59], v73 offset:14336
    ds_read_b64_tr_b16 a[60:61], v74 offset:12288
    ds_read_b64_tr_b16 a[62:63], v74 offset:14336
    ds_read_b64_tr_b16 a[64:65], v71 offset:16384
    s_add_u32 m0, s73, 49152
    s_add_u32 s3, s72, 688128
    buffer_load_dwordx4 v67, s[20:23], s3 offen offset:0 lds
    ds_read_b64_tr_b16 a[66:67], v71 offset:18432
    ds_read_b64_tr_b16 a[68:69], v72 offset:16384
    ds_read_b64_tr_b16 a[70:71], v72 offset:18432
    ds_read_b64_tr_b16 a[72:73], v73 offset:16384
    ds_read_b64_tr_b16 a[74:75], v73 offset:18432
    ds_read_b64_tr_b16 a[76:77], v74 offset:16384
    ds_read_b64_tr_b16 a[78:79], v74 offset:18432
    buffer_load_dwordx4 v68, s[20:23], s3 offen offset:1024 lds
    ds_read_b64_tr_b16 a[80:81], v71 offset:20480
    ds_read_b64_tr_b16 a[82:83], v71 offset:22528
    ds_read_b64_tr_b16 a[84:85], v72 offset:20480
    ds_read_b64_tr_b16 a[86:87], v72 offset:22528
    ds_read_b64_tr_b16 a[88:89], v73 offset:20480
Lst11:
Lv4_1:
Lv4_2:
    s_cbranch_execz Lback
    ds_read_b64_tr_b16 a[90:91], v73 offset:22528
    ds_read_b64_tr_b16 a[92:93], v74 offset:20480
    ds_read_b64_tr_b16 a[94:95], v74 offset:22528
    v_cvt_pk_bf16_f32 v204, v204, v205
    buffer_load_dwordx4 v69, s[20:23], s3 offen offset:2048 lds
    v_cvt_pk_bf16_f32 v205, v206, v207
    v_cvt_pk_bf16_f32 v172, v200, v201
    v_cvt_pk_bf16_f32 v173, v202, v203
    v_cvt_pk_bf16_f32 v174, v108, v109
    v_cvt_pk_bf16_f32 v175, v110, v111
    buffer_load_dwordx4 v70, s[20:23], s3 offen offset:3072 lds
    s_add_u32 m0, s73, 65536
    s_add_u32 s3, s72, 917504
    buffer_load_dwordx4 v67, s[20:23], s3 offen offset:0 lds
    buffer_load_dwordx4 v68, s[20:23], s3 offen offset:1024 lds
    s_waitcnt vmcnt(9)
    v_cmp_ne_u32 vcc, s68, v41
    v_cmp_ne_u32 s[6:7], s69, v43
    s_nop 0
    s_or_b64 vcc, vcc, s[6:7]
    s_waitcnt vmcnt(8)
    v_cmp_ne_u32 s[4:5], s68, v121
    v_cmp_ne_u32 s[6:7], s69, v123
    s_or_b64 vcc, vcc, s[4:5]
    s_or_b64 vcc, vcc, s[6:7]
    s_cbranch_scc1 Lxd_22
Lxk_20:
    buffer_load_dwordx4 v69, s[20:23], s3 offen offset:2048 lds
    v_add_f32 v88, v88, v40
    v_add_f32 v90, v90, v42
    v_add_f32 v160, v160, v120
    v_add_f32 v162, v162, v122
    v_mul_f32 v88, v88, v8
    v_mul_f32 v90, v90, v9
    v_max_f32 v80, v88, v90
    v_mul_f32 v160, v160, v8
    v_mul_f32 v162, v162, v9
    v_max_f32 v152, v160, v162
    s_nop 1
    v_permlane16_swap_b32 v80, v152
    v_max_f32 v80, v80, v152
    v_mov_b32 v152, v80
    s_nop 1
    v_permlane32_swap_b32 v80, v152
    buffer_load_dwordx4 v70, s[20:23], s3 offen offset:3072 lds
    v_max_f32 v80, v80, v152
    v_mov_b32 v152, v80
    s_nop 1
    v_permlane16_swap_b32 v80, v152
    v_sub_f32 v88, v88, v80
    v_sub_f32 v90, v90, v80
    v_sub_f32 v160, v160, v152
    v_sub_f32 v162, v162, v152
    v_exp_f32 v88, v88
    v_exp_f32 v90, v90
    v_exp_f32 v160, v160
    v_exp_f32 v162, v162
    v_add_f32 v80, v88, v90
    v_add_f32 v152, v160, v162
    v_mul_f32 v88, v88, v60
    v_mul_f32 v90, v90, v61
    v_permlane16_swap_b32 v80, v152
    v_add_f32 v80, v80, v152
    v_mov_b32 v152, v80
    v_mul_f32 v160, v160, v60
    v_mul_f32 v162, v162, v61
    v_permlane32_swap_b32 v80, v152
    v_add_f32 v80, v80, v152
    v_mov_b32 v152, v80
    s_nop 1
    v_permlane16_swap_b32 v80, v152
    v_rcp_f32 v80, v80
    v_rcp_f32 v152, v152
    v_mul_f32 v88, v88, v80
    v_mul_f32 v90, v90, v80
    v_cvt_pk_bf16_f32 v88, v88, v88
    v_cvt_pk_bf16_f32 v90, v90, v90
    v_and_b32 v24, v88, v52
    v_and_b32 v25, v90, v53
    v_and_b32 v26, v88, v54
    v_and_b32 v27, v90, v55
    s_nop 1
    v_mfma_f32_16x16x32_bf16 v[212:215], v[76:79], v[24:27], 0
    v_mul_f32 v160, v160, v152
    v_mul_f32 v162, v162, v152
    v_cvt_pk_bf16_f32 v160, v160, v160
    v_cvt_pk_bf16_f32 v162, v162, v162
    v_mfma_f32_16x16x32_bf16 v[208:211], v[100:103], v[24:27], 0
    v_and_b32 v116, v160, v52
    v_and_b32 v117, v162, v53
    v_and_b32 v118, v160, v54
    v_and_b32 v119, v162, v55
    s_nop 1
    v_mfma_f32_16x16x32_bf16 v[216:219], v[84:87], v[116:119], 0
    v_cvt_pk_bf16_f32 v168, v212, v213
    v_cvt_pk_bf16_f32 v169, v214, v215
    v_cvt_pk_bf16_f32 v170, v208, v209
    v_cvt_pk_bf16_f32 v171, v210, v211
    s_nop 3
    v_cvt_pk_bf16_f32 v216, v216, v217
    v_cvt_pk_bf16_f32 v217, v218, v219
    v_cndmask_b32 v170, v170, v204, s[98:99]
    v_cndmask_b32 v171, v171, v205, s[98:99]
    v_cndmask_b32 v174, v174, v216, s[78:79]
    v_cndmask_b32 v175, v175, v217, s[78:79]
    buffer_store_dwordx4 v[168:171], v3, s[40:43], s48 offen offset:0 sc1
    buffer_store_dwordx4 v[172:175], v3, s[40:43], s48 offen offset:1024 sc1
    s_waitcnt lgkmcnt(0)
    s_barrier
    s_mul_i32 s52, s65, 512
    s_add_u32 s52, s52, 507904
    s_mul_i32 s49, s66, 64
    s_add_u32 s49, s49, s52
    s_mul_i32 s50, s65, 128
    s_mul_i32 s95, s66, 8
    s_add_u32 s50, s50, s95
    s_add_u32 s50, s50, 512000
    s_mul_i32 s45, s67, 11264
    s_add_u32 s45, s45, 114688
    s_mul_i32 s0, s67, 7168
    v_min_u32 v5, 6, v2
    v_lshlrev_b32 v8, 3, v5
    v_mul_u32_u24 v5, 64, v5
    v_add_u32 v9, 1, v2
    v_lshrrev_b32 v9, 2, v9
    v_min_u32 v9, 1, v9
    v_lshlrev_b32 v9, 20, v9
    v_add_lshl_u32 v9, v9, v2, 10
    v_min_u32 v10, 1, v2
    v_lshlrev_b32 v10, 30, v10
    v_bfe_u32 v14, v2, 4, 1
    v_lshlrev_b32 v25, 5, v14
    v_and_b32 v14, 3, v2
    v_lshl_add_u32 v25, v14, 3, v25
    v_bfe_u32 v11, v2, 2, 2
    v_lshrrev_b32 v14, 5, v2
    v_lshl_add_u32 v14, v14, 2, v11
    v_xor_b32 v11, s67, v11
    s_add_u32 m0, s73, 81920
    s_add_u32 s3, s72, 1146880
    buffer_load_dwordx4 v67, s[20:23], s3 offen offset:0 lds
    v_lshl_add_u32 v11, v11, 6, v25
    v_lshl_add_u32 v19, v14, 8, v11
    v_add_u32 v24, 57344, v19
    v_lshl_add_u32 v11, v14, 7, v25
    v_bfe_u32 v14, v2, 3, 1
    v_lshl_add_u32 v11, v14, 6, v11
    v_xor_b32 v14, 64, v11
    v_add_u32 v15, s45, v11
    v_add_u32 v16, s45, v14
    v_add_u32 v17, s0, v11
    v_add_u32 v18, s0, v14
    s_mul_i32 s92, s96, 256
    s_mul_i32 s95, s67, 64
    s_add_u32 s92, s92, s95
    v_and_b32 v11, 31, v2
    buffer_load_dwordx4 v68, s[20:23], s3 offen offset:1024 lds
    v_lshl_add_u32 v26, v11, 1, s92
    s_lshl_b32 s93, s66, 7
    v_and_b32 v14, 0x70, v3
    v_add_u32 v28, s93, v14
    ds_read_b64_tr_b16 a[96:97], v71 offset:24576
    ds_read_b64_tr_b16 a[98:99], v71 offset:26624
    s_lshr_b32 s93, s67, 1
    ds_read_b64_tr_b16 a[100:101], v72 offset:24576
    s_and_b32 s94, s67, 1
    ds_read_b64_tr_b16 a[102:103], v72 offset:26624
    s_mul_i32 s55, s65, 57344
    ds_read_b64_tr_b16 a[104:105], v73 offset:24576
    buffer_load_dwordx4 v69, s[20:23], s3 offen offset:2048 lds
    s_mul_i32 s95, s93, 28672
    ds_read_b64_tr_b16 a[106:107], v73 offset:26624
    s_add_u32 s55, s55, s95
    ds_read_b64_tr_b16 a[108:109], v74 offset:24576
    ds_read_b64_tr_b16 a[110:111], v74 offset:26624
    s_mul_i32 s95, s66, 4096
    ds_read_b64_tr_b16 a[112:113], v71 offset:28672
    s_add_u32 s55, s55, s95
    ds_read_b64_tr_b16 a[114:115], v71 offset:30720
    s_mul_i32 s95, s94, 256
    ds_read_b64_tr_b16 a[116:117], v72 offset:28672
    buffer_load_dwordx4 v70, s[20:23], s3 offen offset:3072 lds
    s_add_u32 s55, s55, s95
    ds_read_b64_tr_b16 a[118:119], v72 offset:30720
    s_add_u32 s55, s55, 262144
    ds_read_b64_tr_b16 a[120:121], v73 offset:28672
    ds_read_b64_tr_b16 a[122:123], v73 offset:30720
    s_mul_i32 s56, s65, 4096
    ds_read_b64_tr_b16 a[124:125], v74 offset:28672
    s_mul_i32 s95, s93, 2048
    ds_read_b64_tr_b16 a[126:127], v74 offset:30720
    s_add_u32 s56, s56, s95
    ds_read_b64_tr_b16 a[128:129], v71 offset:32768
    buffer_load_ushort v26, v26, s[28:31], 0 offen
    s_mul_i32 s95, s66, 256
    ds_read_b64_tr_b16 a[130:131], v71 offset:34816
    s_add_u32 s56, s56, s95
    ds_read_b64_tr_b16 a[132:133], v72 offset:32768
    s_mul_i32 s95, s94, 128
    ds_read_b64_tr_b16 a[134:135], v72 offset:34816
    ds_read_b64_tr_b16 a[136:137], v73 offset:32768
    s_add_u32 s56, s56, s95
    ds_read_b64_tr_b16 a[138:139], v73 offset:34816
    s_add_u32 s56, s56, 491520
    ds_read_b64_tr_b16 a[140:141], v74 offset:32768
    buffer_load_dwordx4 v[28:31], v28, s[32:35], 0 offen
    s_and_b32 s92, s65, 1
    ds_read_b64_tr_b16 a[142:143], v74 offset:34816
    s_xor_b32 s93, s92, 1
    ds_read_b64_tr_b16 a[144:145], v71 offset:36864
    s_mul_i32 s94, s67, 14336
    ds_read_b64_tr_b16 a[146:147], v71 offset:38912
    ds_read_b64_tr_b16 a[148:149], v72 offset:36864
    s_mul_i32 s95, s66, 128
    ds_read_b64_tr_b16 a[150:151], v72 offset:38912
    s_add_u32 s94, s94, s95
    ds_read_b64_tr_b16 a[152:153], v73 offset:36864
    s_mul_i32 s44, s92, 114688
    ds_read_b64_tr_b16 a[154:155], v73 offset:38912
    s_add_u32 s44, s44, s94
    ds_read_b64_tr_b16 a[156:157], v74 offset:36864
    s_mul_i32 s74, s93, 114688
    ds_read_b64_tr_b16 a[158:159], v74 offset:38912
    s_add_u32 s74, s74, s94
    v_lshlrev_b32 v164, 16, v32
    v_and_b32 v165, 0xffff0000, v32
    v_lshlrev_b32 v166, 16, v33
    v_and_b32 v167, 0xffff0000, v33
    v_lshlrev_b32 v176, 16, v34
    v_and_b32 v177, 0xffff0000, v34
    v_lshlrev_b32 v178, 16, v35
    v_and_b32 v179, 0xffff0000, v35
    v_lshlrev_b32 v180, 16, v36
    v_and_b32 v181, 0xffff0000, v36
    v_lshlrev_b32 v182, 16, v37
    v_and_b32 v183, 0xffff0000, v37
    v_lshlrev_b32 v184, 16, v38
    v_and_b32 v185, 0xffff0000, v38
    v_lshlrev_b32 v186, 16, v39
    v_and_b32 v187, 0xffff0000, v39
    v_and_b32 v14, 15, v2
    v_lshlrev_b32 v14, 3, v14
    v_lshrrev_b32 v11, 4, v2
    v_lshlrev_b32 v11, 9, v11
    v_lshl_add_u32 v11, v14, 1, v11
    s_waitcnt vmcnt(6)
    s_barrier
    s_cmp_lg_u32 s67, 0
    s_cbranch_scc1 Lg_23
    buffer_store_dwordx2 v[6:7], v10, s[40:43], s49 offen
Lg_23:
    s_branch Ljoin
Lvar5:
Lst12:
    s_cbranch_execz Lback
    s_waitcnt vmcnt(16)
    s_waitcnt lgkmcnt(0)
    s_barrier
    ds_read_b64_tr_b16 v[152:153], v17 offset:53280
    ds_read_b64_tr_b16 v[154:155], v17 offset:53792
    ds_read_b64_tr_b16 v[156:157], v17 offset:55328
    ds_read_b64_tr_b16 v[158:159], v17 offset:55840
    s_add_u32 m0, s71, 49152
    s_sub_u32 s3, s70, 57344
    v_mfma_f32_16x16x32_bf16 v[96:99], v[164:167], a[220:223], v[96:99]
    s_nop 3
    buffer_load_dwordx4 v64, s[16:19], s3 offen lds
    ds_read_b64_tr_b16 v[160:161], v17 offset:61472
    ds_read_b64_tr_b16 v[162:163], v17 offset:61984
    v_mfma_f32_16x16x32_bf16 v[100:103], v[164:167], a[224:227], v[100:103]
    v_cndmask_b32 v15, v116, v117, s[84:85]
    v_cndmask_b32 v15, v15, v118, s[86:87]
    v_cndmask_b32 v15, v15, v119, s[88:89]
    v_mfma_f32_16x16x32_bf16 v[104:107], v[164:167], a[228:231], v[104:107]
    s_add_u32 m0, s71, 53248
    s_sub_u32 s3, s70, 28672
    v_mul_f32 v14, 0xbb124925, v124
    v_mov_b32_dpp v40, v120 row_newbcast:0 row_mask:0xf bank_mask:0xf
    v_mov_b32_dpp v41, v121 row_newbcast:0 row_mask:0xf bank_mask:0xf
    v_mfma_f32_16x16x32_bf16 v[108:111], v[164:167], a[232:235], v[108:111]
    buffer_load_dwordx4 v64, s[16:19], s3 offen lds
    v_mfma_f32_16x16x32_bf16 v[112:115], v[164:167], a[236:239], v[112:115]
    s_waitcnt lgkmcnt(4)
    v_mov_b32_dpp v42, v122 row_newbcast:0 row_mask:0xf bank_mask:0xf
    v_mov_b32_dpp v43, v123 row_newbcast:0 row_mask:0xf bank_mask:0xf
    v_cndmask_b32 v25, v120, v121, s[84:85]
    v_cndmask_b32 v25, v25, v122, s[86:87]
    v_mfma_f32_16x16x32_bf16 v[76:79], v[152:155], a[240:243], v[76:79]
    ds_read_b64_tr_b16 v[164:165], v17 offset:63520
    ds_read_b64_tr_b16 v[166:167], v17 offset:64032
    v_cndmask_b32 v25, v25, v123, s[88:89]
    v_mfma_f32_16x16x32_bf16 v[80:83], v[152:155], a[244:247], v[80:83]
    s_add_u32 m0, s71, 28672
    s_sub_u32 s3, s70, 200704
    v_cndmask_b32 v24, v40, v41, s[84:85]
    v_cndmask_b32 v24, v24, v42, s[86:87]
    v_cndmask_b32 v24, v24, v43, s[88:89]
    v_mfma_f32_16x16x32_bf16 v[84:87], v[152:155], a[248:251], v[84:87]
    buffer_load_dwordx4 v64, s[16:19], s3 offen lds
    v_mfma_f32_16x16x32_bf16 v[88:91], v[152:155], a[252:255], v[88:91]
    v_mul_f32 v24, 0xbb124925, v24
    v_mul_f32 v15, 0x3b124925, v15
    v_fma_f32 v15, -v14, v14, v15
    v_max_f32 v15, 0, v15
    v_mfma_f32_16x16x32_bf16 v[92:95], v[152:155], v[128:131], v[92:95]
    s_waitcnt lgkmcnt(2)
    v_add_f32 v15, 0x3727c5ac, v15
    v_rsq_f32 v15, v15
    v_mfma_f32_16x16x32_bf16 v[76:79], v[160:163], v[132:135], v[76:79]
    s_add_u32 m0, s71, 32768
    s_sub_u32 s3, s70, 172032
    v_mul_f32 v25, 0x3b124925, v25
    v_fma_f32 v25, -v24, v24, v25
    v_max_f32 v25, 0, v25
    v_mfma_f32_16x16x32_bf16 v[80:83], v[160:163], v[136:139], v[80:83]
    buffer_load_dwordx4 v64, s[16:19], s3 offen lds
    v_mfma_f32_16x16x32_bf16 v[84:87], v[160:163], v[140:143], v[84:87]
    v_add_f32 v25, 0x3727c5ac, v25
    v_rsq_f32 v25, v25
    v_mfma_f32_16x16x32_bf16 v[88:91], v[160:163], v[144:147], v[88:91]
    ds_write2_b32 v62, v14, v15 offset0:0 offset1:80
    v_mfma_f32_16x16x32_bf16 v[92:95], v[160:163], v[148:151], v[92:95]
    s_add_u32 m0, s71, 36864
    s_sub_u32 s3, s70, 143360
    ds_write2_b32 v63, v24, v25 offset0:0 offset1:80
    v_mfma_f32_16x16x32_bf16 v[96:99], v[156:159], a[240:243], v[96:99]
    buffer_load_dwordx4 v64, s[16:19], s3 offen lds
    v_mfma_f32_16x16x32_bf16 v[100:103], v[156:159], a[244:247], v[100:103]
    v_mfma_f32_16x16x32_bf16 v[104:107], v[156:159], a[248:251], v[104:107]
    s_waitcnt vmcnt(13)
    s_waitcnt lgkmcnt(0)
    s_barrier
    ds_read2_b32 v[26:27], v29 offset0:16 offset1:32
    ds_read2_b32 v[176:177], v29 offset0:48 offset1:64
    v_mfma_f32_16x16x32_bf16 v[108:111], v[156:159], a[252:255], v[108:111]
    s_add_u32 m0, s71, 40960
    s_sub_u32 s3, s70, 114688
    ds_read_b32 v5, v29
    ds_read_b32 v9, v30 offset:320
    v_mfma_f32_16x16x32_bf16 v[112:115], v[156:159], v[128:131], v[112:115]
    buffer_load_dwordx4 v64, s[16:19], s3 offen lds
    ds_read_b32 v60, v60
    ds_read_b32 v61, v61
    v_mfma_f32_16x16x32_bf16 v[96:99], v[164:167], v[132:135], v[96:99]
    ds_read_b64_tr_b16 v[200:201], v18 offset:0
    ds_read_b64_tr_b16 v[202:203], v18 offset:512
    v_mfma_f32_16x16x32_bf16 v[100:103], v[164:167], v[136:139], v[100:103]
    ds_read_b64_tr_b16 v[204:205], v18 offset:4096
    ds_read_b64_tr_b16 v[206:207], v18 offset:4608
    s_waitcnt lgkmcnt(9)
    v_fmac_f32_dpp v80, v76, v26 row_newbcast:0 row_mask:0xf bank_mask:0xf
    v_mfma_f32_16x16x32_bf16 v[104:107], v[164:167], v[140:143], v[104:107]
    s_add_u32 m0, s71, 0
    s_add_u32 s3, s70, 0
    ds_read_b64_tr_b16 v[208:209], v18 offset:8192
    ds_read_b64_tr_b16 v[210:211], v18 offset:8704
    v_fmac_f32_dpp v81, v77, v26 row_newbcast:0 row_mask:0xf bank_mask:0xf
    v_fmac_f32_dpp v82, v78, v26 row_newbcast:0 row_mask:0xf bank_mask:0xf
    v_mfma_f32_16x16x32_bf16 v[108:111], v[164:167], v[144:147], v[108:111]
    buffer_load_dwordx4 v64, s[16:19], s3 offen lds
    v_mfma_f32_16x16x32_bf16 v[112:115], v[164:167], v[148:151], v[112:115]
    s_waitcnt lgkmcnt(4)
    v_fmac_f32_dpp v83, v79, v26 row_newbcast:0 row_mask:0xf bank_mask:0xf
    v_cvt_pk_bf16_f32 v80, v80, v81
    v_cvt_pk_bf16_f32 v81, v82, v83
    v_mfma_f32_16x16x32_bf16 v[180:183], a[0:3], v[200:203], 0
    s_add_u32 m0, s71, 4096
    s_add_u32 s3, s70, 28672
    ds_write_b64 v56, v[80:81] offset:0
    ds_read_b64_tr_b16 v[212:213], v18 offset:12288
    ds_read_b64_tr_b16 v[214:215], v18 offset:12800
    v_fmac_f32_dpp v84, v76, v27 row_newbcast:0 row_mask:0xf bank_mask:0xf
    v_mfma_f32_16x16x32_bf16 v[184:187], a[4:7], v[200:203], 0
    buffer_load_dwordx4 v64, s[16:19], s3 offen lds
    v_fmac_f32_dpp v85, v77, v27 row_newbcast:0 row_mask:0xf bank_mask:0xf
    v_mfma_f32_16x16x32_bf16 v[188:191], a[8:11], v[200:203], 0
    v_fmac_f32_dpp v86, v78, v27 row_newbcast:0 row_mask:0xf bank_mask:0xf
    v_fmac_f32_dpp v87, v79, v27 row_newbcast:0 row_mask:0xf bank_mask:0xf
    v_cvt_pk_bf16_f32 v84, v84, v85
    v_mfma_f32_16x16x32_bf16 v[192:195], a[12:15], v[200:203], 0
    v_cvt_pk_bf16_f32 v85, v86, v87
    v_fmac_f32_dpp v88, v76, v176 row_newbcast:0 row_mask:0xf bank_mask:0xf
    v_fmac_f32_dpp v89, v77, v176 row_newbcast:0 row_mask:0xf bank_mask:0xf
    v_mfma_f32_16x16x32_bf16 v[196:199], a[16:19], v[200:203], 0
    s_waitcnt lgkmcnt(5)
    s_add_u32 m0, s71, 8192
    s_add_u32 s3, s70, 57344
    ds_write_b64 v56, v[84:85] offset:2176
    v_fmac_f32_dpp v90, v78, v176 row_newbcast:0 row_mask:0xf bank_mask:0xf
    v_fmac_f32_dpp v91, v79, v176 row_newbcast:0 row_mask:0xf bank_mask:0xf
    v_cvt_pk_bf16_f32 v88, v88, v89
    v_mfma_f32_16x16x32_bf16 v[180:183], a[20:23], v[204:207], v[180:183]
    buffer_load_dwordx4 v64, s[16:19], s3 offen lds
    ds_read_b64_tr_b16 v[200:201], v18 offset:16384
    ds_read_b64_tr_b16 v[202:203], v18 offset:16896
    v_mfma_f32_16x16x32_bf16 v[184:187], a[24:27], v[204:207], v[184:187]
    v_cvt_pk_bf16_f32 v89, v90, v91
    v_fmac_f32_dpp v92, v76, v177 row_newbcast:0 row_mask:0xf bank_mask:0xf
    v_mfma_f32_16x16x32_bf16 v[188:191], a[28:31], v[204:207], v[188:191]
    ds_write_b64 v56, v[88:89] offset:4352
    v_fmac_f32_dpp v93, v77, v177 row_newbcast:0 row_mask:0xf bank_mask:0xf
    v_fmac_f32_dpp v94, v78, v177 row_newbcast:0 row_mask:0xf bank_mask:0xf
    v_fmac_f32_dpp v95, v79, v177 row_newbcast:0 row_mask:0xf bank_mask:0xf
    v_cvt_pk_bf16_f32 v92, v92, v93
    v_mfma_f32_16x16x32_bf16 v[192:195], a[32:35], v[204:207], v[192:195]
    s_add_u32 m0, s71, 12288
    s_add_u32 s3, s70, 86016
    v_cvt_pk_bf16_f32 v93, v94, v95
    v_fmac_f32_dpp v100, v96, v26 row_newbcast:0 row_mask:0xf bank_mask:0xf
    v_mfma_f32_16x16x32_bf16 v[196:199], a[36:39], v[204:207], v[196:199]
    s_waitcnt lgkmcnt(7)
    buffer_load_dwordx4 v64, s[16:19], s3 offen lds
    ds_write_b64 v56, v[92:93] offset:6528
    v_fmac_f32_dpp v101, v97, v26 row_newbcast:0 row_mask:0xf bank_mask:0xf
    v_mfma_f32_16x16x32_bf16 v[180:183], a[40:43], v[208:211], v[180:183]
    ds_read_b64_tr_b16 v[204:205], v18 offset:20480
    ds_read_b64_tr_b16 v[206:207], v18 offset:20992
    v_fmac_f32_dpp v102, v98, v26 row_newbcast:0 row_mask:0xf bank_mask:0xf
    v_mfma_f32_16x16x32_bf16 v[184:187], a[44:47], v[208:211], v[184:187]
    v_fmac_f32_dpp v103, v99, v26 row_newbcast:0 row_mask:0xf bank_mask:0xf
    v_cvt_pk_bf16_f32 v100, v100, v101
    v_cvt_pk_bf16_f32 v101, v102, v103
    v_mfma_f32_16x16x32_bf16 v[188:191], a[48:51], v[208:211], v[188:191]
    s_add_u32 m0, s71, 16384
    s_sub_u32 s3, s70, 286720
    ds_write_b64 v56, v[100:101] offset:10880
    v_fmac_f32_dpp v104, v96, v27 row_newbcast:0 row_mask:0xf bank_mask:0xf
    v_fmac_f32_dpp v105, v97, v27 row_newbcast:0 row_mask:0xf bank_mask:0xf
    v_fmac_f32_dpp v106, v98, v27 row_newbcast:0 row_mask:0xf bank_mask:0xf
    v_mfma_f32_16x16x32_bf16 v[192:195], a[52:55], v[208:211], v[192:195]
    buffer_load_dwordx4 v64, s[16:19], s3 offen lds
    v_fmac_f32_dpp v107, v99, v27 row_newbcast:0 row_mask:0xf bank_mask:0xf
    v_mfma_f32_16x16x32_bf16 v[196:199], a[56:59], v[208:211], v[196:199]
    s_waitcnt lgkmcnt(8)
    v_cvt_pk_bf16_f32 v104, v104, v105
    v_cvt_pk_bf16_f32 v105, v106, v107
    v_mfma_f32_16x16x32_bf16 v[180:183], a[60:63], v[212:215], v[180:183]
    ds_write_b64 v56, v[104:105] offset:13056
    ds_read_b64_tr_b16 v[208:209], v18 offset:24576
    ds_read_b64_tr_b16 v[210:211], v18 offset:25088
    v_fmac_f32_dpp v108, v96, v176 row_newbcast:0 row_mask:0xf bank_mask:0xf
    v_fmac_f32_dpp v109, v97, v176 row_newbcast:0 row_mask:0xf bank_mask:0xf
    v_mfma_f32_16x16x32_bf16 v[184:187], a[64:67], v[212:215], v[184:187]
    s_add_u32 m0, s71, 20480
    s_sub_u32 s3, s70, 258048
    v_fmac_f32_dpp v110, v98, v176 row_newbcast:0 row_mask:0xf bank_mask:0xf
    v_fmac_f32_dpp v111, v99, v176 row_newbcast:0 row_mask:0xf bank_mask:0xf
    v_cvt_pk_bf16_f32 v108, v108, v109
    v_mfma_f32_16x16x32_bf16 v[188:191], a[68:71], v[212:215], v[188:191]
    buffer_load_dwordx4 v64, s[16:19], s3 offen lds
    v_cvt_pk_bf16_f32 v109, v110, v111
    v_mfma_f32_16x16x32_bf16 v[192:195], a[72:75], v[212:215], v[192:195]
    ds_write_b64 v56, v[108:109] offset:15232
    v_fmac_f32_dpp v112, v96, v177 row_newbcast:0 row_mask:0xf bank_mask:0xf
    v_fmac_f32_dpp v113, v97, v177 row_newbcast:0 row_mask:0xf bank_mask:0xf
    v_mfma_f32_16x16x32_bf16 v[196:199], a[76:79], v[212:215], v[196:199]
    s_waitcnt lgkmcnt(9)
    v_fmac_f32_dpp v114, v98, v177 row_newbcast:0 row_mask:0xf bank_mask:0xf
    v_fmac_f32_dpp v115, v99, v177 row_newbcast:0 row_mask:0xf bank_mask:0xf
    v_cvt_pk_bf16_f32 v112, v112, v113
    v_cvt_pk_bf16_f32 v113, v114, v115
    v_mfma_f32_16x16x32_bf16 v[180:183], a[80:83], v[200:203], v[180:183]
    ds_read_b64_tr_b16 v[212:213], v18 offset:28672
    ds_read_b64_tr_b16 v[214:215], v18 offset:29184
    ds_write_b64 v56, v[112:113] offset:17408
    v_mfma_f32_16x16x32_bf16 v[184:187], a[84:87], v[200:203], v[184:187]
    v_fmac_f32_dpp v96, v96, v5 row_newbcast:0 row_mask:0xf bank_mask:0xf
    v_fmac_f32_dpp v97, v97, v5 row_newbcast:0 row_mask:0xf bank_mask:0xf
    v_fmac_f32_dpp v98, v98, v5 row_newbcast:0 row_mask:0xf bank_mask:0xf
    v_fmac_f32_dpp v99, v99, v5 row_newbcast:0 row_mask:0xf bank_mask:0xf
    v_mfma_f32_16x16x32_bf16 v[188:191], a[88:91], v[200:203], v[188:191]
    v_cvt_pk_bf16_f32 v96, v96, v97
    v_cvt_pk_bf16_f32 v97, v98, v99
    v_mfma_f32_16x16x32_bf16 v[192:195], a[92:95], v[200:203], v[192:195]
    ds_write_b64 v56, v[96:97] offset:8704
    v_mul_f32 v9, 0x3e8b97f6, v9
    v_mul_f32 v8, v9, v60
    v_mul_f32 v9, v9, v61
    v_mfma_f32_16x16x32_bf16 v[196:199], a[96:99], v[200:203], v[196:199]
    s_waitcnt vmcnt(14)
    s_waitcnt lgkmcnt(0)
    s_barrier
    ds_read_b64 v[24:25], v57 offset:0
    ds_read_b64 v[40:41], v57 offset:8704
    ds_read_b64 v[76:77], v57 offset:10880
    ds_read_b64 v[116:117], v57 offset:64
    ds_read_b64 v[118:119], v57 offset:96
    ds_read_b64 v[120:121], v57 offset:8768
    ds_read_b64 v[122:123], v57 offset:8800
    ds_read_b64 v[124:125], v57 offset:10944
    ds_read_b64 v[126:127], v57 offset:10976
    v_mfma_f32_16x16x32_bf16 v[180:183], a[100:103], v[204:207], v[180:183]
    ds_read_b64_tr_b16 v[200:201], v18 offset:32768
    ds_read_b64_tr_b16 v[202:203], v18 offset:33280
    v_mov_b32 v26, 0
    v_mov_b32 v27, 0
    v_mfma_f32_16x16x32_bf16 v[184:187], a[104:107], v[204:207], v[184:187]
    s_add_u32 m0, s73, 0
    s_add_u32 s3, s72, 0
    v_mov_b32 v42, 0
    v_mov_b32 v43, 0
    v_mov_b32 v78, 0
    v_mov_b32 v79, 0
    v_mov_b32 v89, s68
    v_mfma_f32_16x16x32_bf16 v[188:191], a[108:111], v[204:207], v[188:191]
    buffer_load_dwordx4 v67, s[20:23], s3 offen offset:0 lds
    v_mov_b32 v91, s69
    v_mfma_f32_16x16x32_bf16 v[192:195], a[112:115], v[204:207], v[192:195]
    ds_read_b64 v[92:93], v57 offset:32
    v_mov_b32 v161, s68
    v_mov_b32 v163, s69
    s_waitcnt lgkmcnt(8)
    v_cndmask_b32 v116, v4, v116, s[90:91]
    v_cndmask_b32 v117, v4, v117, s[90:91]
    v_mfma_f32_16x16x32_bf16 v[196:199], a[116:119], v[204:207], v[196:199]
    ds_read_b64 v[94:95], v57 offset:64
    v_mfma_f32_16x16x32_bf16 v[80:83], v[40:43], v[24:27], v[44:47]
    ds_read_b64 v[96:97], v57 offset:8736
    v_mfma_f32_16x16x32_bf16 v[84:87], v[76:79], v[24:27], v[48:51]
    s_waitcnt lgkmcnt(7)
    ds_read_b64 v[98:99], v57 offset:8768
    v_mfma_f32_16x16x32_bf16 v[152:155], v[120:123], v[116:119], v[44:47]
    s_waitcnt lgkmcnt(6)
    ds_read_b64 v[100:101], v57 offset:10912
    v_mfma_f32_16x16x32_bf16 v[156:159], v[124:127], v[116:119], v[48:51]
    buffer_load_dwordx4 v68, s[20:23], s3 offen offset:1024 lds
    ds_read_b64 v[102:103], v57 offset:10944
    v_mfma_f32_16x16x32_bf16 v[180:183], a[120:123], v[208:211], v[180:183]
    ds_read_b64_tr_b16 v[204:205], v18 offset:36864
    ds_read_b64_tr_b16 v[206:207], v18 offset:37376
    v_mfma_f32_16x16x32_bf16 v[184:187], a[124:127], v[208:211], v[184:187]
    v_max3_f32 v88, v80, v81, v84
    v_max3_f32 v90, v82, v83, v86
    v_max_f32 v88, v88, v85
    v_max_f32 v90, v90, v87
    v_mfma_f32_16x16x32_bf16 v[188:191], a[128:131], v[208:211], v[188:191]
    v_max3_f32 v160, v152, v153, v156
    v_max3_f32 v162, v154, v155, v158
    v_max_f32 v160, v160, v157
    v_max_f32 v162, v162, v159
    v_mfma_f32_16x16x32_bf16 v[192:195], a[132:135], v[208:211], v[192:195]
    s_add_u32 s92, s47, 36864
    s_waitcnt lgkmcnt(6)
    v_cndmask_b32 v94, v94, v4, s[90:91]
    v_cndmask_b32 v95, v95, v4, s[90:91]
    v_mfma_f32_16x16x32_bf16 v[196:199], a[136:139], v[208:211], v[196:199]
    s_waitcnt lgkmcnt(4)
    buffer_store_dwordx4 v[88:91], v3, s[40:43], s92 offen sc1
    v_mfma_f32_16x16x32_bf16 v[104:107], v[96:99], v[92:95], v[44:47]
    s_waitcnt lgkmcnt(2)
    buffer_load_dwordx4 v69, s[20:23], s3 offen offset:2048 lds
    s_add_u32 s95, s47, 40960
    buffer_store_dwordx4 v[160:163], v3, s[40:43], s95 offen sc1
    v_mfma_f32_16x16x32_bf16 v[108:111], v[100:103], v[92:95], v[48:51]
    v_mfma_f32_16x16x32_bf16 v[180:183], a[140:143], v[212:215], v[180:183]
    ds_read_b64_tr_b16 v[208:209], v18 offset:40960
    ds_read_b64_tr_b16 v[210:211], v18 offset:41472
    v_mfma_f32_16x16x32_bf16 v[184:187], a[144:147], v[212:215], v[184:187]
    v_mfma_f32_16x16x32_bf16 v[188:191], a[148:151], v[212:215], v[188:191]
    s_nop 2
    v_max3_f32 v112, v104, v105, v108
    v_max3_f32 v114, v106, v107, v110
    v_mfma_f32_16x16x32_bf16 v[192:195], a[152:155], v[212:215], v[192:195]
    v_max_f32 v112, v112, v109
    v_max_f32 v114, v114, v111
    v_mul_f32 v112, v112, v8
    v_mfma_f32_16x16x32_bf16 v[196:199], a[156:159], v[212:215], v[196:199]
    buffer_load_dwordx4 v70, s[20:23], s3 offen offset:3072 lds
    v_mfma_f32_16x16x32_bf16 v[180:183], a[160:163], v[200:203], v[180:183]
    ds_read_b64_tr_b16 v[212:213], v18 offset:45056
    ds_read_b64_tr_b16 v[214:215], v18 offset:45568
    v_mul_f32 v114, v114, v9
    v_mfma_f32_16x16x32_bf16 v[184:187], a[164:167], v[200:203], v[184:187]
    v_max_f32 v104, v112, v114
    v_mov_b32 v105, v104
    v_mfma_f32_16x16x32_bf16 v[188:191], a[168:171], v[200:203], v[188:191]
    s_nop 0
    v_permlane16_swap_b32 v104, v105
    v_max_f32 v104, v104, v105
    v_mov_b32 v105, v104
    v_mfma_f32_16x16x32_bf16 v[192:195], a[172:175], v[200:203], v[192:195]
    s_nop 0
    v_permlane32_swap_b32 v104, v105
    v_max_f32 v104, v104, v105
    v_mfma_f32_16x16x32_bf16 v[196:199], a[176:179], v[200:203], v[196:199]
    s_waitcnt lgkmcnt(4)
    s_add_u32 m0, s73, 16384
    s_add_u32 s3, s72, 229376
    v_sub_f32 v112, v112, v104
    v_sub_f32 v114, v114, v104
    v_mfma_f32_16x16x32_bf16 v[180:183], a[180:183], v[204:207], v[180:183]
    buffer_load_dwordx4 v67, s[20:23], s3 offen offset:0 lds
    ds_read_b64_tr_b16 v[200:201], v18 offset:49152
    ds_read_b64_tr_b16 v[202:203], v18 offset:49664
    v_mfma_f32_16x16x32_bf16 v[184:187], a[184:187], v[204:207], v[184:187]
    v_exp_f32 v112, v112
    v_mfma_f32_16x16x32_bf16 v[188:191], a[188:191], v[204:207], v[188:191]
    v_exp_f32 v114, v114
    s_nop 0
    v_add_f32 v104, v112, v114
    v_mfma_f32_16x16x32_bf16 v[192:195], a[192:195], v[204:207], v[192:195]
    v_mov_b32 v105, v104
    v_mul_f32 v112, v112, v60
    v_mfma_f32_16x16x32_bf16 v[196:199], a[196:199], v[204:207], v[196:199]
    s_waitcnt lgkmcnt(4)
    v_mul_f32 v114, v114, v61
    v_permlane16_swap_b32 v104, v105
    v_add_f32 v104, v104, v105
    v_mfma_f32_16x16x32_bf16 v[180:183], a[200:203], v[208:211], v[180:183]
    ds_read_b64_tr_b16 v[204:205], v18 offset:53248
    ds_read_b64_tr_b16 v[206:207], v18 offset:53760
    v_mfma_f32_16x16x32_bf16 v[184:187], a[204:207], v[208:211], v[184:187]
    buffer_load_dwordx4 v68, s[20:23], s3 offen offset:1024 lds
    v_mov_b32 v105, v104
    v_mfma_f32_16x16x32_bf16 v[188:191], a[208:211], v[208:211], v[188:191]
    s_nop 0
    v_permlane32_swap_b32 v104, v105
    v_add_f32 v104, v104, v105
    v_mfma_f32_16x16x32_bf16 v[192:195], a[212:215], v[208:211], v[192:195]
Lst13:
Lv5_1:
Lv5_2:
    s_cbranch_execz Lback
    v_rcp_f32 v104, v104
    s_nop 0
    v_mul_f32 v112, v112, v104
    v_mfma_f32_16x16x32_bf16 v[196:199], a[216:219], v[208:211], v[196:199]
    s_waitcnt lgkmcnt(4)
    ds_read_b128 v[76:79], v31 offset:0
    v_mul_f32 v114, v114, v104
    v_mfma_f32_16x16x32_bf16 v[180:183], a[220:223], v[212:215], v[180:183]
    s_waitcnt lgkmcnt(3)
    ds_read_b128 v[100:103], v31 offset:64
    v_cvt_pk_bf16_f32 v112, v112, v112
    v_cvt_pk_bf16_f32 v114, v114, v114
    v_mfma_f32_16x16x32_bf16 v[180:183], a[240:243], v[200:203], v[180:183]
    s_waitcnt lgkmcnt(2)
    ds_read_b128 v[124:127], v31 offset:128
    v_and_b32 v92, v112, v52
    v_mfma_f32_16x16x32_bf16 v[180:183], v[132:135], v[204:207], v[180:183]
    buffer_load_dwordx4 v69, s[20:23], s3 offen offset:2048 lds
    ds_read_b128 v[84:87], v31 offset:192
    v_mfma_f32_16x16x32_bf16 v[184:187], a[224:227], v[212:215], v[184:187]
    ds_read_b128 v[108:111], v31 offset:256
    v_and_b32 v93, v114, v53
    v_mfma_f32_16x16x32_bf16 v[184:187], a[244:247], v[200:203], v[184:187]
    v_and_b32 v94, v112, v54
    v_and_b32 v95, v114, v55
    v_mfma_f32_16x16x32_bf16 v[184:187], v[136:139], v[204:207], v[184:187]
    v_mfma_f32_16x16x32_bf16 v[188:191], a[228:231], v[212:215], v[188:191]
    v_mov_b32 v14, v180
    v_mov_b32 v15, v180
    v_mfma_f32_16x16x32_bf16 v[188:191], a[248:251], v[200:203], v[188:191]
    s_nop 0
    v_permlane16_swap_b32 v14, v15
    v_mov_b32 v15, v14
    s_nop 1
    v_permlane32_swap_b32 v14, v15
    v_mfma_f32_16x16x32_bf16 v[188:191], v[140:143], v[204:207], v[188:191]
    buffer_load_dwordx4 v70, s[20:23], s3 offen offset:3072 lds
    v_mfma_f32_16x16x32_bf16 v[192:195], a[232:235], v[212:215], v[192:195]
    s_waitcnt lgkmcnt(4)
    v_fmac_f32 v180, v76, v14
    v_fmac_f32 v181, v77, v14
    v_fmac_f32 v182, v78, v14
    v_mfma_f32_16x16x32_bf16 v[192:195], a[252:255], v[200:203], v[192:195]
    v_fmac_f32 v183, v79, v14
    v_cvt_pk_bf16_f32 v180, v180, v181
    v_mfma_f32_16x16x32_bf16 v[192:195], v[144:147], v[204:207], v[192:195]
    v_cvt_pk_bf16_f32 v181, v182, v183
    s_waitcnt lgkmcnt(3)
    v_fmac_f32 v184, v100, v14
    v_mfma_f32_16x16x32_bf16 v[196:199], a[236:239], v[212:215], v[196:199]
    ds_write_b64 v58, v[180:181] offset:0
    v_fmac_f32 v185, v101, v14
    v_fmac_f32 v186, v102, v14
    v_mfma_f32_16x16x32_bf16 v[196:199], v[128:131], v[200:203], v[196:199]
    v_fmac_f32 v187, v103, v14
    v_cvt_pk_bf16_f32 v184, v184, v185
    v_cvt_pk_bf16_f32 v185, v186, v187
    v_mfma_f32_16x16x32_bf16 v[196:199], v[148:151], v[204:207], v[196:199]
    ds_write_b64 v58, v[184:185] offset:512
    s_waitcnt lgkmcnt(4)
    v_fmac_f32 v188, v124, v14
    v_fmac_f32 v189, v125, v14
    v_fmac_f32 v190, v126, v14
    v_fmac_f32 v191, v127, v14
    v_cvt_pk_bf16_f32 v188, v188, v189
    v_cvt_pk_bf16_f32 v189, v190, v191
    ds_write_b64 v58, v[188:189] offset:1024
    s_waitcnt lgkmcnt(4)
    v_pk_fma_f32 v[192:193], v[84:85], v[14:15], v[192:193] op_sel_hi:[1,0,1]
    v_pk_fma_f32 v[194:195], v[86:87], v[14:15], v[194:195] op_sel_hi:[1,0,1]
    v_cvt_pk_bf16_f32 v192, v192, v193
    v_cvt_pk_bf16_f32 v193, v194, v195
    ds_write_b64 v58, v[192:193] offset:1536
    s_waitcnt lgkmcnt(4)
    v_pk_fma_f32 v[196:197], v[108:109], v[14:15], v[196:197] op_sel_hi:[1,0,1]
    v_pk_fma_f32 v[198:199], v[110:111], v[14:15], v[198:199] op_sel_hi:[1,0,1]
    v_cvt_pk_bf16_f32 v196, v196, v197
    v_cvt_pk_bf16_f32 v197, v198, v199
    ds_write_b64 v58, v[196:197] offset:2048
    s_waitcnt vmcnt(10)
    s_waitcnt lgkmcnt(0)
    s_barrier
    s_add_u32 m0, s73, 32768
    s_add_u32 s3, s72, 458752
    buffer_load_dwordx4 v67, s[20:23], s3 offen offset:0 lds
    ds_read_b64 v[76:77], v59 offset:0
    ds_read_b64 v[78:79], v59 offset:512
    ds_read_b64 v[100:101], v59 offset:2560
    ds_read_b64 v[102:103], v59 offset:3072
    ds_read_b64 v[124:125], v59 offset:5120
    ds_read_b64 v[126:127], v59 offset:5632
    ds_read_b64 v[84:85], v59 offset:7680
    buffer_load_dwordx4 v68, s[20:23], s3 offen offset:1024 lds
    ds_read_b64 v[86:87], v59 offset:8192
    s_waitcnt vmcnt(7)
    s_add_u32 s93, s47, 32768
    buffer_load_dwordx4 v[40:43], v3, s[40:43], s93 offen sc1
    s_add_u32 s94, s47, 45056
    buffer_load_dwordx4 v[120:123], v3, s[40:43], s94 offen sc1
    s_waitcnt lgkmcnt(4)
    v_mfma_f32_16x16x32_bf16 v[208:211], v[100:103], v[92:95], 0
    s_waitcnt lgkmcnt(2)
    ds_read_b64_tr_b16 a[0:1], v71 offset:0
    ds_read_b64_tr_b16 a[2:3], v71 offset:2048
    v_mfma_f32_16x16x32_bf16 v[204:207], v[124:127], v[92:95], 0
    ds_read_b64_tr_b16 a[4:5], v72 offset:0
    ds_read_b64_tr_b16 a[6:7], v72 offset:2048
    ds_read_b64_tr_b16 a[8:9], v73 offset:0
    ds_read_b64_tr_b16 a[10:11], v73 offset:2048
    ds_read_b64_tr_b16 a[12:13], v74 offset:0
    ds_read_b64_tr_b16 a[14:15], v74 offset:2048
    ds_read_b64_tr_b16 a[16:17], v71 offset:4096
    ds_read_b64_tr_b16 a[18:19], v71 offset:6144
    ds_read_b64_tr_b16 a[20:21], v72 offset:4096
    ds_read_b64_tr_b16 a[22:23], v72 offset:6144
    ds_read_b64_tr_b16 a[24:25], v73 offset:4096
    ds_read_b64_tr_b16 a[26:27], v73 offset:6144
    ds_read_b64_tr_b16 a[28:29], v74 offset:4096
    ds_read_b64_tr_b16 a[30:31], v74 offset:6144
    ds_read_b64_tr_b16 a[32:33], v71 offset:8192
    ds_read_b64_tr_b16 a[34:35], v71 offset:10240
    buffer_load_dwordx4 v69, s[20:23], s3 offen offset:2048 lds
    ds_read_b64_tr_b16 a[36:37], v72 offset:8192
    ds_read_b64_tr_b16 a[38:39], v72 offset:10240
    ds_read_b64_tr_b16 a[40:41], v73 offset:8192
    ds_read_b64_tr_b16 a[42:43], v73 offset:10240
    ds_read_b64_tr_b16 a[44:45], v74 offset:8192
    ds_read_b64_tr_b16 a[46:47], v74 offset:10240
    ds_read_b64_tr_b16 a[48:49], v71 offset:12288
    ds_read_b64_tr_b16 a[50:51], v71 offset:14336
    ds_read_b64_tr_b16 a[52:53], v72 offset:12288
    buffer_load_dwordx4 v70, s[20:23], s3 offen offset:3072 lds
    ds_read_b64_tr_b16 a[54:55], v72 offset:14336
    ds_read_b64_tr_b16 a[56:57], v73 offset:12288
    ds_read_b64_tr_b16 a[58:59], v73 offset:14336
    ds_read_b64_tr_b16 a[60:61], v74 offset:12288
    ds_read_b64_tr_b16 a[62:63], v74 offset:14336
    ds_read_b64_tr_b16 a[64:65], v71 offset:16384
    ds_read_b64_tr_b16 a[66:67], v71 offset:18432
    ds_read_b64_tr_b16 a[68:69], v72 offset:16384
    s_add_u32 m0, s73, 49152
    s_add_u32 s3, s72, 688128
    buffer_load_dwordx4 v67, s[20:23], s3 offen offset:0 lds
    ds_read_b64_tr_b16 a[70:71], v72 offset:18432
    ds_read_b64_tr_b16 a[72:73], v73 offset:16384
    ds_read_b64_tr_b16 a[74:75], v73 offset:18432
    ds_read_b64_tr_b16 a[76:77], v74 offset:16384
    ds_read_b64_tr_b16 a[78:79], v74 offset:18432
    ds_read_b64_tr_b16 a[80:81], v71 offset:20480
    ds_read_b64_tr_b16 a[82:83], v71 offset:22528
    ds_read_b64_tr_b16 a[84:85], v72 offset:20480
    buffer_load_dwordx4 v68, s[20:23], s3 offen offset:1024 lds
    ds_read_b64_tr_b16 a[86:87], v72 offset:22528
    ds_read_b64_tr_b16 a[88:89], v73 offset:20480
    ds_read_b64_tr_b16 a[90:91], v73 offset:22528
    ds_read_b64_tr_b16 a[92:93], v74 offset:20480
    ds_read_b64_tr_b16 a[94:95], v74 offset:22528
    v_cvt_pk_bf16_f32 v170, v208, v209
    v_cvt_pk_bf16_f32 v171, v210, v211
    v_cvt_pk_bf16_f32 v172, v204, v205
    v_cvt_pk_bf16_f32 v173, v206, v207
    buffer_load_dwordx4 v69, s[20:23], s3 offen offset:2048 lds
    buffer_load_dwordx4 v70, s[20:23], s3 offen offset:3072 lds
    s_add_u32 m0, s73, 65536
    s_add_u32 s3, s72, 917504
    buffer_load_dwordx4 v67, s[20:23], s3 offen offset:0 lds
    s_waitcnt vmcnt(8)
    v_cmp_ne_u32 vcc, s68, v41
    v_cmp_ne_u32 s[6:7], s69, v43
    s_nop 0
    s_or_b64 vcc, vcc, s[6:7]
    s_waitcnt vmcnt(7)
    v_cmp_ne_u32 s[4:5], s68, v121
    v_cmp_ne_u32 s[6:7], s69, v123
    s_or_b64 vcc, vcc, s[4:5]
    s_or_b64 vcc, vcc, s[6:7]
    s_cbranch_scc1 Lxd_26
Lxk_24:
    buffer_load_dwordx4 v68, s[20:23], s3 offen offset:1024 lds
    v_add_f32 v88, v88, v40
    v_add_f32 v90, v90, v42
    v_add_f32 v160, v160, v120
    v_add_f32 v162, v162, v122
    v_mul_f32 v88, v88, v8
    v_mul_f32 v90, v90, v9
    v_max_f32 v80, v88, v90
    v_mul_f32 v160, v160, v8
    v_mul_f32 v162, v162, v9
    v_max_f32 v152, v160, v162
    s_nop 1
    v_permlane16_swap_b32 v80, v152
    v_max_f32 v80, v80, v152
    v_mov_b32 v152, v80
    s_nop 1
    v_permlane32_swap_b32 v80, v152
    buffer_load_dwordx4 v69, s[20:23], s3 offen offset:2048 lds
    v_max_f32 v80, v80, v152
    v_mov_b32 v152, v80
    s_nop 1
    v_permlane16_swap_b32 v80, v152
    v_sub_f32 v88, v88, v80
    v_sub_f32 v90, v90, v80
    v_sub_f32 v160, v160, v152
    v_sub_f32 v162, v162, v152
    v_exp_f32 v88, v88
    v_exp_f32 v90, v90
    v_exp_f32 v160, v160
    v_exp_f32 v162, v162
    v_add_f32 v80, v88, v90
    v_add_f32 v152, v160, v162
    buffer_load_dwordx4 v70, s[20:23], s3 offen offset:3072 lds
    v_mul_f32 v88, v88, v60
    v_mul_f32 v90, v90, v61
    v_permlane16_swap_b32 v80, v152
    v_add_f32 v80, v80, v152
    v_mov_b32 v152, v80
    v_mul_f32 v160, v160, v60
    v_mul_f32 v162, v162, v61
    v_permlane32_swap_b32 v80, v152
    v_add_f32 v80, v80, v152
    v_mov_b32 v152, v80
    s_nop 1
    v_permlane16_swap_b32 v80, v152
    v_rcp_f32 v80, v80
    v_rcp_f32 v152, v152
    v_mul_f32 v88, v88, v80
    v_mul_f32 v90, v90, v80
    v_cvt_pk_bf16_f32 v88, v88, v88
    v_cvt_pk_bf16_f32 v90, v90, v90
    v_and_b32 v24, v88, v52
    v_and_b32 v25, v90, v53
    v_and_b32 v26, v88, v54
    v_and_b32 v27, v90, v55
    s_nop 1
    v_mfma_f32_16x16x32_bf16 v[212:215], v[76:79], v[24:27], 0
    v_mul_f32 v160, v160, v152
    v_mul_f32 v162, v162, v152
    v_cvt_pk_bf16_f32 v160, v160, v160
    v_cvt_pk_bf16_f32 v162, v162, v162
    v_and_b32 v116, v160, v52
    v_and_b32 v117, v162, v53
    v_and_b32 v118, v160, v54
    v_and_b32 v119, v162, v55
    s_nop 1
    v_mfma_f32_16x16x32_bf16 v[200:203], v[124:127], v[116:119], 0
    s_waitcnt lgkmcnt(15)
    v_mfma_f32_16x16x32_bf16 v[108:111], v[84:87], v[116:119], 0
    v_cvt_pk_bf16_f32 v168, v212, v213
    v_cvt_pk_bf16_f32 v169, v214, v215
    s_nop 3
    v_cvt_pk_bf16_f32 v200, v200, v201
    v_cvt_pk_bf16_f32 v201, v202, v203
    v_cvt_pk_bf16_f32 v174, v108, v109
    v_cvt_pk_bf16_f32 v175, v110, v111
    v_cndmask_b32 v172, v172, v200, s[90:91]
    v_cndmask_b32 v173, v173, v201, s[90:91]
    buffer_store_dwordx4 v[168:171], v3, s[40:43], s48 offen offset:0 sc1
    buffer_store_dwordx4 v[172:175], v3, s[40:43], s48 offen offset:1024 sc1
    s_waitcnt lgkmcnt(0)
    s_barrier
    s_mul_i32 s52, s65, 512
    s_add_u32 s52, s52, 507904
    s_mul_i32 s49, s66, 64
    s_add_u32 s49, s49, s52
    s_mul_i32 s50, s65, 128
    s_mul_i32 s95, s66, 8
    s_add_u32 s50, s50, s95
    s_add_u32 s50, s50, 512000
    s_mul_i32 s45, s67, 11264
    s_add_u32 s45, s45, 114688
    s_mul_i32 s0, s67, 7168
    v_min_u32 v5, 6, v2
    v_lshlrev_b32 v8, 3, v5
    v_mul_u32_u24 v5, 64, v5
    v_add_u32 v9, 1, v2
    v_lshrrev_b32 v9, 2, v9
    v_min_u32 v9, 1, v9
    v_lshlrev_b32 v9, 20, v9
    v_add_lshl_u32 v9, v9, v2, 10
    v_min_u32 v10, 1, v2
    v_lshlrev_b32 v10, 30, v10
    v_bfe_u32 v14, v2, 4, 1
    v_lshlrev_b32 v25, 5, v14
    v_and_b32 v14, 3, v2
    v_lshl_add_u32 v25, v14, 3, v25
    v_bfe_u32 v11, v2, 2, 2
    v_lshrrev_b32 v14, 5, v2
    v_lshl_add_u32 v14, v14, 2, v11
    v_xor_b32 v11, s67, v11
    s_add_u32 m0, s73, 81920
    s_add_u32 s3, s72, 1146880
    buffer_load_dwordx4 v67, s[20:23], s3 offen offset:0 lds
    v_lshl_add_u32 v11, v11, 6, v25
    v_lshl_add_u32 v19, v14, 8, v11
    v_add_u32 v24, 57344, v19
    v_lshl_add_u32 v11, v14, 7, v25
    v_bfe_u32 v14, v2, 3, 1
    v_lshl_add_u32 v11, v14, 6, v11
    v_xor_b32 v14, 64, v11
    v_add_u32 v15, s45, v11
    v_add_u32 v16, s45, v14
    v_add_u32 v17, s0, v11
    v_add_u32 v18, s0, v14
    s_mul_i32 s92, s96, 256
    s_mul_i32 s95, s67, 64
    s_add_u32 s92, s92, s95
    v_and_b32 v11, 31, v2
    buffer_load_dwordx4 v68, s[20:23], s3 offen offset:1024 lds
    v_lshl_add_u32 v26, v11, 1, s92
    s_lshl_b32 s93, s66, 7
    v_and_b32 v14, 0x70, v3
    v_add_u32 v28, s93, v14
    ds_read_b64_tr_b16 a[96:97], v71 offset:24576
    ds_read_b64_tr_b16 a[98:99], v71 offset:26624
    s_lshr_b32 s93, s67, 1
    ds_read_b64_tr_b16 a[100:101], v72 offset:24576
    s_and_b32 s94, s67, 1
    ds_read_b64_tr_b16 a[102:103], v72 offset:26624
    s_mul_i32 s55, s65, 57344
    ds_read_b64_tr_b16 a[104:105], v73 offset:24576
    buffer_load_dwordx4 v69, s[20:23], s3 offen offset:2048 lds
    s_mul_i32 s95, s93, 28672
    ds_read_b64_tr_b16 a[106:107], v73 offset:26624
    s_add_u32 s55, s55, s95
    ds_read_b64_tr_b16 a[108:109], v74 offset:24576
    ds_read_b64_tr_b16 a[110:111], v74 offset:26624
    s_mul_i32 s95, s66, 4096
    ds_read_b64_tr_b16 a[112:113], v71 offset:28672
    s_add_u32 s55, s55, s95
    ds_read_b64_tr_b16 a[114:115], v71 offset:30720
    s_mul_i32 s95, s94, 256
    ds_read_b64_tr_b16 a[116:117], v72 offset:28672
    buffer_load_dwordx4 v70, s[20:23], s3 offen offset:3072 lds
    s_add_u32 s55, s55, s95
    ds_read_b64_tr_b16 a[118:119], v72 offset:30720
    s_add_u32 s55, s55, 262144
    ds_read_b64_tr_b16 a[120:121], v73 offset:28672
    ds_read_b64_tr_b16 a[122:123], v73 offset:30720
    s_mul_i32 s56, s65, 4096
    ds_read_b64_tr_b16 a[124:125], v74 offset:28672
    s_mul_i32 s95, s93, 2048
    ds_read_b64_tr_b16 a[126:127], v74 offset:30720
    s_add_u32 s56, s56, s95
    ds_read_b64_tr_b16 a[128:129], v71 offset:32768
    buffer_load_ushort v26, v26, s[28:31], 0 offen
    s_mul_i32 s95, s66, 256
    ds_read_b64_tr_b16 a[130:131], v71 offset:34816
    s_add_u32 s56, s56, s95
    ds_read_b64_tr_b16 a[132:133], v72 offset:32768
    s_mul_i32 s95, s94, 128
    ds_read_b64_tr_b16 a[134:135], v72 offset:34816
    ds_read_b64_tr_b16 a[136:137], v73 offset:32768
    s_add_u32 s56, s56, s95
    ds_read_b64_tr_b16 a[138:139], v73 offset:34816
    s_add_u32 s56, s56, 491520
    ds_read_b64_tr_b16 a[140:141], v74 offset:32768
    buffer_load_dwordx4 v[28:31], v28, s[32:35], 0 offen
    s_and_b32 s92, s65, 1
    ds_read_b64_tr_b16 a[142:143], v74 offset:34816
    s_xor_b32 s93, s92, 1
    ds_read_b64_tr_b16 a[144:145], v71 offset:36864
    s_mul_i32 s94, s67, 14336
    ds_read_b64_tr_b16 a[146:147], v71 offset:38912
    ds_read_b64_tr_b16 a[148:149], v72 offset:36864
    s_mul_i32 s95, s66, 128
    ds_read_b64_tr_b16 a[150:151], v72 offset:38912
    s_add_u32 s94, s94, s95
    ds_read_b64_tr_b16 a[152:153], v73 offset:36864
    s_mul_i32 s44, s92, 114688
    ds_read_b64_tr_b16 a[154:155], v73 offset:38912
    s_add_u32 s44, s44, s94
    ds_read_b64_tr_b16 a[156:157], v74 offset:36864
    s_mul_i32 s74, s93, 114688
    ds_read_b64_tr_b16 a[158:159], v74 offset:38912
    s_add_u32 s74, s74, s94
    v_lshlrev_b32 v164, 16, v32
    v_and_b32 v165, 0xffff0000, v32
    v_lshlrev_b32 v166, 16, v33
    v_and_b32 v167, 0xffff0000, v33
    v_lshlrev_b32 v176, 16, v34
    v_and_b32 v177, 0xffff0000, v34
    v_lshlrev_b32 v178, 16, v35
    v_and_b32 v179, 0xffff0000, v35
    v_lshlrev_b32 v180, 16, v36
    v_and_b32 v181, 0xffff0000, v36
    v_lshlrev_b32 v182, 16, v37
    v_and_b32 v183, 0xffff0000, v37
    v_lshlrev_b32 v184, 16, v38
    v_and_b32 v185, 0xffff0000, v38
    v_lshlrev_b32 v186, 16, v39
    v_and_b32 v187, 0xffff0000, v39
    v_and_b32 v14, 15, v2
    v_lshlrev_b32 v14, 3, v14
    v_lshrrev_b32 v11, 4, v2
    v_lshlrev_b32 v11, 9, v11
    v_lshl_add_u32 v11, v14, 1, v11
    s_waitcnt vmcnt(6)
    s_barrier
    s_cmp_lg_u32 s67, 0
    s_cbranch_scc1 Lg_27
    buffer_store_dwordx2 v[6:7], v10, s[40:43], s49 offen
Lg_27:
    s_branch Ljoin
Lvar6:
Lst14:
    s_cbranch_execz Lback
    s_waitcnt vmcnt(16)
    s_waitcnt lgkmcnt(0)
    s_barrier
    ds_read_b64_tr_b16 v[152:153], v17 offset:53280
    ds_read_b64_tr_b16 v[154:155], v17 offset:53792
    ds_read_b64_tr_b16 v[156:157], v17 offset:55328
    ds_read_b64_tr_b16 v[158:159], v17 offset:55840
    s_add_u32 m0, s71, 49152
    s_sub_u32 s3, s70, 57344
    v_mfma_f32_16x16x32_bf16 v[96:99], v[164:167], a[220:223], v[96:99]
    s_nop 3
    buffer_load_dwordx4 v64, s[16:19], s3 offen lds
    ds_read_b64_tr_b16 v[160:161], v17 offset:61472
    ds_read_b64_tr_b16 v[162:163], v17 offset:61984
    v_mfma_f32_16x16x32_bf16 v[100:103], v[164:167], a[224:227], v[100:103]
    v_cndmask_b32 v15, v116, v117, s[84:85]
    v_cndmask_b32 v15, v15, v118, s[86:87]
    v_cndmask_b32 v15, v15, v119, s[88:89]
    v_mfma_f32_16x16x32_bf16 v[104:107], v[164:167], a[228:231], v[104:107]
    s_add_u32 m0, s71, 53248
    s_sub_u32 s3, s70, 28672
    v_mul_f32 v14, 0xbb124925, v124
    v_mov_b32_dpp v40, v120 row_newbcast:0 row_mask:0xf bank_mask:0xf
    v_mov_b32_dpp v41, v121 row_newbcast:0 row_mask:0xf bank_mask:0xf
    v_mfma_f32_16x16x32_bf16 v[108:111], v[164:167], a[232:235], v[108:111]
    buffer_load_dwordx4 v64, s[16:19], s3 offen lds
    v_mfma_f32_16x16x32_bf16 v[112:115], v[164:167], a[236:239], v[112:115]
    s_waitcnt lgkmcnt(4)
    v_mov_b32_dpp v42, v122 row_newbcast:0 row_mask:0xf bank_mask:0xf
    v_mov_b32_dpp v43, v123 row_newbcast:0 row_mask:0xf bank_mask:0xf
    v_cndmask_b32 v25, v120, v121, s[84:85]
    v_cndmask_b32 v25, v25, v122, s[86:87]
    v_mfma_f32_16x16x32_bf16 v[76:79], v[152:155], a[240:243], v[76:79]
    ds_read_b64_tr_b16 v[164:165], v17 offset:63520
    ds_read_b64_tr_b16 v[166:167], v17 offset:64032
    v_cndmask_b32 v25, v25, v123, s[88:89]
    v_mfma_f32_16x16x32_bf16 v[80:83], v[152:155], a[244:247], v[80:83]
    s_add_u32 m0, s71, 28672
    s_sub_u32 s3, s70, 200704
    v_cndmask_b32 v24, v40, v41, s[84:85]
    v_cndmask_b32 v24, v24, v42, s[86:87]
    v_cndmask_b32 v24, v24, v43, s[88:89]
    v_mfma_f32_16x16x32_bf16 v[84:87], v[152:155], a[248:251], v[84:87]
    buffer_load_dwordx4 v64, s[16:19], s3 offen lds
    v_mfma_f32_16x16x32_bf16 v[88:91], v[152:155], a[252:255], v[88:91]
    v_mul_f32 v24, 0xbb124925, v24
    v_mul_f32 v15, 0x3b124925, v15
    v_fma_f32 v15, -v14, v14, v15
    v_max_f32 v15, 0, v15
    v_mfma_f32_16x16x32_bf16 v[92:95], v[152:155], v[128:131], v[92:95]
    s_waitcnt lgkmcnt(2)
    v_add_f32 v15, 0x3727c5ac, v15
    v_rsq_f32 v15, v15
    v_mfma_f32_16x16x32_bf16 v[76:79], v[160:163], v[132:135], v[76:79]
    s_add_u32 m0, s71, 32768
    s_sub_u32 s3, s70, 172032
    v_mul_f32 v25, 0x3b124925, v25
    v_fma_f32 v25, -v24, v24, v25
    v_max_f32 v25, 0, v25
    v_mfma_f32_16x16x32_bf16 v[80:83], v[160:163], v[136:139], v[80:83]
    buffer_load_dwordx4 v64, s[16:19], s3 offen lds
    v_mfma_f32_16x16x32_bf16 v[84:87], v[160:163], v[140:143], v[84:87]
    v_add_f32 v25, 0x3727c5ac, v25
    v_rsq_f32 v25, v25
    v_mfma_f32_16x16x32_bf16 v[88:91], v[160:163], v[144:147], v[88:91]
    ds_write2_b32 v62, v14, v15 offset0:0 offset1:80
    v_mfma_f32_16x16x32_bf16 v[92:95], v[160:163], v[148:151], v[92:95]
    s_add_u32 m0, s71, 36864
    s_sub_u32 s3, s70, 143360
    ds_write2_b32 v63, v24, v25 offset0:0 offset1:80
    v_mfma_f32_16x16x32_bf16 v[96:99], v[156:159], a[240:243], v[96:99]
    buffer_load_dwordx4 v64, s[16:19], s3 offen lds
    v_mfma_f32_16x16x32_bf16 v[100:103], v[156:159], a[244:247], v[100:103]
    v_mfma_f32_16x16x32_bf16 v[104:107], v[156:159], a[248:251], v[104:107]
    s_waitcnt vmcnt(13)
    s_waitcnt lgkmcnt(0)
    s_barrier
    ds_read2_b32 v[26:27], v29 offset0:16 offset1:32
    ds_read2_b32 v[176:177], v29 offset0:48 offset1:64
    v_mfma_f32_16x16x32_bf16 v[108:111], v[156:159], a[252:255], v[108:111]
    s_add_u32 m0, s71, 40960
    s_sub_u32 s3, s70, 114688
    ds_read_b32 v5, v29
    ds_read_b32 v9, v30 offset:320
    v_mfma_f32_16x16x32_bf16 v[112:115], v[156:159], v[128:131], v[112:115]
    buffer_load_dwordx4 v64, s[16:19], s3 offen lds
    ds_read_b32 v60, v60
    ds_read_b32 v61, v61
    v_mfma_f32_16x16x32_bf16 v[96:99], v[164:167], v[132:135], v[96:99]
    ds_read_b64_tr_b16 v[200:201], v18 offset:0
    ds_read_b64_tr_b16 v[202:203], v18 offset:512
    v_mfma_f32_16x16x32_bf16 v[100:103], v[164:167], v[136:139], v[100:103]
    ds_read_b64_tr_b16 v[204:205], v18 offset:4096
    ds_read_b64_tr_b16 v[206:207], v18 offset:4608
    s_waitcnt lgkmcnt(9)
    v_fmac_f32_dpp v80, v76, v26 row_newbcast:0 row_mask:0xf bank_mask:0xf
    v_mfma_f32_16x16x32_bf16 v[104:107], v[164:167], v[140:143], v[104:107]
    s_add_u32 m0, s71, 0
    s_add_u32 s3, s70, 0
    ds_read_b64_tr_b16 v[208:209], v18 offset:8192
    ds_read_b64_tr_b16 v[210:211], v18 offset:8704
    v_fmac_f32_dpp v81, v77, v26 row_newbcast:0 row_mask:0xf bank_mask:0xf
    v_fmac_f32_dpp v82, v78, v26 row_newbcast:0 row_mask:0xf bank_mask:0xf
    v_mfma_f32_16x16x32_bf16 v[108:111], v[164:167], v[144:147], v[108:111]
    buffer_load_dwordx4 v64, s[16:19], s3 offen lds
    v_mfma_f32_16x16x32_bf16 v[112:115], v[164:167], v[148:151], v[112:115]
    s_waitcnt lgkmcnt(4)
    v_fmac_f32_dpp v83, v79, v26 row_newbcast:0 row_mask:0xf bank_mask:0xf
    v_cvt_pk_bf16_f32 v80, v80, v81
    v_cvt_pk_bf16_f32 v81, v82, v83
    v_mfma_f32_16x16x32_bf16 v[180:183], a[0:3], v[200:203], 0
    s_add_u32 m0, s71, 4096
    s_add_u32 s3, s70, 28672
    ds_write_b64 v56, v[80:81] offset:0
    ds_read_b64_tr_b16 v[212:213], v18 offset:12288
    ds_read_b64_tr_b16 v[214:215], v18 offset:12800
    v_fmac_f32_dpp v84, v76, v27 row_newbcast:0 row_mask:0xf bank_mask:0xf
    v_mfma_f32_16x16x32_bf16 v[184:187], a[4:7], v[200:203], 0
    buffer_load_dwordx4 v64, s[16:19], s3 offen lds
    v_fmac_f32_dpp v85, v77, v27 row_newbcast:0 row_mask:0xf bank_mask:0xf
    v_mfma_f32_16x16x32_bf16 v[188:191], a[8:11], v[200:203], 0
    v_fmac_f32_dpp v86, v78, v27 row_newbcast:0 row_mask:0xf bank_mask:0xf
    v_fmac_f32_dpp v87, v79, v27 row_newbcast:0 row_mask:0xf bank_mask:0xf
    v_cvt_pk_bf16_f32 v84, v84, v85
    v_mfma_f32_16x16x32_bf16 v[192:195], a[12:15], v[200:203], 0
    v_cvt_pk_bf16_f32 v85, v86, v87
    v_fmac_f32_dpp v88, v76, v176 row_newbcast:0 row_mask:0xf bank_mask:0xf
    v_fmac_f32_dpp v89, v77, v176 row_newbcast:0 row_mask:0xf bank_mask:0xf
    v_mfma_f32_16x16x32_bf16 v[196:199], a[16:19], v[200:203], 0
    s_waitcnt lgkmcnt(5)
    s_add_u32 m0, s71, 8192
    s_sub_u32 s3, s70, 344064
    ds_write_b64 v56, v[84:85] offset:2176
    v_fmac_f32_dpp v90, v78, v176 row_newbcast:0 row_mask:0xf bank_mask:0xf
    v_fmac_f32_dpp v91, v79, v176 row_newbcast:0 row_mask:0xf bank_mask:0xf
    v_cvt_pk_bf16_f32 v88, v88, v89
    v_mfma_f32_16x16x32_bf16 v[180:183], a[20:23], v[204:207], v[180:183]
    buffer_load_dwordx4 v64, s[16:19], s3 offen lds
    ds_read_b64_tr_b16 v[200:201], v18 offset:16384
    ds_read_b64_tr_b16 v[202:203], v18 offset:16896
    v_mfma_f32_16x16x32_bf16 v[184:187], a[24:27], v[204:207], v[184:187]
    v_cvt_pk_bf16_f32 v89, v90, v91
    v_fmac_f32_dpp v92, v76, v177 row_newbcast:0 row_mask:0xf bank_mask:0xf
    v_mfma_f32_16x16x32_bf16 v[188:191], a[28:31], v[204:207], v[188:191]
    ds_write_b64 v56, v[88:89] offset:4352
    v_fmac_f32_dpp v93, v77, v177 row_newbcast:0 row_mask:0xf bank_mask:0xf
    v_fmac_f32_dpp v94, v78, v177 row_newbcast:0 row_mask:0xf bank_mask:0xf
    v_fmac_f32_dpp v95, v79, v177 row_newbcast:0 row_mask:0xf bank_mask:0xf
    v_cvt_pk_bf16_f32 v92, v92, v93
    v_mfma_f32_16x16x32_bf16 v[192:195], a[32:35], v[204:207], v[192:195]
    s_add_u32 m0, s71, 12288
    s_sub_u32 s3, s70, 315392
    v_cvt_pk_bf16_f32 v93, v94, v95
    v_fmac_f32_dpp v100, v96, v26 row_newbcast:0 row_mask:0xf bank_mask:0xf
    v_mfma_f32_16x16x32_bf16 v[196:199], a[36:39], v[204:207], v[196:199]
    s_waitcnt lgkmcnt(7)
    buffer_load_dwordx4 v64, s[16:19], s3 offen lds
    ds_write_b64 v56, v[92:93] offset:6528
    v_fmac_f32_dpp v101, v97, v26 row_newbcast:0 row_mask:0xf bank_mask:0xf
    v_mfma_f32_16x16x32_bf16 v[180:183], a[40:43], v[208:211], v[180:183]
    ds_read_b64_tr_b16 v[204:205], v18 offset:20480
    ds_read_b64_tr_b16 v[206:207], v18 offset:20992
    v_fmac_f32_dpp v102, v98, v26 row_newbcast:0 row_mask:0xf bank_mask:0xf
    v_mfma_f32_16x16x32_bf16 v[184:187], a[44:47], v[208:211], v[184:187]
    v_fmac_f32_dpp v103, v99, v26 row_newbcast:0 row_mask:0xf bank_mask:0xf
    v_cvt_pk_bf16_f32 v100, v100, v101
    v_cvt_pk_bf16_f32 v101, v102, v103
    v_mfma_f32_16x16x32_bf16 v[188:191], a[48:51], v[208:211], v[188:191]
    s_add_u32 m0, s71, 16384
    s_sub_u32 s3, s70, 286720
    ds_write_b64 v56, v[100:101] offset:10880
    v_fmac_f32_dpp v104, v96, v27 row_newbcast:0 row_mask:0xf bank_mask:0xf
    v_fmac_f32_dpp v105, v97, v27 row_newbcast:0 row_mask:0xf bank_mask:0xf
    v_fmac_f32_dpp v106, v98, v27 row_newbcast:0 row_mask:0xf bank_mask:0xf
    v_mfma_f32_16x16x32_bf16 v[192:195], a[52:55], v[208:211], v[192:195]
    buffer_load_dwordx4 v64, s[16:19], s3 offen lds
    v_fmac_f32_dpp v107, v99, v27 row_newbcast:0 row_mask:0xf bank_mask:0xf
    v_mfma_f32_16x16x32_bf16 v[196:199], a[56:59], v[208:211], v[196:199]
    s_waitcnt lgkmcnt(8)
    v_cvt_pk_bf16_f32 v104, v104, v105
    v_cvt_pk_bf16_f32 v105, v106, v107
    v_mfma_f32_16x16x32_bf16 v[180:183], a[60:63], v[212:215], v[180:183]
    ds_write_b64 v56, v[104:105] offset:13056
    ds_read_b64_tr_b16 v[208:209], v18 offset:24576
    ds_read_b64_tr_b16 v[210:211], v18 offset:25088
    v_fmac_f32_dpp v108, v96, v176 row_newbcast:0 row_mask:0xf bank_mask:0xf
    v_fmac_f32_dpp v109, v97, v176 row_newbcast:0 row_mask:0xf bank_mask:0xf
    v_mfma_f32_16x16x32_bf16 v[184:187], a[64:67], v[212:215], v[184:187]
    s_add_u32 m0, s71, 20480
    s_sub_u32 s3, s70, 258048
    v_fmac_f32_dpp v110, v98, v176 row_newbcast:0 row_mask:0xf bank_mask:0xf
    v_fmac_f32_dpp v111, v99, v176 row_newbcast:0 row_mask:0xf bank_mask:0xf
    v_cvt_pk_bf16_f32 v108, v108, v109
    v_mfma_f32_16x16x32_bf16 v[188:191], a[68:71], v[212:215], v[188:191]
    buffer_load_dwordx4 v64, s[16:19], s3 offen lds
    v_cvt_pk_bf16_f32 v109, v110, v111
    v_mfma_f32_16x16x32_bf16 v[192:195], a[72:75], v[212:215], v[192:195]
    ds_write_b64 v56, v[108:109] offset:15232
    v_fmac_f32_dpp v112, v96, v177 row_newbcast:0 row_mask:0xf bank_mask:0xf
    v_fmac_f32_dpp v113, v97, v177 row_newbcast:0 row_mask:0xf bank_mask:0xf
    v_mfma_f32_16x16x32_bf16 v[196:199], a[76:79], v[212:215], v[196:199]
    s_waitcnt lgkmcnt(9)
    v_fmac_f32_dpp v114, v98, v177 row_newbcast:0 row_mask:0xf bank_mask:0xf
    v_fmac_f32_dpp v115, v99, v177 row_newbcast:0 row_mask:0xf bank_mask:0xf
Lst15:
Lv6_1:
Lv6_2:
    s_cbranch_execz Lback
    v_cvt_pk_bf16_f32 v112, v112, v113
    v_cvt_pk_bf16_f32 v113, v114, v115
    v_mfma_f32_16x16x32_bf16 v[180:183], a[80:83], v[200:203], v[180:183]
    ds_read_b64_tr_b16 v[212:213], v18 offset:28672
    ds_read_b64_tr_b16 v[214:215], v18 offset:29184
    ds_write_b64 v56, v[112:113] offset:17408
    v_mfma_f32_16x16x32_bf16 v[184:187], a[84:87], v[200:203], v[184:187]
    v_fmac_f32_dpp v96, v96, v5 row_newbcast:0 row_mask:0xf bank_mask:0xf
    v_fmac_f32_dpp v97, v97, v5 row_newbcast:0 row_mask:0xf bank_mask:0xf
    v_fmac_f32_dpp v98, v98, v5 row_newbcast:0 row_mask:0xf bank_mask:0xf
    v_fmac_f32_dpp v99, v99, v5 row_newbcast:0 row_mask:0xf bank_mask:0xf
    v_mfma_f32_16x16x32_bf16 v[188:191], a[88:91], v[200:203], v[188:191]
    v_cvt_pk_bf16_f32 v96, v96, v97
    v_cvt_pk_bf16_f32 v97, v98, v99
    v_mfma_f32_16x16x32_bf16 v[192:195], a[92:95], v[200:203], v[192:195]
    ds_write_b64 v56, v[96:97] offset:8704
    v_mul_f32 v9, 0x3e8b97f6, v9
    v_mul_f32 v8, v9, v60
    v_mul_f32 v9, v9, v61
    v_mfma_f32_16x16x32_bf16 v[196:199], a[96:99], v[200:203], v[196:199]
    s_waitcnt vmcnt(14)
    s_waitcnt lgkmcnt(0)
    s_barrier
    ds_read_b64 v[24:25], v57 offset:0
    ds_read_b64 v[40:41], v57 offset:8704
    ds_read_b64 v[76:77], v57 offset:10880
    v_mfma_f32_16x16x32_bf16 v[180:183], a[100:103], v[204:207], v[180:183]
    ds_read_b64_tr_b16 v[200:201], v18 offset:32768
    ds_read_b64_tr_b16 v[202:203], v18 offset:33280
    v_mov_b32 v26, 0
    v_mov_b32 v27, 0
    v_mfma_f32_16x16x32_bf16 v[184:187], a[104:107], v[204:207], v[184:187]
    s_add_u32 m0, s73, 0
    s_add_u32 s3, s72, 0
    v_mov_b32 v42, 0
    v_mov_b32 v43, 0
    v_mov_b32 v78, 0
    v_mov_b32 v79, 0
    v_mov_b32 v89, s68
    v_mfma_f32_16x16x32_bf16 v[188:191], a[108:111], v[204:207], v[188:191]
    buffer_load_dwordx4 v67, s[20:23], s3 offen offset:0 lds
    v_mov_b32 v91, s69
    v_mfma_f32_16x16x32_bf16 v[192:195], a[112:115], v[204:207], v[192:195]
    ds_read_b64 v[92:93], v57 offset:16
    ds_read_b64 v[94:95], v57 offset:48
    ds_read_b64 v[96:97], v57 offset:8720
    s_waitcnt lgkmcnt(7)
    v_cndmask_b32 v24, v24, v4, s[98:99]
    v_cndmask_b32 v25, v25, v4, s[98:99]
    v_mfma_f32_16x16x32_bf16 v[196:199], a[116:119], v[204:207], v[196:199]
    s_waitcnt lgkmcnt(6)
    ds_read_b64 v[98:99], v57 offset:8752
    ds_read_b64 v[100:101], v57 offset:10896
    v_mfma_f32_16x16x32_bf16 v[80:83], v[40:43], v[24:27], v[44:47]
    s_waitcnt lgkmcnt(7)
    ds_read_b64 v[102:103], v57 offset:10928
    ds_read_b64 v[116:117], v57 offset:64
    ds_read_b64 v[118:119], v57 offset:96
    v_mfma_f32_16x16x32_bf16 v[84:87], v[76:79], v[24:27], v[48:51]
    ds_read_b64 v[120:121], v57 offset:8768
    ds_read_b64 v[122:123], v57 offset:8800
    v_mfma_f32_16x16x32_bf16 v[180:183], a[120:123], v[208:211], v[180:183]
    ds_read_b64 v[124:125], v57 offset:10944
    ds_read_b64 v[126:127], v57 offset:10976
    ds_read_b64_tr_b16 v[204:205], v18 offset:36864
    ds_read_b64_tr_b16 v[206:207], v18 offset:37376
    v_mfma_f32_16x16x32_bf16 v[184:187], a[124:127], v[208:211], v[184:187]
    buffer_load_dwordx4 v68, s[20:23], s3 offen offset:1024 lds
    v_mfma_f32_16x16x32_bf16 v[188:191], a[128:131], v[208:211], v[188:191]
    v_max3_f32 v88, v80, v81, v84
    v_max3_f32 v90, v82, v83, v86
    v_mfma_f32_16x16x32_bf16 v[192:195], a[132:135], v[208:211], v[192:195]
    s_waitcnt lgkmcnt(12)
    v_cndmask_b32 v94, v94, v4, s[90:91]
    v_cndmask_b32 v95, v95, v4, s[90:91]
    s_waitcnt lgkmcnt(7)
    v_cndmask_b32 v116, v4, v116, s[78:79]
    v_cndmask_b32 v117, v4, v117, s[78:79]
    v_mfma_f32_16x16x32_bf16 v[196:199], a[136:139], v[208:211], v[196:199]
    s_add_u32 s92, s47, 45056
    v_max_f32 v88, v88, v85
    v_max_f32 v90, v90, v87
    v_mfma_f32_16x16x32_bf16 v[104:107], v[96:99], v[92:95], v[44:47]
    buffer_store_dwordx4 v[88:91], v3, s[40:43], s92 offen sc1
    v_mfma_f32_16x16x32_bf16 v[108:111], v[100:103], v[92:95], v[48:51]
    s_waitcnt lgkmcnt(4)
    v_mfma_f32_16x16x32_bf16 v[152:155], v[120:123], v[116:119], v[44:47]
    s_waitcnt lgkmcnt(2)
    buffer_load_dwordx4 v69, s[20:23], s3 offen offset:2048 lds
    v_mfma_f32_16x16x32_bf16 v[156:159], v[124:127], v[116:119], v[48:51]
    v_mfma_f32_16x16x32_bf16 v[180:183], a[140:143], v[212:215], v[180:183]
    ds_read_b64_tr_b16 v[208:209], v18 offset:40960
    ds_read_b64_tr_b16 v[210:211], v18 offset:41472
    v_mfma_f32_16x16x32_bf16 v[184:187], a[144:147], v[212:215], v[184:187]
    v_mfma_f32_16x16x32_bf16 v[188:191], a[148:151], v[212:215], v[188:191]
    v_max3_f32 v112, v104, v105, v108
    v_max3_f32 v114, v106, v107, v110
    v_max_f32 v112, v112, v109
    v_mfma_f32_16x16x32_bf16 v[192:195], a[152:155], v[212:215], v[192:195]
    v_max_f32 v114, v114, v111
    v_max3_f32 v160, v152, v153, v156
    v_max3_f32 v162, v154, v155, v158
    v_mfma_f32_16x16x32_bf16 v[196:199], a[156:159], v[212:215], v[196:199]
    buffer_load_dwordx4 v70, s[20:23], s3 offen offset:3072 lds
    v_max_f32 v160, v160, v157
    v_mfma_f32_16x16x32_bf16 v[180:183], a[160:163], v[200:203], v[180:183]
    ds_read_b64_tr_b16 v[212:213], v18 offset:45056
    ds_read_b64_tr_b16 v[214:215], v18 offset:45568
    v_max_f32 v162, v162, v159
    v_mfma_f32_16x16x32_bf16 v[184:187], a[164:167], v[200:203], v[184:187]
    v_mul_f32 v112, v112, v8
    v_mul_f32 v114, v114, v9
    v_max_f32 v104, v112, v114
    v_mfma_f32_16x16x32_bf16 v[188:191], a[168:171], v[200:203], v[188:191]
    v_mul_f32 v160, v160, v8
    v_mul_f32 v162, v162, v9
    v_max_f32 v152, v160, v162
    v_mfma_f32_16x16x32_bf16 v[192:195], a[172:175], v[200:203], v[192:195]
    s_nop 0
    v_permlane16_swap_b32 v104, v152
    v_max_f32 v104, v104, v152
    v_mov_b32 v152, v104
    v_mfma_f32_16x16x32_bf16 v[196:199], a[176:179], v[200:203], v[196:199]
    s_waitcnt lgkmcnt(4)
    s_add_u32 m0, s73, 16384
    s_add_u32 s3, s72, 229376
    v_permlane32_swap_b32 v104, v152
    v_max_f32 v104, v104, v152
    v_mov_b32 v152, v104
    v_mfma_f32_16x16x32_bf16 v[180:183], a[180:183], v[204:207], v[180:183]
    buffer_load_dwordx4 v67, s[20:23], s3 offen offset:0 lds
    ds_read_b64_tr_b16 v[200:201], v18 offset:49152
    ds_read_b64_tr_b16 v[202:203], v18 offset:49664
    v_mfma_f32_16x16x32_bf16 v[184:187], a[184:187], v[204:207], v[184:187]
    v_permlane16_swap_b32 v104, v152
    v_sub_f32 v112, v112, v104
    v_sub_f32 v114, v114, v104
    v_mfma_f32_16x16x32_bf16 v[188:191], a[188:191], v[204:207], v[188:191]
    v_sub_f32 v160, v160, v152
    v_sub_f32 v162, v162, v152
    v_mfma_f32_16x16x32_bf16 v[192:195], a[192:195], v[204:207], v[192:195]
    v_exp_f32 v112, v112
    v_mfma_f32_16x16x32_bf16 v[196:199], a[196:199], v[204:207], v[196:199]
    s_waitcnt lgkmcnt(4)
    v_exp_f32 v114, v114
    v_mfma_f32_16x16x32_bf16 v[180:183], a[200:203], v[208:211], v[180:183]
    ds_read_b64_tr_b16 v[204:205], v18 offset:53248
    ds_read_b64_tr_b16 v[206:207], v18 offset:53760
    v_mfma_f32_16x16x32_bf16 v[184:187], a[204:207], v[208:211], v[184:187]
    buffer_load_dwordx4 v68, s[20:23], s3 offen offset:1024 lds
    v_mfma_f32_16x16x32_bf16 v[188:191], a[208:211], v[208:211], v[188:191]
    v_exp_f32 v160, v160
    v_mfma_f32_16x16x32_bf16 v[192:195], a[212:215], v[208:211], v[192:195]
    v_exp_f32 v162, v162
    v_add_f32 v104, v112, v114
    v_mfma_f32_16x16x32_bf16 v[196:199], a[216:219], v[208:211], v[196:199]
    s_waitcnt lgkmcnt(4)
    ds_read_b128 v[76:79], v31 offset:0
    v_add_f32 v152, v160, v162
    v_mul_f32 v112, v112, v60
    v_mfma_f32_16x16x32_bf16 v[180:183], a[220:223], v[212:215], v[180:183]
    s_waitcnt lgkmcnt(3)
    ds_read_b128 v[100:103], v31 offset:64
    v_mul_f32 v114, v114, v61
    v_permlane16_swap_b32 v104, v152
    v_mfma_f32_16x16x32_bf16 v[180:183], a[240:243], v[200:203], v[180:183]
    s_waitcnt lgkmcnt(2)
    ds_read_b128 v[124:127], v31 offset:128
    v_add_f32 v104, v104, v152
    v_mov_b32 v152, v104
    v_mfma_f32_16x16x32_bf16 v[180:183], v[132:135], v[204:207], v[180:183]
    buffer_load_dwordx4 v69, s[20:23], s3 offen offset:2048 lds
    ds_read_b128 v[84:87], v31 offset:192
    v_mfma_f32_16x16x32_bf16 v[184:187], a[224:227], v[212:215], v[184:187]
    ds_read_b128 v[108:111], v31 offset:256
    v_mul_f32 v160, v160, v60
    v_mul_f32 v162, v162, v61
    v_mfma_f32_16x16x32_bf16 v[184:187], a[244:247], v[200:203], v[184:187]
    v_permlane32_swap_b32 v104, v152
    v_add_f32 v104, v104, v152
    v_mov_b32 v152, v104
    v_mfma_f32_16x16x32_bf16 v[184:187], v[136:139], v[204:207], v[184:187]
    s_nop 0
    v_permlane16_swap_b32 v104, v152
    v_mfma_f32_16x16x32_bf16 v[188:191], a[228:231], v[212:215], v[188:191]
    v_mov_b32 v14, v180
    v_mov_b32 v15, v180
    v_mfma_f32_16x16x32_bf16 v[188:191], a[248:251], v[200:203], v[188:191]
    s_nop 0
    v_permlane16_swap_b32 v14, v15
    v_mov_b32 v15, v14
    s_nop 1
    v_permlane32_swap_b32 v14, v15
    v_mfma_f32_16x16x32_bf16 v[188:191], v[140:143], v[204:207], v[188:191]
    buffer_load_dwordx4 v70, s[20:23], s3 offen offset:3072 lds
    v_mfma_f32_16x16x32_bf16 v[192:195], a[232:235], v[212:215], v[192:195]
    s_waitcnt lgkmcnt(4)
    v_fmac_f32 v180, v76, v14
    v_fmac_f32 v181, v77, v14
    v_fmac_f32 v182, v78, v14
    v_mfma_f32_16x16x32_bf16 v[192:195], a[252:255], v[200:203], v[192:195]
    v_fmac_f32 v183, v79, v14
    v_cvt_pk_bf16_f32 v180, v180, v181
    v_mfma_f32_16x16x32_bf16 v[192:195], v[144:147], v[204:207], v[192:195]
    v_cvt_pk_bf16_f32 v181, v182, v183
    s_waitcnt lgkmcnt(3)
    v_fmac_f32 v184, v100, v14
    v_mfma_f32_16x16x32_bf16 v[196:199], a[236:239], v[212:215], v[196:199]
    ds_write_b64 v58, v[180:181] offset:0
    v_fmac_f32 v185, v101, v14
    v_fmac_f32 v186, v102, v14
    v_mfma_f32_16x16x32_bf16 v[196:199], v[128:131], v[200:203], v[196:199]
    v_fmac_f32 v187, v103, v14
    v_cvt_pk_bf16_f32 v184, v184, v185
    v_cvt_pk_bf16_f32 v185, v186, v187
    v_mfma_f32_16x16x32_bf16 v[196:199], v[148:151], v[204:207], v[196:199]
    ds_write_b64 v58, v[184:185] offset:512
    s_waitcnt lgkmcnt(4)
    v_fmac_f32 v188, v124, v14
    v_fmac_f32 v189, v125, v14
    v_fmac_f32 v190, v126, v14
    v_fmac_f32 v191, v127, v14
    v_cvt_pk_bf16_f32 v188, v188, v189
    v_cvt_pk_bf16_f32 v189, v190, v191
    ds_write_b64 v58, v[188:189] offset:1024
    s_waitcnt lgkmcnt(4)
    v_pk_fma_f32 v[192:193], v[84:85], v[14:15], v[192:193] op_sel_hi:[1,0,1]
    v_pk_fma_f32 v[194:195], v[86:87], v[14:15], v[194:195] op_sel_hi:[1,0,1]
    v_cvt_pk_bf16_f32 v192, v192, v193
    v_cvt_pk_bf16_f32 v193, v194, v195
    ds_write_b64 v58, v[192:193] offset:1536
    s_waitcnt lgkmcnt(4)
    v_pk_fma_f32 v[196:197], v[108:109], v[14:15], v[196:197] op_sel_hi:[1,0,1]
    v_pk_fma_f32 v[198:199], v[110:111], v[14:15], v[198:199] op_sel_hi:[1,0,1]
    v_cvt_pk_bf16_f32 v196, v196, v197
    v_cvt_pk_bf16_f32 v197, v198, v199
    ds_write_b64 v58, v[196:197] offset:2048
    s_waitcnt vmcnt(9)
    s_waitcnt lgkmcnt(0)
    s_barrier
    s_add_u32 m0, s73, 32768
    s_add_u32 s3, s72, 458752
    buffer_load_dwordx4 v67, s[20:23], s3 offen offset:0 lds
    ds_read_b64 v[76:77], v59 offset:0
    ds_read_b64 v[78:79], v59 offset:512
    ds_read_b64 v[100:101], v59 offset:2560
    ds_read_b64 v[102:103], v59 offset:3072
    ds_read_b64 v[124:125], v59 offset:5120
    ds_read_b64 v[126:127], v59 offset:5632
    ds_read_b64 v[84:85], v59 offset:7680
    buffer_load_dwordx4 v68, s[20:23], s3 offen offset:1024 lds
    ds_read_b64 v[86:87], v59 offset:8192
    v_rcp_f32 v104, v104
    v_rcp_f32 v152, v152
    v_mul_f32 v112, v112, v104
    v_mul_f32 v114, v114, v104
    v_cvt_pk_bf16_f32 v112, v112, v112
    v_cvt_pk_bf16_f32 v114, v114, v114
    v_and_b32 v92, v112, v52
    v_and_b32 v93, v114, v53
    v_and_b32 v94, v112, v54
    v_and_b32 v95, v114, v55
    v_mul_f32 v160, v160, v152
    v_mul_f32 v162, v162, v152
    v_cvt_pk_bf16_f32 v160, v160, v160
    buffer_load_dwordx4 v69, s[20:23], s3 offen offset:2048 lds
    v_cvt_pk_bf16_f32 v162, v162, v162
    v_and_b32 v116, v160, v52
    v_and_b32 v117, v162, v53
    v_and_b32 v118, v160, v54
    v_and_b32 v119, v162, v55
    s_waitcnt vmcnt(9)
    s_add_u32 s93, s47, 40960
    buffer_load_dwordx4 v[40:43], v3, s[40:43], s93 offen sc1
    s_waitcnt lgkmcnt(6)
    v_mfma_f32_16x16x32_bf16 v[208:211], v[76:79], v[92:95], 0
    s_waitcnt lgkmcnt(4)
    ds_read_b64_tr_b16 a[0:1], v71 offset:0
    ds_read_b64_tr_b16 a[2:3], v71 offset:2048
    v_mfma_f32_16x16x32_bf16 v[204:207], v[100:103], v[92:95], 0
    s_waitcnt lgkmcnt(4)
    ds_read_b64_tr_b16 a[4:5], v72 offset:0
    ds_read_b64_tr_b16 a[6:7], v72 offset:2048
    v_mfma_f32_16x16x32_bf16 v[200:203], v[124:127], v[92:95], 0
    ds_read_b64_tr_b16 a[8:9], v73 offset:0
    ds_read_b64_tr_b16 a[10:11], v73 offset:2048
    buffer_load_dwordx4 v70, s[20:23], s3 offen offset:3072 lds
    v_mfma_f32_16x16x32_bf16 v[108:111], v[124:127], v[116:119], 0
    s_waitcnt lgkmcnt(6)
    ds_read_b64_tr_b16 a[12:13], v74 offset:0
    ds_read_b64_tr_b16 a[14:15], v74 offset:2048
    v_mfma_f32_16x16x32_bf16 v[176:179], v[84:87], v[116:119], 0
    ds_read_b64_tr_b16 a[16:17], v71 offset:4096
    ds_read_b64_tr_b16 a[18:19], v71 offset:6144
    s_add_u32 m0, s73, 49152
    s_add_u32 s3, s72, 688128
    buffer_load_dwordx4 v67, s[20:23], s3 offen offset:0 lds
    ds_read_b64_tr_b16 a[20:21], v72 offset:4096
    ds_read_b64_tr_b16 a[22:23], v72 offset:6144
    ds_read_b64_tr_b16 a[24:25], v73 offset:4096
    ds_read_b64_tr_b16 a[26:27], v73 offset:6144
    ds_read_b64_tr_b16 a[28:29], v74 offset:4096
    ds_read_b64_tr_b16 a[30:31], v74 offset:6144
    ds_read_b64_tr_b16 a[32:33], v71 offset:8192
    ds_read_b64_tr_b16 a[34:35], v71 offset:10240
    buffer_load_dwordx4 v68, s[20:23], s3 offen offset:1024 lds
    ds_read_b64_tr_b16 a[36:37], v72 offset:8192
    ds_read_b64_tr_b16 a[38:39], v72 offset:10240
    ds_read_b64_tr_b16 a[40:41], v73 offset:8192
    ds_read_b64_tr_b16 a[42:43], v73 offset:10240
    ds_read_b64_tr_b16 a[44:45], v74 offset:8192
    ds_read_b64_tr_b16 a[46:47], v74 offset:10240
    ds_read_b64_tr_b16 a[48:49], v71 offset:12288
    ds_read_b64_tr_b16 a[50:51], v71 offset:14336
    buffer_load_dwordx4 v69, s[20:23], s3 offen offset:2048 lds
    ds_read_b64_tr_b16 a[52:53], v72 offset:12288
    ds_read_b64_tr_b16 a[54:55], v72 offset:14336
    ds_read_b64_tr_b16 a[56:57], v73 offset:12288
    ds_read_b64_tr_b16 a[58:59], v73 offset:14336
    ds_read_b64_tr_b16 a[60:61], v74 offset:12288
    ds_read_b64_tr_b16 a[62:63], v74 offset:14336
    ds_read_b64_tr_b16 a[64:65], v71 offset:16384
    ds_read_b64_tr_b16 a[66:67], v71 offset:18432
    ds_read_b64_tr_b16 a[68:69], v72 offset:16384
    buffer_load_dwordx4 v70, s[20:23], s3 offen offset:3072 lds
    ds_read_b64_tr_b16 a[70:71], v72 offset:18432
    ds_read_b64_tr_b16 a[72:73], v73 offset:16384
    ds_read_b64_tr_b16 a[74:75], v73 offset:18432
    ds_read_b64_tr_b16 a[76:77], v74 offset:16384
    ds_read_b64_tr_b16 a[78:79], v74 offset:18432
    ds_read_b64_tr_b16 a[80:81], v71 offset:20480
    ds_read_b64_tr_b16 a[82:83], v71 offset:22528
    ds_read_b64_tr_b16 a[84:85], v72 offset:20480
    s_add_u32 m0, s73, 65536
    s_add_u32 s3, s72, 917504
    buffer_load_dwordx4 v67, s[20:23], s3 offen offset:0 lds
    ds_read_b64_tr_b16 a[86:87], v72 offset:22528
    ds_read_b64_tr_b16 a[88:89], v73 offset:20480
    ds_read_b64_tr_b16 a[90:91], v73 offset:22528
    ds_read_b64_tr_b16 a[92:93], v74 offset:20480
    ds_read_b64_tr_b16 a[94:95], v74 offset:22528
    v_cvt_pk_bf16_f32 v208, v208, v209
    v_cvt_pk_bf16_f32 v209, v210, v211
    v_cvt_pk_bf16_f32 v170, v204, v205
    v_cvt_pk_bf16_f32 v171, v206, v207
    v_cvt_pk_bf16_f32 v172, v200, v201
    buffer_load_dwordx4 v68, s[20:23], s3 offen offset:1024 lds
    v_cvt_pk_bf16_f32 v173, v202, v203
    v_cvt_pk_bf16_f32 v108, v108, v109
    v_cvt_pk_bf16_f32 v109, v110, v111
    v_cvt_pk_bf16_f32 v174, v176, v177
    v_cvt_pk_bf16_f32 v175, v178, v179
    buffer_load_dwordx4 v69, s[20:23], s3 offen offset:2048 lds
    buffer_load_dwordx4 v70, s[20:23], s3 offen offset:3072 lds
    s_waitcnt vmcnt(9)
    v_cmp_ne_u32 vcc, s68, v41
    v_cmp_ne_u32 s[6:7], s69, v43
    s_nop 0
    s_or_b64 vcc, vcc, s[6:7]
    s_cbranch_scc1 Lxd_30
Lxk_28:
    v_add_f32 v88, v88, v40
    v_add_f32 v90, v90, v42
    v_mul_f32 v88, v88, v8
    v_mul_f32 v90, v90, v9
    v_max_f32 v80, v88, v90
    v_mov_b32 v81, v80
    s_nop 1
    v_permlane16_swap_b32 v80, v81
    v_max_f32 v80, v80, v81
    v_mov_b32 v81, v80
    s_nop 1
    v_permlane32_swap_b32 v80, v81
    v_max_f32 v80, v80, v81
    v_sub_f32 v88, v88, v80
    v_sub_f32 v90, v90, v80
    v_exp_f32 v88, v88
    v_exp_f32 v90, v90
    s_nop 0
    v_add_f32 v80, v88, v90
    v_mov_b32 v81, v80
    v_mul_f32 v88, v88, v60
    v_mul_f32 v90, v90, v61
    v_permlane16_swap_b32 v80, v81
    v_add_f32 v80, v80, v81
    v_mov_b32 v81, v80
    s_nop 1
    v_permlane32_swap_b32 v80, v81
    v_add_f32 v80, v80, v81
    v_rcp_f32 v80, v80
    s_nop 0
    v_mul_f32 v88, v88, v80
    v_mul_f32 v90, v90, v80
    v_cvt_pk_bf16_f32 v88, v88, v88
    v_cvt_pk_bf16_f32 v90, v90, v90
    v_and_b32 v24, v88, v52
    v_and_b32 v25, v90, v53
    v_and_b32 v26, v88, v54
    v_and_b32 v27, v90, v55
    s_nop 1
    v_mfma_f32_16x16x32_bf16 v[212:215], v[76:79], v[24:27], 0
    s_nop 7
    v_cvt_pk_bf16_f32 v168, v212, v213
    v_cvt_pk_bf16_f32 v169, v214, v215
    v_cndmask_b32 v168, v168, v208, s[98:99]
    v_cndmask_b32 v169, v169, v209, s[98:99]
    v_cndmask_b32 v172, v172, v108, s[78:79]
    v_cndmask_b32 v173, v173, v109, s[78:79]
    buffer_store_dwordx4 v[168:171], v3, s[40:43], s48 offen offset:0 sc1
    buffer_store_dwordx4 v[172:175], v3, s[40:43], s48 offen offset:1024 sc1
    s_waitcnt lgkmcnt(0)
    s_barrier
    s_mul_i32 s52, s65, 512
    s_add_u32 s52, s52, 507904
    s_mul_i32 s49, s66, 64
    s_add_u32 s49, s49, s52
    s_mul_i32 s50, s65, 128
    s_mul_i32 s95, s66, 8
    s_add_u32 s50, s50, s95
    s_add_u32 s50, s50, 512000
    s_mul_i32 s45, s67, 11264
    s_add_u32 s45, s45, 114688
    s_mul_i32 s0, s67, 7168
    v_min_u32 v5, 6, v2
    v_lshlrev_b32 v8, 3, v5
    v_mul_u32_u24 v5, 64, v5
    v_add_u32 v9, 1, v2
    v_lshrrev_b32 v9, 2, v9
    v_min_u32 v9, 1, v9
    v_lshlrev_b32 v9, 20, v9
    v_add_lshl_u32 v9, v9, v2, 10
    v_min_u32 v10, 1, v2
    v_lshlrev_b32 v10, 30, v10
    v_bfe_u32 v14, v2, 4, 1
    v_lshlrev_b32 v25, 5, v14
    v_and_b32 v14, 3, v2
    v_lshl_add_u32 v25, v14, 3, v25
    v_bfe_u32 v11, v2, 2, 2
    v_lshrrev_b32 v14, 5, v2
    v_lshl_add_u32 v14, v14, 2, v11
    v_xor_b32 v11, s67, v11
    s_add_u32 m0, s73, 81920
    s_add_u32 s3, s72, 1146880
    buffer_load_dwordx4 v67, s[20:23], s3 offen offset:0 lds
    v_lshl_add_u32 v11, v11, 6, v25
    v_lshl_add_u32 v19, v14, 8, v11
    v_add_u32 v24, 57344, v19
    v_lshl_add_u32 v11, v14, 7, v25
    v_bfe_u32 v14, v2, 3, 1
    v_lshl_add_u32 v11, v14, 6, v11
    v_xor_b32 v14, 64, v11
    v_add_u32 v15, s45, v11
    v_add_u32 v16, s45, v14
    v_add_u32 v17, s0, v11
    v_add_u32 v18, s0, v14
    s_mul_i32 s92, s96, 256
    s_mul_i32 s95, s67, 64
    s_add_u32 s92, s92, s95
    v_and_b32 v11, 31, v2
    buffer_load_dwordx4 v68, s[20:23], s3 offen offset:1024 lds
    v_lshl_add_u32 v26, v11, 1, s92
    s_lshl_b32 s93, s66, 7
    v_and_b32 v14, 0x70, v3
    v_add_u32 v28, s93, v14
    ds_read_b64_tr_b16 a[96:97], v71 offset:24576
    ds_read_b64_tr_b16 a[98:99], v71 offset:26624
    s_lshr_b32 s93, s67, 1
    ds_read_b64_tr_b16 a[100:101], v72 offset:24576
    s_and_b32 s94, s67, 1
    ds_read_b64_tr_b16 a[102:103], v72 offset:26624
    s_mul_i32 s55, s65, 57344
    ds_read_b64_tr_b16 a[104:105], v73 offset:24576
    buffer_load_dwordx4 v69, s[20:23], s3 offen offset:2048 lds
    s_mul_i32 s95, s93, 28672
    ds_read_b64_tr_b16 a[106:107], v73 offset:26624
    s_add_u32 s55, s55, s95
    ds_read_b64_tr_b16 a[108:109], v74 offset:24576
    ds_read_b64_tr_b16 a[110:111], v74 offset:26624
    s_mul_i32 s95, s66, 4096
    ds_read_b64_tr_b16 a[112:113], v71 offset:28672
    s_add_u32 s55, s55, s95
    ds_read_b64_tr_b16 a[114:115], v71 offset:30720
    s_mul_i32 s95, s94, 256
    ds_read_b64_tr_b16 a[116:117], v72 offset:28672
    buffer_load_dwordx4 v70, s[20:23], s3 offen offset:3072 lds
    s_add_u32 s55, s55, s95
    ds_read_b64_tr_b16 a[118:119], v72 offset:30720
    s_add_u32 s55, s55, 262144
    ds_read_b64_tr_b16 a[120:121], v73 offset:28672
    ds_read_b64_tr_b16 a[122:123], v73 offset:30720
    s_mul_i32 s56, s65, 4096
    ds_read_b64_tr_b16 a[124:125], v74 offset:28672
    s_mul_i32 s95, s93, 2048
    ds_read_b64_tr_b16 a[126:127], v74 offset:30720
    s_add_u32 s56, s56, s95
    ds_read_b64_tr_b16 a[128:129], v71 offset:32768
    buffer_load_ushort v26, v26, s[28:31], 0 offen
    s_mul_i32 s95, s66, 256
    ds_read_b64_tr_b16 a[130:131], v71 offset:34816
    s_add_u32 s56, s56, s95
    ds_read_b64_tr_b16 a[132:133], v72 offset:32768
    s_mul_i32 s95, s94, 128
    ds_read_b64_tr_b16 a[134:135], v72 offset:34816
    ds_read_b64_tr_b16 a[136:137], v73 offset:32768
    s_add_u32 s56, s56, s95
    ds_read_b64_tr_b16 a[138:139], v73 offset:34816
    s_add_u32 s56, s56, 491520
    ds_read_b64_tr_b16 a[140:141], v74 offset:32768
    buffer_load_dwordx4 v[28:31], v28, s[32:35], 0 offen
    s_and_b32 s92, s65, 1
    ds_read_b64_tr_b16 a[142:143], v74 offset:34816
    s_xor_b32 s93, s92, 1
    ds_read_b64_tr_b16 a[144:145], v71 offset:36864
    s_mul_i32 s94, s67, 14336
    ds_read_b64_tr_b16 a[146:147], v71 offset:38912
    ds_read_b64_tr_b16 a[148:149], v72 offset:36864
    s_mul_i32 s95, s66, 128
    ds_read_b64_tr_b16 a[150:151], v72 offset:38912
    s_add_u32 s94, s94, s95
    ds_read_b64_tr_b16 a[152:153], v73 offset:36864
    s_mul_i32 s44, s92, 114688
    ds_read_b64_tr_b16 a[154:155], v73 offset:38912
    s_add_u32 s44, s44, s94
    ds_read_b64_tr_b16 a[156:157], v74 offset:36864
    s_mul_i32 s74, s93, 114688
    ds_read_b64_tr_b16 a[158:159], v74 offset:38912
    s_add_u32 s74, s74, s94
    v_lshlrev_b32 v164, 16, v32
    v_and_b32 v165, 0xffff0000, v32
    v_lshlrev_b32 v166, 16, v33
    v_and_b32 v167, 0xffff0000, v33
    v_lshlrev_b32 v176, 16, v34
    v_and_b32 v177, 0xffff0000, v34
    v_lshlrev_b32 v178, 16, v35
    v_and_b32 v179, 0xffff0000, v35
    v_lshlrev_b32 v180, 16, v36
    v_and_b32 v181, 0xffff0000, v36
    v_lshlrev_b32 v182, 16, v37
    v_and_b32 v183, 0xffff0000, v37
    v_lshlrev_b32 v184, 16, v38
    v_and_b32 v185, 0xffff0000, v38
    v_lshlrev_b32 v186, 16, v39
    v_and_b32 v187, 0xffff0000, v39
    v_and_b32 v14, 15, v2
    v_lshlrev_b32 v14, 3, v14
    v_lshrrev_b32 v11, 4, v2
    v_lshlrev_b32 v11, 9, v11
    v_lshl_add_u32 v11, v14, 1, v11
    s_waitcnt vmcnt(6)
    s_barrier
    s_cmp_lg_u32 s67, 0
    s_cbranch_scc1 Lg_31
    buffer_store_dwordx2 v[6:7], v10, s[40:43], s49 offen
Lg_31:
    s_branch Ljoin
.p2align 12
Ljoin:
Lst16:
    s_cbranch_execz Lback
    ds_read_b64_tr_b16 a[160:161], v71 offset:40960
    ds_read_b64_tr_b16 a[162:163], v71 offset:43008
    ds_read_b64_tr_b16 a[164:165], v72 offset:40960
    ds_read_b64_tr_b16 a[166:167], v72 offset:43008
    ds_read_b64_tr_b16 a[168:169], v73 offset:40960
    ds_read_b64_tr_b16 a[170:171], v73 offset:43008
    ds_read_b64_tr_b16 a[172:173], v74 offset:40960
    ds_read_b64_tr_b16 a[174:175], v74 offset:43008
    ds_read_b64_tr_b16 a[176:177], v71 offset:45056
    ds_read_b64_tr_b16 a[178:179], v71 offset:47104
    ds_read_b64_tr_b16 a[180:181], v72 offset:45056
    ds_read_b64_tr_b16 a[182:183], v72 offset:47104
    ds_read_b64_tr_b16 a[184:185], v73 offset:45056
    ds_read_b64_tr_b16 a[186:187], v73 offset:47104
    ds_read_b64_tr_b16 a[188:189], v74 offset:45056
    ds_read_b64_tr_b16 a[190:191], v74 offset:47104
    s_mov_b64 exec, 0
    s_cmp_eq_u32 s67, 0
    s_cbranch_scc1 Lch0
    s_cmp_eq_u32 s67, 1
    s_cbranch_scc1 Lch1
    s_cmp_eq_u32 s67, 2
    s_cbranch_scc1 Lch2
    s_branch Lch3
Lback2:
    s_mov_b64 exec, -1
    s_add_u32 s92, s57, 14336
    s_add_u32 s48, s48, 2048
    s_cmp_eq_u32 s48, s92
    s_cselect_b32 s48, s57, s48
    s_mov_b32 s97, 0
LpA1:
    buffer_load_dwordx2 v[12:13], v5, s[40:43], s52 offen sc1
    s_add_u32 s97, s97, 1
    s_cmp_gt_u32 s97, 12
    s_waitcnt vmcnt(0)
    s_cbranch_scc1 LpB1
    v_cmp_ne_u64 vcc, s[68:69], v[12:13]
    s_nop 1
    s_cbranch_vccnz LpA1
LpK1:
    buffer_load_dwordx4 v[188:191], v3, s[40:43], s48 offen offset:0 sc1
    buffer_load_dwordx4 v[192:195], v3, s[40:43], s48 offen offset:1024 sc1
    s_add_u32 s48, s48, 2048
    s_cmp_eq_u32 s48, s92
    s_cselect_b32 s48, s57, s48
    buffer_load_dwordx4 v[196:199], v3, s[40:43], s48 offen offset:0 sc1
    s_barrier
    buffer_load_dwordx4 v[200:203], v3, s[40:43], s48 offen offset:1024 sc1
    ds_read_b64_tr_b16 a[192:193], v71 offset:49152
    ds_read_b64_tr_b16 a[194:195], v71 offset:51200
    ds_read_b64_tr_b16 a[196:197], v72 offset:49152
    ds_read_b64_tr_b16 a[198:199], v72 offset:51200
    ds_read_b64_tr_b16 a[200:201], v73 offset:49152
    ds_read_b64_tr_b16 a[202:203], v73 offset:51200
    s_add_u32 s48, s48, 2048
    s_cmp_eq_u32 s48, s92
    s_cselect_b32 s48, s57, s48
    buffer_load_dwordx4 v[204:207], v3, s[40:43], s48 offen offset:0 sc1
    ds_read_b64_tr_b16 a[204:205], v74 offset:49152
    ds_read_b64_tr_b16 a[206:207], v74 offset:51200
    ds_read_b64_tr_b16 a[208:209], v71 offset:53248
    ds_read_b64_tr_b16 a[210:211], v71 offset:55296
    ds_read_b64_tr_b16 a[212:213], v72 offset:53248
    ds_read_b64_tr_b16 a[214:215], v72 offset:55296
    buffer_load_dwordx4 v[208:211], v3, s[40:43], s48 offen offset:1024 sc1
    ds_read_b64_tr_b16 a[216:217], v73 offset:53248
    ds_read_b64_tr_b16 a[218:219], v73 offset:55296
    ds_read_b64_tr_b16 a[220:221], v74 offset:53248
    ds_read_b64_tr_b16 a[222:223], v74 offset:55296
    ds_read_b64_tr_b16 v[40:41], v19 offset:0
    ds_read_b64_tr_b16 v[42:43], v19 offset:4096
    s_add_u32 s48, s48, 2048
    s_cmp_eq_u32 s48, s92
    s_cselect_b32 s48, s57, s48
    buffer_load_dwordx4 v[212:215], v3, s[40:43], s48 offen offset:0 sc1
    ds_read_b64_tr_b16 v[44:45], v19 offset:2048
    ds_read_b64_tr_b16 v[46:47], v19 offset:6144
    ds_read_b64_tr_b16 v[48:49], v19 offset:8192
    ds_read_b64_tr_b16 v[50:51], v19 offset:12288
    ds_read_b64_tr_b16 v[52:53], v19 offset:10240
    ds_read_b64_tr_b16 v[54:55], v19 offset:14336
    ds_read_b64_tr_b16 v[56:57], v19 offset:16384
    buffer_load_dwordx4 v[216:219], v3, s[40:43], s48 offen offset:1024 sc1
    ds_read_b64_tr_b16 v[58:59], v19 offset:20480
    ds_read_b64_tr_b16 v[60:61], v19 offset:18432
    ds_read_b64_tr_b16 v[62:63], v19 offset:22528
    ds_read_b64_tr_b16 v[76:77], v19 offset:24576
    ds_read_b64_tr_b16 v[78:79], v19 offset:28672
    ds_read_b64_tr_b16 v[80:81], v19 offset:26624
    s_add_u32 s48, s48, 2048
    s_cmp_eq_u32 s48, s92
    s_cselect_b32 s48, s57, s48
    buffer_load_dwordx4 v[220:223], v3, s[40:43], s48 offen offset:0 sc1
    ds_read_b64_tr_b16 v[82:83], v19 offset:30720
    ds_read_b64_tr_b16 v[84:85], v19 offset:32768
    ds_read_b64_tr_b16 v[86:87], v19 offset:36864
    ds_read_b64_tr_b16 v[88:89], v19 offset:34816
    ds_read_b64_tr_b16 v[90:91], v19 offset:38912
    ds_read_b64_tr_b16 v[92:93], v19 offset:40960
    buffer_load_dwordx4 v[224:227], v3, s[40:43], s48 offen offset:1024 sc1
    ds_read_b64_tr_b16 v[94:95], v19 offset:45056
    ds_read_b64_tr_b16 v[96:97], v19 offset:43008
    ds_read_b64_tr_b16 v[98:99], v19 offset:47104
    ds_read_b64_tr_b16 v[100:101], v19 offset:49152
    ds_read_b64_tr_b16 v[102:103], v19 offset:53248
    ds_read_b64_tr_b16 v[104:105], v19 offset:51200
    ds_read_b64_tr_b16 v[106:107], v19 offset:55296
    s_waitcnt lgkmcnt(0)
    s_barrier
    s_add_u32 s48, s48, 2048
    s_cmp_eq_u32 s48, s92
    s_cselect_b32 s48, s57, s48
    v_mfma_f32_16x16x32_bf16 v[164:167], a[0:3], v[168:171], v[164:167]
    buffer_load_dwordx4 v[228:231], v3, s[40:43], s48 offen offset:0 sc1
    v_mfma_f32_16x16x32_bf16 v[176:179], a[4:7], v[168:171], v[176:179]
    v_mfma_f32_16x16x32_bf16 v[180:183], a[8:11], v[168:171], v[180:183]
    v_mfma_f32_16x16x32_bf16 v[184:187], a[12:15], v[168:171], v[184:187]
    v_mfma_f32_16x16x32_bf16 v[164:167], a[16:19], v[172:175], v[164:167]
    buffer_load_dwordx4 v[232:235], v3, s[40:43], s48 offen offset:1024 sc1
    v_mfma_f32_16x16x32_bf16 v[176:179], a[20:23], v[172:175], v[176:179]
    v_mfma_f32_16x16x32_bf16 v[180:183], a[24:27], v[172:175], v[180:183]
    v_mfma_f32_16x16x32_bf16 v[184:187], a[28:31], v[172:175], v[184:187]
    s_waitcnt vmcnt(11)
    v_mfma_f32_16x16x32_bf16 v[164:167], a[32:35], v[188:191], v[164:167]
    v_mfma_f32_16x16x32_bf16 v[176:179], a[36:39], v[188:191], v[176:179]
    s_add_u32 m0, s45, 0
    s_add_u32 s3, s44, 0
    v_mfma_f32_16x16x32_bf16 v[180:183], a[40:43], v[188:191], v[180:183]
    buffer_load_dwordx4 v65, s[24:27], s3 offen lds
    v_mfma_f32_16x16x32_bf16 v[184:187], a[44:47], v[188:191], v[184:187]
    s_waitcnt vmcnt(11)
    v_mfma_f32_16x16x32_bf16 v[164:167], a[48:51], v[192:195], v[164:167]
    v_mfma_f32_16x16x32_bf16 v[176:179], a[52:55], v[192:195], v[176:179]
    buffer_load_dwordx4 v66, s[24:27], s3 offen offset:1024 lds
    v_mfma_f32_16x16x32_bf16 v[180:183], a[56:59], v[192:195], v[180:183]
    v_mfma_f32_16x16x32_bf16 v[184:187], a[60:63], v[192:195], v[184:187]
    s_add_u32 m0, s45, 2048
    s_add_u32 s3, s44, 57344
    s_waitcnt vmcnt(11)
    v_mfma_f32_16x16x32_bf16 v[164:167], a[64:67], v[196:199], v[164:167]
    buffer_load_dwordx4 v65, s[24:27], s3 offen lds
    v_mfma_f32_16x16x32_bf16 v[176:179], a[68:71], v[196:199], v[176:179]
    v_mfma_f32_16x16x32_bf16 v[180:183], a[72:75], v[196:199], v[180:183]
    v_mfma_f32_16x16x32_bf16 v[184:187], a[76:79], v[196:199], v[184:187]
    buffer_load_dwordx4 v66, s[24:27], s3 offen offset:1024 lds
    s_waitcnt vmcnt(12)
    v_mfma_f32_16x16x32_bf16 v[164:167], a[80:83], v[200:203], v[164:167]
    v_mfma_f32_16x16x32_bf16 v[176:179], a[84:87], v[200:203], v[176:179]
    v_mfma_f32_16x16x32_bf16 v[180:183], a[88:91], v[200:203], v[180:183]
    s_add_u32 m0, s45, 4096
    s_add_u32 s3, s74, 0
    v_mfma_f32_16x16x32_bf16 v[184:187], a[92:95], v[200:203], v[184:187]
    buffer_load_dwordx4 v65, s[24:27], s3 offen lds
    s_waitcnt vmcnt(12)
    v_mfma_f32_16x16x32_bf16 v[164:167], a[96:99], v[204:207], v[164:167]
    v_mfma_f32_16x16x32_bf16 v[176:179], a[100:103], v[204:207], v[176:179]
    v_mfma_f32_16x16x32_bf16 v[180:183], a[104:107], v[204:207], v[180:183]
    buffer_load_dwordx4 v66, s[24:27], s3 offen offset:1024 lds
    v_mfma_f32_16x16x32_bf16 v[184:187], a[108:111], v[204:207], v[184:187]
    s_waitcnt vmcnt(12)
    v_mfma_f32_16x16x32_bf16 v[164:167], a[112:115], v[208:211], v[164:167]
    s_add_u32 m0, s73, 98304
    s_add_u32 s3, s72, 1376256
    v_mfma_f32_16x16x32_bf16 v[176:179], a[116:119], v[208:211], v[176:179]
    buffer_load_dwordx4 v67, s[20:23], s3 offen offset:0 lds
    v_mfma_f32_16x16x32_bf16 v[180:183], a[120:123], v[208:211], v[180:183]
    v_mfma_f32_16x16x32_bf16 v[184:187], a[124:127], v[208:211], v[184:187]
    s_waitcnt vmcnt(12)
    v_mfma_f32_16x16x32_bf16 v[164:167], a[128:131], v[212:215], v[164:167]
    v_mfma_f32_16x16x32_bf16 v[176:179], a[132:135], v[212:215], v[176:179]
    buffer_load_dwordx4 v68, s[20:23], s3 offen offset:1024 lds
    v_mfma_f32_16x16x32_bf16 v[180:183], a[136:139], v[212:215], v[180:183]
    v_mfma_f32_16x16x32_bf16 v[184:187], a[140:143], v[212:215], v[184:187]
    s_waitcnt vmcnt(12)
    v_mfma_f32_16x16x32_bf16 v[164:167], a[144:147], v[216:219], v[164:167]
    buffer_load_dwordx4 v69, s[20:23], s3 offen offset:2048 lds
    v_mfma_f32_16x16x32_bf16 v[176:179], a[148:151], v[216:219], v[176:179]
    v_mfma_f32_16x16x32_bf16 v[180:183], a[152:155], v[216:219], v[180:183]
    v_mfma_f32_16x16x32_bf16 v[184:187], a[156:159], v[216:219], v[184:187]
    buffer_load_dwordx4 v70, s[20:23], s3 offen offset:3072 lds
    s_waitcnt vmcnt(13)
    v_mfma_f32_16x16x32_bf16 v[164:167], a[160:163], v[220:223], v[164:167]
    v_mfma_f32_16x16x32_bf16 v[176:179], a[164:167], v[220:223], v[176:179]
    s_add_u32 m0, s45, 6144
    s_add_u32 s3, s74, 57344
    v_mfma_f32_16x16x32_bf16 v[180:183], a[168:171], v[220:223], v[180:183]
    buffer_load_dwordx4 v65, s[24:27], s3 offen lds
    v_mfma_f32_16x16x32_bf16 v[184:187], a[172:175], v[220:223], v[184:187]
    s_waitcnt vmcnt(13)
    v_mfma_f32_16x16x32_bf16 v[164:167], a[176:179], v[224:227], v[164:167]
    v_mfma_f32_16x16x32_bf16 v[176:179], a[180:183], v[224:227], v[176:179]
    v_mfma_f32_16x16x32_bf16 v[180:183], a[184:187], v[224:227], v[180:183]
    buffer_load_dwordx4 v66, s[24:27], s3 offen offset:1024 lds
    v_mfma_f32_16x16x32_bf16 v[184:187], a[188:191], v[224:227], v[184:187]
    s_waitcnt vmcnt(13)
    v_mfma_f32_16x16x32_bf16 v[164:167], a[192:195], v[228:231], v[164:167]
    s_add_u32 m0, s45, 8192
    s_add_u32 s3, s44, 229376
    v_mfma_f32_16x16x32_bf16 v[176:179], a[196:199], v[228:231], v[176:179]
    buffer_load_dwordx4 v65, s[24:27], s3 offen lds
    v_mfma_f32_16x16x32_bf16 v[180:183], a[200:203], v[228:231], v[180:183]
    v_mfma_f32_16x16x32_bf16 v[184:187], a[204:207], v[228:231], v[184:187]
    s_waitcnt vmcnt(13)
    v_mfma_f32_16x16x32_bf16 v[164:167], a[208:211], v[232:235], v[164:167]
    buffer_load_dwordx4 v66, s[24:27], s3 offen offset:1024 lds
    v_mfma_f32_16x16x32_bf16 v[176:179], a[212:215], v[232:235], v[176:179]
    v_mfma_f32_16x16x32_bf16 v[180:183], a[216:219], v[232:235], v[180:183]
    v_mfma_f32_16x16x32_bf16 v[184:187], a[220:223], v[232:235], v[184:187]
    s_nop 3
    v_cvt_pk_bf16_f32 v32, v164, v165
    v_cvt_pk_bf16_f32 v33, v166, v167
    v_cvt_pk_bf16_f32 v34, v176, v177
    v_cvt_pk_bf16_f32 v35, v178, v179
    v_cvt_pk_bf16_f32 v36, v180, v181
    v_cvt_pk_bf16_f32 v37, v182, v183
    v_cvt_pk_bf16_f32 v38, v184, v185
    v_cvt_pk_bf16_f32 v39, v186, v187
    v_mfma_f32_16x16x32_bf16 v[188:191], v[32:35], v[32:35], 0
    s_nop 0
    v_mfma_f32_16x16x32_bf16 v[188:191], v[36:39], v[36:39], v[188:191]
    v_mfma_f32_16x16x32_bf16 v[192:195], v[20:23], v[32:35], 0
    s_cmp_lg_u32 s67, 0
    s_cbranch_scc1 Lg_32
    buffer_store_dwordx2 v[6:7], v10, s[40:43], s49 offen offset:2048 sc1
Lg_32:
    v_mfma_f32_16x16x32_bf16 v[192:195], v[20:23], v[36:39], v[192:195]
    buffer_store_dwordx4 v[32:35], v11, s[40:43], s55 offen offset:0 sc1
    buffer_store_dwordx4 v[36:39], v11, s[40:43], s55 offen offset:2048 sc1
    s_nop 1
    v_cndmask_b32 v188, v188, v189, s[84:85]
    v_cndmask_b32 v188, v188, v190, s[86:87]
    s_nop 1
    v_cndmask_b32 v193, v188, v191, s[88:89]
    s_mov_b32 exec_lo, 0x00f0000f
    s_mov_b32 exec_hi, 0xf0000f00
    buffer_store_dwordx2 v[192:193], v14, s[40:43], s56 offen sc1
    s_mov_b64 exec, -1
    s_mov_b32 vcc_lo, 0x100001
    s_mov_b32 vcc_hi, 0x100001
    v_cndmask_b32 v20, v4, v20, vcc
    v_cndmask_b32 v21, v4, v21, vcc
    v_cndmask_b32 v22, v4, v22, vcc
    v_cndmask_b32 v23, v4, v23, vcc
    s_nop 1
    v_mfma_f32_16x16x32_bf16 v[164:167], v[20:23], v[40:43], 0
    s_waitcnt vmcnt(15)
    ds_read_b64_tr_b16 a[0:1], v15 offset:0
    v_mfma_f32_16x16x32_bf16 v[164:167], v[20:23], v[44:47], v[164:167]
    ds_read_b64_tr_b16 a[2:3], v15 offset:1024
    v_mfma_f32_16x16x32_bf16 v[164:167], v[20:23], v[48:51], v[164:167]
    ds_read_b64_tr_b16 a[4:5], v16 offset:0
    v_mfma_f32_16x16x32_bf16 v[164:167], v[20:23], v[52:55], v[164:167]
    ds_read_b64_tr_b16 a[6:7], v16 offset:1024
    v_mfma_f32_16x16x32_bf16 v[164:167], v[20:23], v[56:59], v[164:167]
    s_waitcnt vmcnt(13)
    ds_read_b64_tr_b16 a[8:9], v15 offset:2048
    v_mfma_f32_16x16x32_bf16 v[164:167], v[20:23], v[60:63], v[164:167]
    ds_read_b64_tr_b16 a[10:11], v15 offset:3072
    v_mfma_f32_16x16x32_bf16 v[164:167], v[20:23], v[76:79], v[164:167]
    ds_read_b64_tr_b16 a[12:13], v16 offset:2048
    v_mfma_f32_16x16x32_bf16 v[164:167], v[20:23], v[80:83], v[164:167]
    ds_read_b64_tr_b16 a[14:15], v16 offset:3072
    v_mfma_f32_16x16x32_bf16 v[164:167], v[20:23], v[84:87], v[164:167]
    s_waitcnt vmcnt(11)
    ds_read_b64_tr_b16 a[112:113], v15 offset:4096
    v_mfma_f32_16x16x32_bf16 v[164:167], v[20:23], v[88:91], v[164:167]
    ds_read_b64_tr_b16 a[114:115], v15 offset:5120
    v_mfma_f32_16x16x32_bf16 v[164:167], v[20:23], v[92:95], v[164:167]
    ds_read_b64_tr_b16 a[116:117], v16 offset:4096
    v_mfma_f32_16x16x32_bf16 v[164:167], v[20:23], v[96:99], v[164:167]
    ds_read_b64_tr_b16 a[118:119], v16 offset:5120
    v_mfma_f32_16x16x32_bf16 v[164:167], v[20:23], v[100:103], v[164:167]
    v_mfma_f32_16x16x32_bf16 v[164:167], v[20:23], v[104:107], v[164:167]
    s_waitcnt lgkmcnt(0)
    s_add_u32 m0, s45, 0
    s_add_u32 s3, s44, 286720
    buffer_load_dwordx4 v65, s[24:27], s3 offen lds
    v_mov_b32 v64, 0x40000000
    v_cndmask_b32 v14, v3, v64, s[90:91]
    v_bfe_u32 v25, v2, 1, 4
    v_and_b32 v11, 1, v2
    v_lshl_add_u32 v25, v11, 4, v25
    v_lshlrev_b32 v25, 4, v25
    v_add_u32 v25, 159744, v25
    s_mul_i32 s92, s67, 1024
    s_add_u32 s92, s92, 159744
    v_add_u32 v64, s92, v3
    v_add_u32 v27, 57344, v3
    s_lshr_b32 s93, s65, 1
    s_and_b32 s92, s96, 1
    s_mul_i32 s53, s93, 256
    buffer_load_dwordx4 v66, s[24:27], s3 offen offset:1024 lds
    s_mul_i32 s95, s92, 128
    s_add_u32 s53, s53, s95
    s_add_u32 s53, s53, 512000
    s_xor_b32 s52, s53, 128
    s_mul_i32 s58, s93, 114688
    s_mul_i32 s95, s67, 4096
    s_add_u32 s58, s58, s95
    s_add_u32 s58, s58, 262144
    s_mul_i32 s62, s93, 114688
    s_mul_i32 s95, s67, 3072
    s_add_u32 s62, s62, s95
    s_add_u32 s62, s62, 278528
    s_mul_i32 s63, s67, 4096
    s_mul_i32 s100, s67, 3072
    s_add_u32 s100, s100, 16384
    s_mul_i32 s59, s93, 8192
    s_add_u32 s59, s59, 491520
    s_add_u32 m0, s45, 2048
    s_add_u32 s3, s74, 229376
    buffer_load_dwordx4 v65, s[24:27], s3 offen lds
    s_mul_i32 s60, s93, 458752
    s_mul_i32 s95, s96, 8192
    s_add_u32 s60, s60, s95
    s_mul_i32 s95, s67, 2048
    s_add_u32 s60, s60, s95
    s_add_u32 s60, s60, 524288
    s_mul_i32 s61, s65, 229376
    s_mul_i32 s95, s67, 1024
    s_add_u32 s61, s61, s95
    s_add_u32 s61, s61, 524288
    s_and_b32 s92, s96, 1
    s_xor_b32 s93, s92, 1
    s_mul_i32 s75, s93, 57344
    s_add_u32 s75, s75, s58
    s_mul_i32 s94, s92, 57344
    buffer_load_dwordx4 v66, s[24:27], s3 offen offset:1024 lds
    s_add_u32 s58, s58, s94
    s_mul_i32 s76, s93, 57344
    s_add_u32 s76, s76, s62
    s_mul_i32 s94, s92, 57344
    s_add_u32 s62, s62, s94
    s_mul_i32 s77, s93, 229376
    s_add_u32 s77, s77, s60
    s_mul_i32 s94, s92, 229376
    s_add_u32 s60, s60, s94
    s_lshr_b32 s94, s96, 1
    s_mul_i32 s51, s92, 128
    s_mul_i32 s95, s94, 8
    s_add_u32 s51, s51, s95
    s_add_u32 s51, s51, s54
    s_xor_b32 s92, s92, s67
    s_and_b32 s92, s92, 1
    s_lshr_b32 s94, s67, 1
    s_add_u32 m0, s45, 4096
    s_add_u32 s3, s74, 286720
    buffer_load_dwordx4 v65, s[24:27], s3 offen lds
    s_mul_i32 s93, s92, 4096
    s_mul_i32 s95, s94, 2048
    s_add_u32 s93, s93, s95
    s_add_u32 s59, s59, s93
    s_and_b32 s92, s65, 1
    s_mul_i32 s94, s92, 8192
    s_sub_u32 s80, s61, s94
    s_add_u32 s80, s80, 8192
    s_add_u32 s61, s61, s94
    s_mul_i32 s94, s92, 128
    s_sub_u32 s81, s54, s94
    s_add_u32 s81, s81, 128
    s_add_u32 s54, s54, s94
    s_waitcnt vmcnt(10)
    ds_read_b64_tr_b16 a[120:121], v15 offset:6144
    buffer_load_dwordx4 v66, s[24:27], s3 offen offset:1024 lds
    ds_read_b64_tr_b16 a[122:123], v15 offset:7168
    ds_read_b64_tr_b16 a[124:125], v16 offset:6144
    ds_read_b64_tr_b16 a[126:127], v16 offset:7168
    s_waitcnt vmcnt(9)
    ds_read_b64_tr_b16 a[16:17], v15 offset:8192
    ds_read_b64_tr_b16 a[18:19], v15 offset:9216
    ds_read_b64_tr_b16 a[20:21], v16 offset:8192
    ds_read_b64_tr_b16 a[22:23], v16 offset:9216
    s_waitcnt lgkmcnt(0)
    s_waitcnt vmcnt(6)
    s_barrier
    s_cmp_lg_u32 s67, 0
    s_cbranch_scc1 Lg_33
    buffer_store_dwordx2 v[6:7], v9, s[40:43], s50 offen
Lg_33:
    s_add_u32 m0, s45, 6144
    s_add_u32 s3, s44, 458752
    buffer_load_dwordx4 v65, s[24:27], s3 offen lds
    buffer_load_dwordx4 v66, s[24:27], s3 offen offset:1024 lds
    s_add_u32 m0, s45, 8192
    s_add_u32 s3, s44, 516096
    buffer_load_dwordx4 v65, s[24:27], s3 offen lds
    buffer_load_dwordx4 v66, s[24:27], s3 offen offset:1024 lds
    ds_read_b64_tr_b16 v[108:109], v24 offset:0
    ds_read_b64_tr_b16 v[110:111], v24 offset:4096
    ds_read_b64_tr_b16 v[112:113], v24 offset:2048
    ds_read_b64_tr_b16 v[114:115], v24 offset:6144
    ds_read_b64_tr_b16 v[116:117], v24 offset:8192
    ds_read_b64_tr_b16 v[118:119], v24 offset:12288
    ds_read_b64_tr_b16 v[120:121], v24 offset:10240
    ds_read_b64_tr_b16 v[122:123], v24 offset:14336
    ds_read_b64_tr_b16 v[124:125], v24 offset:16384
    ds_read_b64_tr_b16 v[126:127], v24 offset:20480
    ds_read_b64_tr_b16 v[128:129], v24 offset:18432
    ds_read_b64_tr_b16 v[130:131], v24 offset:22528
    ds_read_b64_tr_b16 v[132:133], v24 offset:24576
    ds_read_b64_tr_b16 v[134:135], v24 offset:28672
    ds_read_b64_tr_b16 v[136:137], v24 offset:26624
    ds_read_b64_tr_b16 v[138:139], v24 offset:30720
    ds_read_b64_tr_b16 v[140:141], v24 offset:32768
    ds_read_b64_tr_b16 v[142:143], v24 offset:36864
    ds_read_b64_tr_b16 v[144:145], v24 offset:34816
    ds_read_b64_tr_b16 v[146:147], v24 offset:38912
    ds_read_b64_tr_b16 v[148:149], v24 offset:40960
    ds_read_b64_tr_b16 v[150:151], v24 offset:45056
    ds_read_b64_tr_b16 v[152:153], v24 offset:43008
    ds_read_b64_tr_b16 v[154:155], v24 offset:47104
    ds_read_b64_tr_b16 v[156:157], v24 offset:49152
    ds_read_b64_tr_b16 v[158:159], v24 offset:53248
    ds_read_b64_tr_b16 v[160:161], v24 offset:51200
    ds_read_b64_tr_b16 v[162:163], v24 offset:55296
    s_buffer_load_dwordx16 s[8:23], s[40:43], s53 offset:0
    s_waitcnt lgkmcnt(0)
    s_xor_b64 s[8:9], s[8:9], s[68:69]
    s_xor_b64 s[10:11], s[10:11], s[68:69]
    s_xor_b64 s[12:13], s[12:13], s[68:69]
    s_xor_b64 s[14:15], s[14:15], s[68:69]
    s_xor_b64 s[16:17], s[16:17], s[68:69]
    s_xor_b64 s[18:19], s[18:19], s[68:69]
    s_xor_b64 s[20:21], s[20:21], s[68:69]
    s_or_b64 s[8:9], s[8:9], s[10:11]
    s_or_b64 s[8:9], s[8:9], s[12:13]
    s_or_b64 s[8:9], s[8:9], s[14:15]
    s_or_b64 s[8:9], s[8:9], s[16:17]
    s_or_b64 s[8:9], s[8:9], s[18:19]
    s_or_b64 s[8:9], s[8:9], s[20:21]
    s_cbranch_scc1 Lslow3_4
Lok3_4:
    s_buffer_load_dwordx16 s[8:23], s[40:43], s52 offset:0
    s_add_u32 m0, s63, 0
    s_add_u32 s3, s58, 0
    buffer_load_dwordx4 v3, s[40:43], s3 offen offset:0 sc1 lds
    buffer_load_dwordx4 v3, s[40:43], s3 offen offset:1024 sc1 lds
    buffer_load_dwordx4 v3, s[40:43], s3 offen offset:2048 sc1 lds
    buffer_load_dwordx4 v3, s[40:43], s3 offen offset:3072 sc1 lds
    s_add_u32 m0, s100, 0
    s_add_u32 s3, s62, 0
    v_mfma_f32_16x16x32_bf16 v[164:167], v[20:23], v[108:111], v[164:167]
    buffer_load_dwordx4 v3, s[40:43], s3 offen offset:0 sc1 lds
    v_mfma_f32_16x16x32_bf16 v[164:167], v[20:23], v[112:115], v[164:167]
    v_mfma_f32_16x16x32_bf16 v[164:167], v[20:23], v[116:119], v[164:167]
    v_mfma_f32_16x16x32_bf16 v[164:167], v[20:23], v[120:123], v[164:167]
    v_mfma_f32_16x16x32_bf16 v[164:167], v[20:23], v[124:127], v[164:167]
    buffer_load_dwordx4 v3, s[40:43], s3 offen offset:1024 sc1 lds
    v_mfma_f32_16x16x32_bf16 v[164:167], v[20:23], v[128:131], v[164:167]
    v_mfma_f32_16x16x32_bf16 v[164:167], v[20:23], v[132:135], v[164:167]
    v_mfma_f32_16x16x32_bf16 v[164:167], v[20:23], v[136:139], v[164:167]
    v_mfma_f32_16x16x32_bf16 v[164:167], v[20:23], v[140:143], v[164:167]
    v_mfma_f32_16x16x32_bf16 v[164:167], v[20:23], v[144:147], v[164:167]
    buffer_load_dwordx4 v3, s[40:43], s3 offen offset:2048 sc1 lds
    v_mfma_f32_16x16x32_bf16 v[164:167], v[20:23], v[148:151], v[164:167]
    v_mfma_f32_16x16x32_bf16 v[164:167], v[20:23], v[152:155], v[164:167]
    v_mfma_f32_16x16x32_bf16 v[164:167], v[20:23], v[156:159], v[164:167]
    v_mfma_f32_16x16x32_bf16 v[164:167], v[20:23], v[160:163], v[164:167]
    s_waitcnt lgkmcnt(0)
    s_xor_b64 s[8:9], s[8:9], s[68:69]
    s_xor_b64 s[10:11], s[10:11], s[68:69]
    s_xor_b64 s[12:13], s[12:13], s[68:69]
    s_xor_b64 s[14:15], s[14:15], s[68:69]
    s_xor_b64 s[16:17], s[16:17], s[68:69]
    s_xor_b64 s[18:19], s[18:19], s[68:69]
    s_xor_b64 s[20:21], s[20:21], s[68:69]
    s_or_b64 s[8:9], s[8:9], s[10:11]
    s_or_b64 s[8:9], s[8:9], s[12:13]
    s_or_b64 s[8:9], s[8:9], s[14:15]
    s_or_b64 s[8:9], s[8:9], s[16:17]
    s_or_b64 s[8:9], s[8:9], s[18:19]
    s_or_b64 s[8:9], s[8:9], s[20:21]
    s_cbranch_scc1 Lslow3_5
Lok3_5:
    buffer_load_dwordx4 v[68:71], v3, s[40:43], s59 offen offset:0 sc1
    buffer_load_dwordx4 v[72:75], v14, s[40:43], s59 offen offset:1024 sc1
    s_add_u32 m0, s63, 28672
    s_add_u32 s3, s75, 0
    buffer_load_dwordx4 v3, s[40:43], s3 offen offset:0 sc1 lds
    buffer_load_dwordx4 v3, s[40:43], s3 offen offset:1024 sc1 lds
    s_waitcnt vmcnt(7)
    s_barrier
    ds_read_b128 v[188:191], v3 offset:0
    ds_read_b128 v[192:195], v3 offset:1024
    ds_read_b128 v[196:199], v3 offset:2048
    s_waitcnt lgkmcnt(2)
    v_mfma_f32_32x32x16_bf16 v[204:219], v[40:43], v[188:191], 0
    s_waitcnt lgkmcnt(1)
    buffer_load_dwordx4 v3, s[40:43], s3 offen offset:2048 sc1 lds
    ds_read_b128 v[200:203], v3 offset:3072
    ds_read_b64_tr_b16 a[24:25], v15 offset:0
    ds_read_b64_tr_b16 a[26:27], v15 offset:1024
    ds_read_b64_tr_b16 a[28:29], v16 offset:0
    v_mfma_f32_32x32x16_bf16 v[204:219], v[44:47], v[192:195], v[204:219]
    s_waitcnt lgkmcnt(4)
    buffer_load_dwordx4 v3, s[40:43], s3 offen offset:3072 sc1 lds
    ds_read_b128 v[188:191], v3 offset:4096
    ds_read_b64_tr_b16 a[30:31], v16 offset:1024
    ds_read_b64_tr_b16 a[128:129], v15 offset:2048
    v_lshlrev_b32 v26, 16, v26
    v_cvt_pk_bf16_f32 v165, v164, v164
    v_mfma_f32_32x32x16_bf16 v[204:219], v[48:51], v[196:199], v[204:219]
    s_waitcnt lgkmcnt(6)
    s_add_u32 m0, s100, 28672
    s_add_u32 s3, s76, 0
    ds_read_b128 v[192:195], v3 offset:5120
    ds_read_b64_tr_b16 a[130:131], v15 offset:3072
    ds_read_b64_tr_b16 a[132:133], v16 offset:2048
    ds_read_b64_tr_b16 a[134:135], v16 offset:3072
    v_lshlrev_b32 v165, 16, v165
    v_sub_f32 v165, v164, v165
    v_cvt_pk_bf16_f32 v220, v164, v165
    v_mfma_f32_32x32x16_bf16 v[204:219], v[52:55], v[200:203], v[204:219]
    s_waitcnt lgkmcnt(6)
    buffer_load_dwordx4 v3, s[40:43], s3 offen offset:0 sc1 lds
    ds_read_b128 v[196:199], v3 offset:6144
    ds_read_b64_tr_b16 a[136:137], v15 offset:4096
    ds_read_b64_tr_b16 a[138:139], v15 offset:5120
    v_cvt_pk_bf16_f32 v221, v164, v26
    v_mfma_f32_32x32x16_bf16 v[204:219], v[56:59], v[188:191], v[204:219]
    s_waitcnt lgkmcnt(6)
    buffer_load_dwordx4 v3, s[40:43], s3 offen offset:1024 sc1 lds
    ds_read_b128 v[200:203], v3 offset:7168
    ds_read_b64_tr_b16 a[140:141], v16 offset:4096
    ds_read_b64_tr_b16 a[142:143], v16 offset:5120
    v_cvt_pk_bf16_f32 v222, v26, v4
    v_mfma_f32_32x32x16_bf16 v[204:219], v[60:63], v[192:195], v[204:219]
    s_waitcnt lgkmcnt(5)
    ds_read_b128 v[188:191], v3 offset:8192
    ds_read_b64_tr_b16 a[32:33], v15 offset:6144
    ds_read_b64_tr_b16 a[34:35], v15 offset:7168
    ds_read_b64_tr_b16 a[36:37], v16 offset:6144
    v_mov_b32 v223, 0
    v_cndmask_b32 v220, v220, v4, s[98:99]
    v_cndmask_b32 v221, v221, v4, s[98:99]
    v_mfma_f32_32x32x16_bf16 v[204:219], v[76:79], v[196:199], v[204:219]
    s_waitcnt lgkmcnt(6)
    buffer_load_dwordx4 v3, s[40:43], s3 offen offset:2048 sc1 lds
    s_add_u32 m0, s63, 57344
    s_add_u32 s3, s58, 28672
    ds_read_b128 v[192:195], v3 offset:9216
    ds_read_b64_tr_b16 a[38:39], v16 offset:7168
    ds_read_b64_tr_b16 a[40:41], v15 offset:8192
    v_cndmask_b32 v222, v222, v4, s[98:99]
    v_mfma_f32_32x32x16_bf16 v[204:219], v[80:83], v[200:203], v[204:219]
    s_waitcnt lgkmcnt(6)
    buffer_load_dwordx4 v3, s[40:43], s3 offen offset:0 sc1 lds
    ds_read_b128 v[196:199], v3 offset:10240
    ds_read_b64_tr_b16 a[42:43], v15 offset:9216
    ds_read_b64_tr_b16 a[44:45], v16 offset:8192
    ds_read_b64_tr_b16 a[46:47], v16 offset:9216
    v_mfma_f32_32x32x16_bf16 v[204:219], v[84:87], v[188:191], v[204:219]
    s_waitcnt lgkmcnt(6)
    ds_read_b128 v[200:203], v3 offset:11264
    s_waitcnt vmcnt(8)
    v_add_f32 v68, v68, v72
    v_add_f32 v70, v70, v74
    v_add_f32 v69, v69, v73
    v_add_f32 v71, v71, v75
    v_permlane16_swap_b32 v68, v70
    v_mfma_f32_32x32x16_bf16 v[204:219], v[88:91], v[192:195], v[204:219]
    s_waitcnt lgkmcnt(4)
    buffer_load_dwordx4 v3, s[40:43], s3 offen offset:1024 sc1 lds
    ds_read_b128 v[188:191], v3 offset:12288
    v_permlane16_swap_b32 v69, v71
    v_add_f32 v68, v68, v70
    v_add_f32 v69, v69, v71
    v_mfma_f32_32x32x16_bf16 v[204:219], v[92:95], v[196:199], v[204:219]
    s_waitcnt lgkmcnt(1)
    buffer_load_dwordx4 v3, s[40:43], s3 offen offset:2048 sc1 lds
    ds_read_b128 v[192:195], v3 offset:13312
    v_mov_b32 v70, v68
    v_mov_b32 v71, v69
    v_mov_b32 v183, 0
    v_mfma_f32_32x32x16_bf16 v[204:219], v[96:99], v[200:203], v[204:219]
    s_waitcnt lgkmcnt(1)
    ds_read_b128 v[196:199], v3 offset:14336
    v_permlane32_swap_b32 v68, v70
    v_permlane32_swap_b32 v69, v71
    v_add_f32 v68, v68, v70
    v_add_f32 v69, v69, v71
    v_mul_f32 v68, 0xbb124925, v68
    v_mfma_f32_32x32x16_bf16 v[204:219], v[100:103], v[188:191], v[204:219]
    s_waitcnt lgkmcnt(1)
    buffer_load_dwordx4 v3, s[40:43], s3 offen offset:3072 sc1 lds
    s_add_u32 m0, s100, 57344
    s_add_u32 s3, s62, 28672
    ds_read_b128 v[200:203], v3 offset:15360
    v_mul_f32 v69, 0x3b124925, v69
    v_fma_f32 v69, -v68, v68, v69
    v_max_f32 v69, 0, v69
    v_mfma_f32_32x32x16_bf16 v[204:219], v[104:107], v[192:195], v[204:219]
    s_waitcnt lgkmcnt(1)
    s_barrier
    buffer_load_dwordx4 v3, s[40:43], s3 offen offset:0 sc1 lds
    ds_read_b128 v[188:191], v3 offset:16384
    v_add_f32 v69, 0x3727c5ac, v69
    v_mfma_f32_32x32x16_bf16 v[204:219], v[108:111], v[196:199], v[204:219]
    s_waitcnt lgkmcnt(1)
    ds_read_b128 v[192:195], v3 offset:17408
    v_rsq_f32 v70, v69
    v_cvt_pk_bf16_f32 v180, v68, v68
    v_mul_f32 v186, v69, v70
    v_lshlrev_b32 v71, 16, v180
    v_mfma_f32_32x32x16_bf16 v[204:219], v[112:115], v[200:203], v[204:219]
    s_waitcnt lgkmcnt(1)
    buffer_load_dwordx4 v3, s[40:43], s3 offen offset:1024 sc1 lds
    ds_read_b128 v[196:199], v3 offset:18432
    v_sub_f32 v71, v68, v71
    v_cvt_pk_bf16_f32 v181, v71, v186
    v_and_b32 v71, 0xffff0000, v181
Lst17:
Lch0:
    s_cbranch_execz Lback2
    v_mfma_f32_32x32x16_bf16 v[204:219], v[116:119], v[188:191], v[204:219]
    s_waitcnt lgkmcnt(1)
    buffer_load_dwordx4 v3, s[40:43], s3 offen offset:2048 sc1 lds
    ds_read_b128 v[200:203], v3 offset:19456
    v_sub_f32 v71, v186, v71
    v_cvt_pk_bf16_f32 v182, v71, v4
    v_mfma_f32_32x32x16_bf16 v[204:219], v[120:123], v[192:195], v[204:219]
    s_waitcnt lgkmcnt(1)
    s_add_u32 m0, s63, 86016
    s_add_u32 s3, s75, 28672
    ds_read_b128 v[188:191], v3 offset:20480
    s_mov_b32 exec_hi, 0
    ds_write_b128 v64, v[180:183]
    s_mov_b32 exec_hi, -1
    v_mul_f32 v184, 0xc0135761, v70
    v_mul_f32 v185, v70, v70
    v_mul_f32 v185, v185, v184
    v_mfma_f32_32x32x16_bf16 v[204:219], v[124:127], v[196:199], v[204:219]
    s_waitcnt lgkmcnt(2)
    buffer_load_dwordx4 v3, s[40:43], s3 offen offset:0 sc1 lds
    ds_read_b128 v[192:195], v3 offset:21504
    v_mul_f32 v185, 0x3d372713, v185
    v_mfma_f32_32x32x16_bf16 v[204:219], v[128:131], v[200:203], v[204:219]
    s_waitcnt lgkmcnt(2)
    buffer_load_dwordx4 v3, s[40:43], s3 offen offset:1024 sc1 lds
    ds_read_b128 v[196:199], v3 offset:22528
    v_mfma_f32_32x32x16_bf16 v[204:219], v[132:135], v[188:191], v[204:219]
    s_waitcnt lgkmcnt(1)
    ds_read_b128 v[200:203], v3 offset:23552
    s_mov_b32 exec_hi, 0
    ds_write_b128 v64, v[184:187] offset:512
    s_mov_b32 exec_hi, -1
    v_mfma_f32_32x32x16_bf16 v[204:219], v[136:139], v[192:195], v[204:219]
    s_waitcnt lgkmcnt(2)
    buffer_load_dwordx4 v3, s[40:43], s3 offen offset:2048 sc1 lds
    ds_read_b128 v[188:191], v3 offset:24576
    v_mfma_f32_32x32x16_bf16 v[204:219], v[140:143], v[196:199], v[204:219]
    s_waitcnt lgkmcnt(2)
    buffer_load_dwordx4 v3, s[40:43], s3 offen offset:3072 sc1 lds
    ds_read_b128 v[192:195], v3 offset:25600
    v_mfma_f32_32x32x16_bf16 v[204:219], v[144:147], v[200:203], v[204:219]
    s_waitcnt lgkmcnt(1)
    s_barrier
    s_add_u32 m0, s100, 86016
    s_add_u32 s3, s76, 28672
    ds_read_b128 v[196:199], v3 offset:26624
    ds_read_b128 v[224:227], v25 offset:0
    ds_read_b128 v[228:231], v25 offset:512
    v_mfma_f32_32x32x16_bf16 v[204:219], v[148:151], v[188:191], v[204:219]
    s_waitcnt lgkmcnt(3)
    buffer_load_dwordx4 v3, s[40:43], s3 offen offset:0 sc1 lds
    ds_read_b128 v[180:183], v3 offset:27648
    v_mfma_f32_32x32x16_bf16 v[204:219], v[152:155], v[192:195], v[204:219]
    s_waitcnt lgkmcnt(3)
    s_waitcnt vmcnt(12)
    s_barrier
    buffer_load_dwordx4 v3, s[40:43], s3 offen offset:1024 sc1 lds
    ds_read_b128 v[184:187], v3 offset:28672
    v_mfma_f32_32x32x16_bf16 v[204:219], v[156:159], v[196:199], v[204:219]
    s_waitcnt lgkmcnt(1)
    ds_read_b128 v[200:203], v3 offset:29696
    v_mfma_f32_32x32x16_bf16 v[204:219], v[160:163], v[180:183], v[204:219]
    buffer_load_dwordx4 v3, s[40:43], s3 offen offset:2048 sc1 lds
    ds_read_b128 v[188:191], v3 offset:30720
    v_mfma_f32_32x32x16_bf16 v[204:219], v[220:223], v[224:227], v[204:219]
    ds_read_b128 v[192:195], v3 offset:31744
    s_add_u32 m0, s45, 0
    s_add_u32 s3, s74, 458752
    s_waitcnt lgkmcnt(3)
    v_mfma_f32_32x32x16_bf16 v[164:179], v[40:43], v[184:187], 0
    s_waitcnt lgkmcnt(1)
    buffer_load_dwordx4 v65, s[24:27], s3 offen lds
    ds_read_b128 v[196:199], v3 offset:32768
    v_mfma_f32_32x32x16_bf16 v[164:179], v[44:47], v[200:203], v[164:179]
    s_barrier
    ds_read_b128 v[180:183], v3 offset:33792
    ds_read_b128 v[184:187], v3 offset:34816
    v_mfma_f32_32x32x16_bf16 v[164:179], v[48:51], v[188:191], v[164:179]
    s_waitcnt lgkmcnt(2)
    s_add_u32 s92, s60, 0
    buffer_load_dwordx4 v66, s[24:27], s3 offen offset:1024 lds
    ds_read_b128 v[200:203], v3 offset:35840
    v_mul_f32 v236, v204, v204
    v_mul_f32 v237, v205, v205
    v_mul_f32 v238, v206, v206
    v_mul_f32 v239, v207, v207
    v_fma_f32 v236, v236, v229, v228
    v_mfma_f32_32x32x16_bf16 v[164:179], v[52:55], v[192:195], v[164:179]
    s_add_u32 m0, s45, 2048
    s_add_u32 s3, s74, 516096
    ds_read_b128 v[188:191], v3 offset:36864
    v_fma_f32 v237, v237, v229, v228
    v_fma_f32 v238, v238, v229, v228
    v_fma_f32 v239, v239, v229, v228
    v_mul_f32 v236, v236, v204
    v_mul_f32 v237, v237, v205
    v_mul_f32 v238, v238, v206
    v_mul_f32 v239, v239, v207
    v_mfma_f32_32x32x16_bf16 v[164:179], v[56:59], v[196:199], v[164:179]
    s_waitcnt lgkmcnt(2)
    buffer_load_dwordx4 v65, s[24:27], s3 offen lds
    ds_read_b128 v[192:195], v3 offset:37888
    v_exp_f32 v236, v236
    v_exp_f32 v237, v237
    v_mfma_f32_32x32x16_bf16 v[164:179], v[60:63], v[180:183], v[164:179]
    ds_read_b128 v[196:199], v3 offset:38912
    v_exp_f32 v238, v238
    v_exp_f32 v239, v239
    v_fma_f32 v236, v236, v230, v230
    v_fma_f32 v237, v237, v230, v230
    v_fma_f32 v238, v238, v230, v230
    v_fma_f32 v239, v239, v230, v230
    v_mfma_f32_32x32x16_bf16 v[164:179], v[76:79], v[184:187], v[164:179]
    s_waitcnt lgkmcnt(2)
    buffer_load_dwordx4 v66, s[24:27], s3 offen offset:1024 lds
    ds_read_b128 v[180:183], v3 offset:39936
    v_rcp_f32 v236, v236
    v_rcp_f32 v237, v237
    v_rcp_f32 v238, v238
    v_mfma_f32_32x32x16_bf16 v[164:179], v[80:83], v[200:203], v[164:179]
    s_add_u32 m0, s45, 4096
    s_add_u32 s3, s44, 688128
    ds_read_b128 v[184:187], v3 offset:40960
    v_rcp_f32 v239, v239
    v_mul_f32 v236, v236, v204
    v_mul_f32 v237, v237, v205
    v_mul_f32 v238, v238, v206
    v_mul_f32 v239, v239, v207
    v_cvt_pk_bf16_f32 v204, v236, v237
    v_cvt_pk_bf16_f32 v205, v238, v239
    v_mfma_f32_32x32x16_bf16 v[164:179], v[84:87], v[188:191], v[164:179]
    s_waitcnt lgkmcnt(2)
    buffer_load_dwordx4 v65, s[24:27], s3 offen lds
    ds_read_b128 v[200:203], v3 offset:41984
    v_mul_f32 v240, v208, v208
    v_mul_f32 v241, v209, v209
    v_mul_f32 v242, v210, v210
    v_mul_f32 v243, v211, v211
    v_mfma_f32_32x32x16_bf16 v[164:179], v[88:91], v[192:195], v[164:179]
    ds_read_b128 v[188:191], v3 offset:43008
    v_fma_f32 v240, v240, v229, v228
    v_fma_f32 v241, v241, v229, v228
    v_fma_f32 v242, v242, v229, v228
    v_fma_f32 v243, v243, v229, v228
    v_mul_f32 v240, v240, v208
    v_mul_f32 v241, v241, v209
    v_mul_f32 v242, v242, v210
    v_mul_f32 v243, v243, v211
    v_mfma_f32_32x32x16_bf16 v[164:179], v[92:95], v[196:199], v[164:179]
    s_waitcnt lgkmcnt(2)
    buffer_load_dwordx4 v66, s[24:27], s3 offen offset:1024 lds
    ds_read_b128 v[192:195], v3 offset:44032
    v_exp_f32 v240, v240
    v_exp_f32 v241, v241
    v_exp_f32 v242, v242
    v_mfma_f32_32x32x16_bf16 v[164:179], v[96:99], v[180:183], v[164:179]
    s_add_u32 m0, s45, 6144
    s_add_u32 s3, s74, 688128
    ds_read_b128 v[196:199], v3 offset:45056
    v_exp_f32 v243, v243
    v_fma_f32 v240, v240, v230, v230
    v_fma_f32 v241, v241, v230, v230
    v_fma_f32 v242, v242, v230, v230
    v_fma_f32 v243, v243, v230, v230
    v_rcp_f32 v240, v240
    v_mfma_f32_32x32x16_bf16 v[164:179], v[100:103], v[184:187], v[164:179]
    s_waitcnt lgkmcnt(2)
    buffer_load_dwordx4 v65, s[24:27], s3 offen lds
    ds_read_b128 v[180:183], v3 offset:46080
    v_rcp_f32 v241, v241
    v_rcp_f32 v242, v242
    v_mfma_f32_32x32x16_bf16 v[164:179], v[104:107], v[200:203], v[164:179]
    ds_read_b128 v[184:187], v3 offset:47104
    v_rcp_f32 v243, v243
    v_mul_f32 v240, v240, v208
    v_mul_f32 v241, v241, v209
    v_mul_f32 v242, v242, v210
    v_mul_f32 v243, v243, v211
    v_cvt_pk_bf16_f32 v206, v240, v241
    v_cvt_pk_bf16_f32 v207, v242, v243
    v_mfma_f32_32x32x16_bf16 v[164:179], v[108:111], v[188:191], v[164:179]
    s_waitcnt lgkmcnt(2)
    buffer_load_dwordx4 v66, s[24:27], s3 offen offset:1024 lds
    buffer_store_dwordx4 v[204:207], v3, s[40:43], s92 offen offset:0 sc1
    s_cmp_lg_u32 s67, 0
    s_cbranch_scc1 Lg_34
    buffer_store_dwordx2 v[6:7], v10, s[40:43], s50 offen offset:3072 sc1
Lg_34:
    ds_read_b128 v[200:203], v3 offset:48128
    v_mul_f32 v236, v212, v212
    v_mul_f32 v237, v213, v213
    v_mfma_f32_32x32x16_bf16 v[164:179], v[112:115], v[192:195], v[164:179]
    s_add_u32 m0, s45, 8192
    s_add_u32 s3, s44, 745472
    ds_read_b128 v[188:191], v3 offset:49152
    v_mul_f32 v238, v214, v214
    v_mul_f32 v239, v215, v215
    v_fma_f32 v236, v236, v229, v228
    v_fma_f32 v237, v237, v229, v228
    v_fma_f32 v238, v238, v229, v228
    v_fma_f32 v239, v239, v229, v228
    v_mul_f32 v236, v236, v212
    v_mul_f32 v237, v237, v213
    v_mfma_f32_32x32x16_bf16 v[164:179], v[116:119], v[196:199], v[164:179]
    s_waitcnt lgkmcnt(2)
    buffer_load_dwordx4 v65, s[24:27], s3 offen lds
    ds_read_b128 v[192:195], v3 offset:50176
    v_mul_f32 v238, v238, v214
    v_mul_f32 v239, v239, v215
    v_exp_f32 v236, v236
    v_mfma_f32_32x32x16_bf16 v[164:179], v[120:123], v[180:183], v[164:179]
    ds_read_b128 v[196:199], v3 offset:51200
    v_exp_f32 v237, v237
    v_exp_f32 v238, v238
    v_exp_f32 v239, v239
    v_fma_f32 v236, v236, v230, v230
    v_fma_f32 v237, v237, v230, v230
    v_mfma_f32_32x32x16_bf16 v[164:179], v[124:127], v[184:187], v[164:179]
    s_waitcnt lgkmcnt(2)
    buffer_load_dwordx4 v66, s[24:27], s3 offen offset:1024 lds
    ds_read_b128 v[180:183], v3 offset:52224
    v_fma_f32 v238, v238, v230, v230
    v_fma_f32 v239, v239, v230, v230
    v_rcp_f32 v236, v236
    v_rcp_f32 v237, v237
    v_mfma_f32_32x32x16_bf16 v[164:179], v[128:131], v[200:203], v[164:179]
    s_add_u32 m0, s0, 0
    s_add_u32 s3, s74, 745472
    ds_read_b128 v[184:187], v3 offset:53248
    v_rcp_f32 v238, v238
    v_rcp_f32 v239, v239
    v_mul_f32 v236, v236, v212
    v_mul_f32 v237, v237, v213
    v_mul_f32 v238, v238, v214
    v_mul_f32 v239, v239, v215
    v_mfma_f32_32x32x16_bf16 v[164:179], v[132:135], v[188:191], v[164:179]
    s_waitcnt lgkmcnt(2)
    buffer_load_dwordx4 v65, s[24:27], s3 offen lds
    ds_read_b128 v[200:203], v3 offset:54272
    v_cvt_pk_bf16_f32 v208, v236, v237
    v_cvt_pk_bf16_f32 v209, v238, v239
    v_mul_f32 v240, v216, v216
    v_mul_f32 v241, v217, v217
    v_mfma_f32_32x32x16_bf16 v[164:179], v[136:139], v[192:195], v[164:179]
    ds_read_b128 v[188:191], v3 offset:55296
    ds_read_b128 v[224:227], v25 offset:1024
    v_mul_f32 v242, v218, v218
    v_mul_f32 v243, v219, v219
    v_fma_f32 v240, v240, v229, v228
    v_fma_f32 v241, v241, v229, v228
    v_fma_f32 v242, v242, v229, v228
    v_fma_f32 v243, v243, v229, v228
    v_mul_f32 v240, v240, v216
    v_mfma_f32_32x32x16_bf16 v[164:179], v[140:143], v[196:199], v[164:179]
    s_waitcnt lgkmcnt(3)
    buffer_load_dwordx4 v66, s[24:27], s3 offen offset:1024 lds
    ds_read_b128 v[192:195], v3 offset:56320
    ds_read_b128 v[232:235], v25 offset:1536
    v_mul_f32 v241, v241, v217
    v_mul_f32 v242, v242, v218
    v_mul_f32 v243, v243, v219
    v_exp_f32 v240, v240
    v_mfma_f32_32x32x16_bf16 v[164:179], v[144:147], v[180:183], v[164:179]
    s_add_u32 m0, s0, 2048
    s_add_u32 s3, s44, 917504
    v_exp_f32 v241, v241
    v_exp_f32 v242, v242
    v_exp_f32 v243, v243
    v_fma_f32 v240, v240, v230, v230
    v_fma_f32 v241, v241, v230, v230
    v_fma_f32 v242, v242, v230, v230
    v_mfma_f32_32x32x16_bf16 v[164:179], v[148:151], v[184:187], v[164:179]
    s_waitcnt lgkmcnt(3)
    s_waitcnt vmcnt(20)
    s_barrier
    buffer_load_dwordx4 v65, s[24:27], s3 offen lds
    ds_read_b128 v[196:199], v27 offset:0
    v_fma_f32 v243, v243, v230, v230
    v_rcp_f32 v240, v240
    v_mfma_f32_32x32x16_bf16 v[164:179], v[152:155], v[200:203], v[164:179]
    ds_read_b128 v[180:183], v27 offset:1024
    v_rcp_f32 v241, v241
    v_rcp_f32 v242, v242
    v_rcp_f32 v243, v243
    v_mul_f32 v240, v240, v216
    v_mul_f32 v241, v241, v217
    v_mfma_f32_32x32x16_bf16 v[164:179], v[156:159], v[188:191], v[164:179]
    s_waitcnt lgkmcnt(4)
    s_waitcnt lgkmcnt(3)
    buffer_load_dwordx4 v66, s[24:27], s3 offen offset:1024 lds
    ds_read_b128 v[184:187], v27 offset:2048
    v_mul_f32 v242, v242, v218
    v_mul_f32 v243, v243, v219
    v_cvt_pk_bf16_f32 v210, v240, v241
    v_cvt_pk_bf16_f32 v211, v242, v243
    v_mfma_f32_32x32x16_bf16 v[164:179], v[160:163], v[192:195], v[164:179]
    buffer_store_dwordx4 v[208:211], v3, s[40:43], s92 offen offset:1024 sc1
    ds_read_b128 v[200:203], v27 offset:3072
    v_mfma_f32_32x32x16_bf16 v[164:179], v[220:223], v[224:227], v[164:179]
    ds_read_b128 v[188:191], v27 offset:4096
    s_waitcnt lgkmcnt(4)
    v_mfma_f32_32x32x16_bf16 v[204:219], v[40:43], v[196:199], 0
    s_waitcnt lgkmcnt(2)
    ds_read_b128 v[192:195], v27 offset:5120
    v_mfma_f32_32x32x16_bf16 v[204:219], v[44:47], v[180:183], v[204:219]
    s_barrier
    s_add_u32 m0, s0, 4096
    s_add_u32 s3, s44, 974848
    ds_read_b128 v[196:199], v27 offset:6144
    v_mfma_f32_32x32x16_bf16 v[204:219], v[48:51], v[184:187], v[204:219]
    s_waitcnt lgkmcnt(2)
    s_add_u32 s92, s77, 0
    buffer_load_dwordx4 v65, s[24:27], s3 offen lds
    ds_read_b128 v[180:183], v27 offset:7168
    v_mul_f32 v236, v164, v164
    v_mul_f32 v237, v165, v165
    v_mul_f32 v238, v166, v166
    v_mul_f32 v239, v167, v167
    v_mfma_f32_32x32x16_bf16 v[204:219], v[52:55], v[200:203], v[204:219]
    ds_read_b128 v[184:187], v27 offset:8192
    v_fma_f32 v236, v236, v233, v232
    v_fma_f32 v237, v237, v233, v232
    v_fma_f32 v238, v238, v233, v232
    v_fma_f32 v239, v239, v233, v232
    v_mul_f32 v236, v236, v164
    v_mul_f32 v237, v237, v165
    v_mul_f32 v238, v238, v166
    v_mul_f32 v239, v239, v167
    v_mfma_f32_32x32x16_bf16 v[204:219], v[56:59], v[188:191], v[204:219]
    s_waitcnt lgkmcnt(2)
    ds_read_b128 v[200:203], v27 offset:9216
    v_exp_f32 v236, v236
    v_exp_f32 v237, v237
    v_exp_f32 v238, v238
    v_mfma_f32_32x32x16_bf16 v[204:219], v[60:63], v[192:195], v[204:219]
    buffer_load_dwordx4 v66, s[24:27], s3 offen offset:1024 lds
    ds_read_b128 v[188:191], v27 offset:10240
    v_exp_f32 v239, v239
    v_fma_f32 v236, v236, v234, v234
    v_fma_f32 v237, v237, v234, v234
    v_fma_f32 v238, v238, v234, v234
    v_fma_f32 v239, v239, v234, v234
    v_mfma_f32_32x32x16_bf16 v[204:219], v[76:79], v[196:199], v[204:219]
    s_waitcnt lgkmcnt(2)
    ds_read_b128 v[192:195], v27 offset:11264
    v_rcp_f32 v236, v236
    v_rcp_f32 v237, v237
    v_rcp_f32 v238, v238
    v_rcp_f32 v239, v239
    v_mfma_f32_32x32x16_bf16 v[204:219], v[80:83], v[180:183], v[204:219]
    s_add_u32 m0, s0, 28672
    s_add_u32 s3, s74, 917504
    ds_read_b128 v[196:199], v27 offset:12288
    v_mul_f32 v236, v236, v164
    v_mul_f32 v237, v237, v165
    v_mul_f32 v238, v238, v166
    v_mul_f32 v239, v239, v167
    v_cvt_pk_bf16_f32 v164, v236, v237
    v_cvt_pk_bf16_f32 v165, v238, v239
    v_mul_f32 v240, v168, v168
    v_mul_f32 v241, v169, v169
    v_mfma_f32_32x32x16_bf16 v[204:219], v[84:87], v[184:187], v[204:219]
    s_waitcnt lgkmcnt(2)
    buffer_load_dwordx4 v65, s[24:27], s3 offen lds
    ds_read_b128 v[180:183], v27 offset:13312
    v_mul_f32 v242, v170, v170
    v_mul_f32 v243, v171, v171
    v_fma_f32 v240, v240, v233, v232
    v_fma_f32 v241, v241, v233, v232
    v_mfma_f32_32x32x16_bf16 v[204:219], v[88:91], v[200:203], v[204:219]
    ds_read_b128 v[184:187], v27 offset:14336
    v_fma_f32 v242, v242, v233, v232
    v_fma_f32 v243, v243, v233, v232
    v_mul_f32 v240, v240, v168
    v_mul_f32 v241, v241, v169
    v_mul_f32 v242, v242, v170
    v_mul_f32 v243, v243, v171
    v_exp_f32 v240, v240
    v_mfma_f32_32x32x16_bf16 v[204:219], v[92:95], v[188:191], v[204:219]
    s_waitcnt lgkmcnt(2)
    ds_read_b128 v[200:203], v27 offset:15360
    v_exp_f32 v241, v241
    v_exp_f32 v242, v242
    v_exp_f32 v243, v243
    v_fma_f32 v240, v240, v234, v234
    v_fma_f32 v241, v241, v234, v234
    v_mfma_f32_32x32x16_bf16 v[204:219], v[96:99], v[192:195], v[204:219]
    ds_read_b128 v[188:191], v27 offset:16384
    v_fma_f32 v242, v242, v234, v234
    v_fma_f32 v243, v243, v234, v234
    v_rcp_f32 v240, v240
    v_rcp_f32 v241, v241
    v_rcp_f32 v242, v242
    v_mfma_f32_32x32x16_bf16 v[204:219], v[100:103], v[196:199], v[204:219]
    s_waitcnt lgkmcnt(2)
    buffer_load_dwordx4 v66, s[24:27], s3 offen offset:1024 lds
    ds_read_b128 v[192:195], v27 offset:17408
    v_rcp_f32 v243, v243
    v_mul_f32 v240, v240, v168
    v_mul_f32 v241, v241, v169
    v_mul_f32 v242, v242, v170
    v_mfma_f32_32x32x16_bf16 v[204:219], v[104:107], v[180:183], v[204:219]
    ds_read_b128 v[196:199], v27 offset:18432
    v_mul_f32 v243, v243, v171
    v_cvt_pk_bf16_f32 v166, v240, v241
    v_cvt_pk_bf16_f32 v167, v242, v243
    v_mul_f32 v236, v172, v172
    v_mul_f32 v237, v173, v173
    v_mul_f32 v238, v174, v174
    v_mfma_f32_32x32x16_bf16 v[204:219], v[108:111], v[184:187], v[204:219]
    s_waitcnt lgkmcnt(2)
    buffer_store_dwordx4 v[164:167], v3, s[40:43], s92 offen offset:0 sc1
    s_add_u32 m0, s0, 30720
    s_add_u32 s3, s74, 974848
    ds_read_b128 v[180:183], v27 offset:19456
    v_mul_f32 v239, v175, v175
    v_fma_f32 v236, v236, v233, v232
    v_fma_f32 v237, v237, v233, v232
    v_fma_f32 v238, v238, v233, v232
    v_fma_f32 v239, v239, v233, v232
    v_mul_f32 v236, v236, v172
    v_mul_f32 v237, v237, v173
    v_mul_f32 v238, v238, v174
    v_mfma_f32_32x32x16_bf16 v[204:219], v[112:115], v[200:203], v[204:219]
    buffer_load_dwordx4 v65, s[24:27], s3 offen lds
    ds_read_b128 v[184:187], v27 offset:20480
    v_mul_f32 v239, v239, v175
    v_exp_f32 v236, v236
    v_exp_f32 v237, v237
    v_mfma_f32_32x32x16_bf16 v[204:219], v[116:119], v[188:191], v[204:219]
    s_waitcnt lgkmcnt(2)
    ds_read_b128 v[200:203], v27 offset:21504
    v_exp_f32 v238, v238
    v_exp_f32 v239, v239
    v_fma_f32 v236, v236, v234, v234
    v_fma_f32 v237, v237, v234, v234
    v_fma_f32 v238, v238, v234, v234
    v_mfma_f32_32x32x16_bf16 v[204:219], v[120:123], v[192:195], v[204:219]
    ds_read_b128 v[188:191], v27 offset:22528
    v_fma_f32 v239, v239, v234, v234
    v_rcp_f32 v236, v236
    v_rcp_f32 v237, v237
    v_rcp_f32 v238, v238
    v_mfma_f32_32x32x16_bf16 v[204:219], v[124:127], v[196:199], v[204:219]
    s_waitcnt lgkmcnt(2)
    buffer_load_dwordx4 v66, s[24:27], s3 offen offset:1024 lds
    ds_read_b128 v[192:195], v27 offset:23552
    s_waitcnt vmcnt(21)
    ds_read_b64_tr_b16 a[144:145], v15 offset:0
    ds_read_b64_tr_b16 a[146:147], v15 offset:1024
    v_rcp_f32 v239, v239
    v_mul_f32 v236, v236, v172
    v_mul_f32 v237, v237, v173
    v_mfma_f32_32x32x16_bf16 v[204:219], v[128:131], v[180:183], v[204:219]
    ds_read_b128 v[196:199], v27 offset:24576
    ds_read_b64_tr_b16 a[148:149], v16 offset:0
    ds_read_b64_tr_b16 a[150:151], v16 offset:1024
    v_mul_f32 v238, v238, v174
    v_mul_f32 v239, v239, v175
    v_cvt_pk_bf16_f32 v168, v236, v237
    v_cvt_pk_bf16_f32 v169, v238, v239
    v_mul_f32 v240, v176, v176
    v_mul_f32 v241, v177, v177
    v_mfma_f32_32x32x16_bf16 v[204:219], v[132:135], v[184:187], v[204:219]
    s_waitcnt lgkmcnt(6)
    ds_read_b128 v[180:183], v27 offset:25600
    s_waitcnt vmcnt(19)
    ds_read_b64_tr_b16 a[152:153], v15 offset:2048
    v_mul_f32 v242, v178, v178
    v_mul_f32 v243, v179, v179
    v_fma_f32 v240, v240, v233, v232
    v_fma_f32 v241, v241, v233, v232
    v_fma_f32 v242, v242, v233, v232
    v_fma_f32 v243, v243, v233, v232
    v_mfma_f32_32x32x16_bf16 v[204:219], v[136:139], v[200:203], v[204:219]
    s_add_u32 m0, s0, 32768
    s_add_u32 s3, s44, 1146880
    ds_read_b128 v[184:187], v27 offset:26624
    ds_read_b64_tr_b16 a[154:155], v15 offset:3072
    ds_read_b64_tr_b16 a[156:157], v16 offset:2048
    ds_read_b128 v[224:227], v25 offset:2048
    v_mul_f32 v240, v240, v176
    v_mul_f32 v241, v241, v177
    v_mul_f32 v242, v242, v178
    v_mul_f32 v243, v243, v179
    v_mfma_f32_32x32x16_bf16 v[204:219], v[140:143], v[188:191], v[204:219]
    s_waitcnt lgkmcnt(8)
    buffer_load_dwordx4 v65, s[24:27], s3 offen lds
    ds_read_b128 v[200:203], v27 offset:27648
    ds_read_b64_tr_b16 a[158:159], v16 offset:3072
    s_waitcnt vmcnt(18)
    ds_read_b64_tr_b16 a[48:49], v15 offset:4096
    ds_read_b128 v[228:231], v25 offset:2560
    v_exp_f32 v240, v240
    v_mfma_f32_32x32x16_bf16 v[204:219], v[144:147], v[192:195], v[204:219]
    ds_read_b64_tr_b16 a[50:51], v15 offset:5120
    ds_read_b64_tr_b16 a[52:53], v16 offset:4096
    v_exp_f32 v241, v241
    v_exp_f32 v242, v242
    v_exp_f32 v243, v243
    v_fma_f32 v240, v240, v234, v234
    v_mfma_f32_32x32x16_bf16 v[204:219], v[148:151], v[196:199], v[204:219]
    s_waitcnt lgkmcnt(9)
    s_waitcnt vmcnt(8)
    s_barrier
    s_cmp_lg_u32 s67, 0
    s_cbranch_scc1 Lg_35
    buffer_store_dwordx2 v[6:7], v9, s[40:43], s51 offen offset:0
Lg_35:
    ds_read_b128 v[188:191], v27 offset:28672
    ds_read_b64_tr_b16 a[54:55], v16 offset:5120
    v_fma_f32 v241, v241, v234, v234
    v_fma_f32 v242, v242, v234, v234
    v_fma_f32 v243, v243, v234, v234
    v_mfma_f32_32x32x16_bf16 v[204:219], v[152:155], v[180:183], v[204:219]
    buffer_load_dwordx4 v66, s[24:27], s3 offen offset:1024 lds
    ds_read_b128 v[192:195], v27 offset:29696
    ds_read_b64_tr_b16 a[160:161], v15 offset:6144
    ds_read_b64_tr_b16 a[162:163], v15 offset:7168
    v_rcp_f32 v240, v240
    v_rcp_f32 v241, v241
    v_mfma_f32_32x32x16_bf16 v[204:219], v[156:159], v[184:187], v[204:219]
    s_waitcnt lgkmcnt(11)
    s_waitcnt lgkmcnt(10)
    ds_read_b128 v[196:199], v27 offset:30720
    ds_read_b64_tr_b16 a[164:165], v16 offset:6144
    ds_read_b64_tr_b16 a[166:167], v16 offset:7168
    v_rcp_f32 v242, v242
    v_rcp_f32 v243, v243
    v_mul_f32 v240, v240, v176
    v_mul_f32 v241, v241, v177
    v_mfma_f32_32x32x16_bf16 v[204:219], v[160:163], v[200:203], v[204:219]
    ds_read_b128 v[180:183], v27 offset:31744
    v_mul_f32 v242, v242, v178
    v_mul_f32 v243, v243, v179
    v_cvt_pk_bf16_f32 v170, v240, v241
    v_cvt_pk_bf16_f32 v171, v242, v243
    v_mfma_f32_32x32x16_bf16 v[204:219], v[220:223], v[224:227], v[204:219]
    buffer_store_dwordx4 v[168:171], v3, s[40:43], s92 offen offset:1024 sc1
    ds_read_b128 v[184:187], v27 offset:32768
    s_waitcnt lgkmcnt(9)
    v_mfma_f32_32x32x16_bf16 v[164:179], v[40:43], v[188:191], 0
    s_waitcnt lgkmcnt(7)
    ds_read_b128 v[200:203], v27 offset:33792
    v_mfma_f32_32x32x16_bf16 v[164:179], v[44:47], v[192:195], v[164:179]
    s_waitcnt lgkmcnt(5)
    s_barrier
    s_add_u32 m0, s45, 0
    s_add_u32 s3, s44, 1204224
    ds_read_b128 v[188:191], v27 offset:34816
    v_mfma_f32_32x32x16_bf16 v[164:179], v[48:51], v[196:199], v[164:179]
    s_waitcnt lgkmcnt(3)
    s_add_u32 s92, s60, 114688
    buffer_load_dwordx4 v65, s[24:27], s3 offen lds
    ds_read_b128 v[192:195], v27 offset:35840
    v_mul_f32 v236, v204, v204
    v_mul_f32 v237, v205, v205
    v_mul_f32 v238, v206, v206
    v_mul_f32 v239, v207, v207
    v_mfma_f32_32x32x16_bf16 v[164:179], v[52:55], v[180:183], v[164:179]
    s_waitcnt lgkmcnt(3)
    buffer_load_dwordx4 v66, s[24:27], s3 offen offset:1024 lds
    ds_read_b128 v[196:199], v27 offset:36864
    v_fma_f32 v236, v236, v229, v228
    v_fma_f32 v237, v237, v229, v228
    v_fma_f32 v238, v238, v229, v228
    v_fma_f32 v239, v239, v229, v228
    v_mul_f32 v236, v236, v204
    v_mul_f32 v237, v237, v205
    v_mul_f32 v238, v238, v206
    v_mfma_f32_32x32x16_bf16 v[164:179], v[56:59], v[184:187], v[164:179]
    s_waitcnt lgkmcnt(3)
    s_add_u32 m0, s45, 2048
    s_add_u32 s3, s74, 1146880
    ds_read_b128 v[180:183], v27 offset:37888
    v_mul_f32 v239, v239, v207
    v_exp_f32 v236, v236
    v_exp_f32 v237, v237
    v_exp_f32 v238, v238
    v_mfma_f32_32x32x16_bf16 v[164:179], v[60:63], v[200:203], v[164:179]
    s_waitcnt lgkmcnt(3)
    buffer_load_dwordx4 v65, s[24:27], s3 offen lds
    ds_read_b128 v[184:187], v27 offset:38912
    v_exp_f32 v239, v239
    v_fma_f32 v236, v236, v230, v230
    v_fma_f32 v237, v237, v230, v230
    v_fma_f32 v238, v238, v230, v230
    v_mfma_f32_32x32x16_bf16 v[164:179], v[76:79], v[188:191], v[164:179]
    s_waitcnt lgkmcnt(3)
    buffer_load_dwordx4 v66, s[24:27], s3 offen offset:1024 lds
    ds_read_b128 v[200:203], v27 offset:39936
    v_fma_f32 v239, v239, v230, v230
    v_rcp_f32 v236, v236
    v_rcp_f32 v237, v237
    v_mfma_f32_32x32x16_bf16 v[164:179], v[80:83], v[192:195], v[164:179]
    s_waitcnt lgkmcnt(3)
    s_add_u32 m0, s45, 4096
    s_add_u32 s3, s74, 1204224
    ds_read_b128 v[188:191], v27 offset:40960
    v_rcp_f32 v238, v238
    v_rcp_f32 v239, v239
    v_mul_f32 v236, v236, v204
    v_mul_f32 v237, v237, v205
    v_mul_f32 v238, v238, v206
    v_mul_f32 v239, v239, v207
    v_cvt_pk_bf16_f32 v204, v236, v237
    v_mfma_f32_32x32x16_bf16 v[164:179], v[84:87], v[196:199], v[164:179]
    s_waitcnt lgkmcnt(3)
    buffer_load_dwordx4 v65, s[24:27], s3 offen lds
    ds_read_b128 v[192:195], v27 offset:41984
    v_cvt_pk_bf16_f32 v205, v238, v239
    v_mul_f32 v240, v208, v208
    v_mul_f32 v241, v209, v209
    v_mul_f32 v242, v210, v210
    v_mul_f32 v243, v211, v211
    v_mfma_f32_32x32x16_bf16 v[164:179], v[88:91], v[180:183], v[164:179]
    s_waitcnt lgkmcnt(3)
    buffer_load_dwordx4 v66, s[24:27], s3 offen offset:1024 lds
    ds_read_b128 v[196:199], v27 offset:43008
    v_fma_f32 v240, v240, v229, v228
    v_fma_f32 v241, v241, v229, v228
    v_fma_f32 v242, v242, v229, v228
    v_fma_f32 v243, v243, v229, v228
    v_mul_f32 v240, v240, v208
    v_mul_f32 v241, v241, v209
    v_mfma_f32_32x32x16_bf16 v[164:179], v[92:95], v[184:187], v[164:179]
    s_waitcnt lgkmcnt(3)
    s_add_u32 m0, s45, 6144
    s_add_u32 s3, s44, 1376256
    ds_read_b128 v[180:183], v27 offset:44032
    v_mul_f32 v242, v242, v210
    v_mul_f32 v243, v243, v211
    v_exp_f32 v240, v240
    v_exp_f32 v241, v241
    v_exp_f32 v242, v242
    v_mfma_f32_32x32x16_bf16 v[164:179], v[96:99], v[200:203], v[164:179]
    s_waitcnt lgkmcnt(3)
    buffer_load_dwordx4 v65, s[24:27], s3 offen lds
    ds_read_b128 v[184:187], v27 offset:45056
    v_exp_f32 v243, v243
    v_fma_f32 v240, v240, v230, v230
    v_fma_f32 v241, v241, v230, v230
    v_fma_f32 v242, v242, v230, v230
    v_fma_f32 v243, v243, v230, v230
    v_mfma_f32_32x32x16_bf16 v[164:179], v[100:103], v[188:191], v[164:179]
    s_waitcnt lgkmcnt(3)
    buffer_load_dwordx4 v66, s[24:27], s3 offen offset:1024 lds
    ds_read_b128 v[200:203], v27 offset:46080
    v_rcp_f32 v240, v240
    v_rcp_f32 v241, v241
    v_rcp_f32 v242, v242
    v_mfma_f32_32x32x16_bf16 v[164:179], v[104:107], v[192:195], v[164:179]
    s_waitcnt lgkmcnt(3)
    s_add_u32 m0, s0, 57344
Lst18:
Lch1:
    s_cbranch_execz Lback2
    s_add_u32 s3, s44, 1433600
    ds_read_b128 v[188:191], v27 offset:47104
    v_rcp_f32 v243, v243
    v_mul_f32 v240, v240, v208
    v_mul_f32 v241, v241, v209
    v_mul_f32 v242, v242, v210
    v_mul_f32 v243, v243, v211
    v_cvt_pk_bf16_f32 v206, v240, v241
    v_cvt_pk_bf16_f32 v207, v242, v243
    v_mfma_f32_32x32x16_bf16 v[164:179], v[108:111], v[196:199], v[164:179]
    s_waitcnt lgkmcnt(3)
    buffer_load_dwordx4 v65, s[24:27], s3 offen lds
    buffer_store_dwordx4 v[204:207], v3, s[40:43], s92 offen offset:0 sc1
    s_cmp_lg_u32 s67, 0
    s_cbranch_scc1 Lg_36
    buffer_store_dwordx2 v[6:7], v10, s[40:43], s51 offen offset:3072 sc1
Lg_36:
    ds_read_b128 v[192:195], v27 offset:48128
    v_mul_f32 v236, v212, v212
    v_mfma_f32_32x32x16_bf16 v[164:179], v[112:115], v[180:183], v[164:179]
    s_waitcnt lgkmcnt(3)
    buffer_load_dwordx4 v66, s[24:27], s3 offen offset:1024 lds
    ds_read_b128 v[196:199], v27 offset:49152
    v_mul_f32 v237, v213, v213
    v_mul_f32 v238, v214, v214
    v_mul_f32 v239, v215, v215
    v_fma_f32 v236, v236, v229, v228
    v_fma_f32 v237, v237, v229, v228
    v_fma_f32 v238, v238, v229, v228
    v_fma_f32 v239, v239, v229, v228
    v_mfma_f32_32x32x16_bf16 v[164:179], v[116:119], v[184:187], v[164:179]
    s_waitcnt lgkmcnt(3)
    s_buffer_load_dwordx16 s[8:23], s[40:43], s54 offset:0
    s_add_u32 m0, s0, 59392
    s_add_u32 s3, s74, 1376256
    ds_read_b128 v[180:183], v27 offset:50176
    v_mul_f32 v236, v236, v212
    v_mul_f32 v237, v237, v213
    v_mul_f32 v238, v238, v214
    v_mul_f32 v239, v239, v215
    v_exp_f32 v236, v236
    v_mfma_f32_32x32x16_bf16 v[164:179], v[120:123], v[200:203], v[164:179]
    s_waitcnt lgkmcnt(3)
    buffer_load_dwordx4 v65, s[24:27], s3 offen lds
    ds_read_b128 v[184:187], v27 offset:51200
    v_exp_f32 v237, v237
    v_exp_f32 v238, v238
    v_mfma_f32_32x32x16_bf16 v[164:179], v[124:127], v[188:191], v[164:179]
    s_waitcnt lgkmcnt(3)
    buffer_load_dwordx4 v66, s[24:27], s3 offen offset:1024 lds
    ds_read_b128 v[200:203], v27 offset:52224
    v_exp_f32 v239, v239
    v_fma_f32 v236, v236, v230, v230
    v_fma_f32 v237, v237, v230, v230
    v_fma_f32 v238, v238, v230, v230
    v_fma_f32 v239, v239, v230, v230
    v_mfma_f32_32x32x16_bf16 v[164:179], v[128:131], v[192:195], v[164:179]
    s_waitcnt lgkmcnt(3)
    s_add_u32 m0, s0, 61440
    s_add_u32 s3, s74, 1433600
    ds_read_b128 v[188:191], v27 offset:53248
    v_rcp_f32 v236, v236
    v_rcp_f32 v237, v237
    v_rcp_f32 v238, v238
    v_rcp_f32 v239, v239
    v_mul_f32 v236, v236, v212
    v_mfma_f32_32x32x16_bf16 v[164:179], v[132:135], v[196:199], v[164:179]
    s_waitcnt lgkmcnt(3)
    buffer_load_dwordx4 v65, s[24:27], s3 offen lds
    ds_read_b128 v[192:195], v27 offset:54272
    v_mul_f32 v237, v237, v213
    v_mul_f32 v238, v238, v214
    v_mul_f32 v239, v239, v215
    v_cvt_pk_bf16_f32 v208, v236, v237
    v_cvt_pk_bf16_f32 v209, v238, v239
    v_mfma_f32_32x32x16_bf16 v[164:179], v[136:139], v[180:183], v[164:179]
    s_waitcnt lgkmcnt(3)
    buffer_load_dwordx4 v66, s[24:27], s3 offen offset:1024 lds
    ds_read_b128 v[196:199], v27 offset:55296
    ds_read_b128 v[224:227], v25 offset:3072
    v_mul_f32 v240, v216, v216
    v_mul_f32 v241, v217, v217
    v_mul_f32 v242, v218, v218
    v_mul_f32 v243, v219, v219
    v_fma_f32 v240, v240, v229, v228
    v_mfma_f32_32x32x16_bf16 v[164:179], v[140:143], v[184:187], v[164:179]
    s_waitcnt lgkmcnt(4)
    s_waitcnt lgkmcnt(0)
    s_xor_b64 s[8:9], s[8:9], s[68:69]
    s_xor_b64 s[10:11], s[10:11], s[68:69]
    s_xor_b64 s[12:13], s[12:13], s[68:69]
    s_xor_b64 s[14:15], s[14:15], s[68:69]
    ds_read_b128 v[180:183], v27 offset:56320
    ds_read_b128 v[232:235], v25 offset:3584
    v_fma_f32 v241, v241, v229, v228
    v_fma_f32 v242, v242, v229, v228
    v_fma_f32 v243, v243, v229, v228
    v_mul_f32 v240, v240, v216
    v_mul_f32 v241, v241, v217
    v_mfma_f32_32x32x16_bf16 v[164:179], v[144:147], v[200:203], v[164:179]
    s_xor_b64 s[16:17], s[16:17], s[68:69]
    s_xor_b64 s[18:19], s[18:19], s[68:69]
    s_xor_b64 s[20:21], s[20:21], s[68:69]
    s_or_b64 s[8:9], s[8:9], s[10:11]
    v_mul_f32 v242, v242, v218
    v_mul_f32 v243, v243, v219
    v_exp_f32 v240, v240
    v_exp_f32 v241, v241
    v_exp_f32 v242, v242
    v_mfma_f32_32x32x16_bf16 v[164:179], v[148:151], v[188:191], v[164:179]
    s_waitcnt vmcnt(15)
    s_barrier
    s_or_b64 s[8:9], s[8:9], s[12:13]
    s_or_b64 s[8:9], s[8:9], s[14:15]
    s_or_b64 s[8:9], s[8:9], s[16:17]
    s_or_b64 s[8:9], s[8:9], s[18:19]
    s_cmp_lg_u32 s67, 0
    s_cbranch_scc1 Lg_37
    buffer_store_dwordx2 v[6:7], v9, s[40:43], s51 offen offset:256
Lg_37:
    s_add_u32 s3, s61, 0
    v_exp_f32 v243, v243
    v_fma_f32 v240, v240, v230, v230
    v_fma_f32 v241, v241, v230, v230
    v_fma_f32 v242, v242, v230, v230
    v_mfma_f32_32x32x16_bf16 v[164:179], v[152:155], v[192:195], v[164:179]
    s_or_b64 s[8:9], s[8:9], s[20:21]
    s_cbranch_scc1 Lslow3_0
Lok3_0:
    buffer_load_dwordx4 a[224:227], v3, s[40:43], s3 offen sc1
    s_add_u32 s3, s61, 4096
    buffer_load_dwordx4 a[228:231], v3, s[40:43], s3 offen sc1
    s_add_u32 s3, s61, 16384
    v_fma_f32 v243, v243, v230, v230
    v_rcp_f32 v240, v240
    v_mfma_f32_32x32x16_bf16 v[164:179], v[156:159], v[196:199], v[164:179]
    s_waitcnt lgkmcnt(1)
    buffer_load_dwordx4 a[232:235], v3, s[40:43], s3 offen sc1
    s_add_u32 s3, s61, 20480
    v_rcp_f32 v241, v241
    v_rcp_f32 v242, v242
    v_rcp_f32 v243, v243
    v_mul_f32 v240, v240, v216
    v_mfma_f32_32x32x16_bf16 v[164:179], v[160:163], v[180:183], v[164:179]
    buffer_load_dwordx4 a[236:239], v3, s[40:43], s3 offen sc1
    v_mul_f32 v241, v241, v217
    v_mul_f32 v242, v242, v218
    v_mul_f32 v243, v243, v219
    v_cvt_pk_bf16_f32 v210, v240, v241
    v_cvt_pk_bf16_f32 v211, v242, v243
    v_mfma_f32_32x32x16_bf16 v[164:179], v[220:223], v[224:227], v[164:179]
    buffer_store_dwordx4 v[208:211], v3, s[40:43], s92 offen offset:1024 sc1
    s_add_u32 s3, s61, 32768
    buffer_load_dwordx4 a[240:243], v3, s[40:43], s3 offen sc1
    s_add_u32 s3, s61, 36864
    buffer_load_dwordx4 a[244:247], v3, s[40:43], s3 offen sc1
    s_add_u32 s3, s61, 49152
    buffer_load_dwordx4 a[248:251], v3, s[40:43], s3 offen sc1
    s_add_u32 s92, s77, 114688
    s_nop 3
    v_pk_mul_f32 v[236:237], v[164:165], v[164:165]
    v_pk_mul_f32 v[238:239], v[166:167], v[166:167]
    s_waitcnt lgkmcnt(0)
    v_pk_fma_f32 v[236:237], v[236:237], v[232:233], v[232:233] op_sel:[0,1,0] op_sel_hi:[1,1,0]
    v_pk_fma_f32 v[238:239], v[238:239], v[232:233], v[232:233] op_sel:[0,1,0] op_sel_hi:[1,1,0]
    v_pk_mul_f32 v[236:237], v[236:237], v[164:165]
    v_pk_mul_f32 v[238:239], v[238:239], v[166:167]
    v_exp_f32 v236, v236
    v_exp_f32 v237, v237
    s_add_u32 s3, s61, 53248
    buffer_load_dwordx4 a[252:255], v3, s[40:43], s3 offen sc1
    v_exp_f32 v238, v238
    v_exp_f32 v239, v239
    v_pk_fma_f32 v[236:237], v[236:237], v[234:235], v[234:235] op_sel_hi:[1,0,0]
    v_pk_fma_f32 v[238:239], v[238:239], v[234:235], v[234:235] op_sel_hi:[1,0,0]
    v_rcp_f32 v236, v236
    v_rcp_f32 v237, v237
    v_rcp_f32 v238, v238
    v_rcp_f32 v239, v239
    v_pk_mul_f32 v[236:237], v[236:237], v[164:165]
    v_pk_mul_f32 v[238:239], v[238:239], v[166:167]
    s_add_u32 s3, s61, 65536
    buffer_load_dwordx4 v[40:43], v3, s[40:43], s3 offen sc1
    v_cvt_pk_bf16_f32 v164, v236, v237
    v_cvt_pk_bf16_f32 v165, v238, v239
    v_pk_mul_f32 v[240:241], v[168:169], v[168:169]
    v_pk_mul_f32 v[242:243], v[170:171], v[170:171]
    v_pk_fma_f32 v[240:241], v[240:241], v[232:233], v[232:233] op_sel:[0,1,0] op_sel_hi:[1,1,0]
    v_pk_fma_f32 v[242:243], v[242:243], v[232:233], v[232:233] op_sel:[0,1,0] op_sel_hi:[1,1,0]
    v_pk_mul_f32 v[240:241], v[240:241], v[168:169]
    v_pk_mul_f32 v[242:243], v[242:243], v[170:171]
    v_exp_f32 v240, v240
    v_exp_f32 v241, v241
    s_add_u32 s3, s61, 69632
    buffer_load_dwordx4 v[44:47], v3, s[40:43], s3 offen sc1
    v_exp_f32 v242, v242
    v_exp_f32 v243, v243
    v_pk_fma_f32 v[240:241], v[240:241], v[234:235], v[234:235] op_sel_hi:[1,0,0]
    v_pk_fma_f32 v[242:243], v[242:243], v[234:235], v[234:235] op_sel_hi:[1,0,0]
    v_rcp_f32 v240, v240
    v_rcp_f32 v241, v241
    v_rcp_f32 v242, v242
    v_rcp_f32 v243, v243
    v_pk_mul_f32 v[240:241], v[240:241], v[168:169]
    v_pk_mul_f32 v[242:243], v[242:243], v[170:171]
    s_add_u32 s3, s61, 81920
    buffer_load_dwordx4 v[48:51], v3, s[40:43], s3 offen sc1
    v_cvt_pk_bf16_f32 v166, v240, v241
    v_cvt_pk_bf16_f32 v167, v242, v243
    v_pk_mul_f32 v[236:237], v[172:173], v[172:173]
    v_pk_mul_f32 v[238:239], v[174:175], v[174:175]
    v_pk_fma_f32 v[236:237], v[236:237], v[232:233], v[232:233] op_sel:[0,1,0] op_sel_hi:[1,1,0]
    v_pk_fma_f32 v[238:239], v[238:239], v[232:233], v[232:233] op_sel:[0,1,0] op_sel_hi:[1,1,0]
    v_pk_mul_f32 v[236:237], v[236:237], v[172:173]
    v_pk_mul_f32 v[238:239], v[238:239], v[174:175]
    v_exp_f32 v236, v236
    v_exp_f32 v237, v237
    s_add_u32 s3, s61, 86016
    buffer_load_dwordx4 v[52:55], v3, s[40:43], s3 offen sc1
    v_exp_f32 v238, v238
    v_exp_f32 v239, v239
    v_pk_fma_f32 v[236:237], v[236:237], v[234:235], v[234:235] op_sel_hi:[1,0,0]
    v_pk_fma_f32 v[238:239], v[238:239], v[234:235], v[234:235] op_sel_hi:[1,0,0]
    v_rcp_f32 v236, v236
    v_rcp_f32 v237, v237
    v_rcp_f32 v238, v238
    v_rcp_f32 v239, v239
    v_pk_mul_f32 v[236:237], v[236:237], v[172:173]
    v_pk_mul_f32 v[238:239], v[238:239], v[174:175]
    s_add_u32 s3, s61, 98304
    buffer_load_dwordx4 v[56:59], v3, s[40:43], s3 offen sc1
    v_cvt_pk_bf16_f32 v168, v236, v237
    v_cvt_pk_bf16_f32 v169, v238, v239
    v_pk_mul_f32 v[240:241], v[176:177], v[176:177]
    v_pk_mul_f32 v[242:243], v[178:179], v[178:179]
    v_pk_fma_f32 v[240:241], v[240:241], v[232:233], v[232:233] op_sel:[0,1,0] op_sel_hi:[1,1,0]
    v_pk_fma_f32 v[242:243], v[242:243], v[232:233], v[232:233] op_sel:[0,1,0] op_sel_hi:[1,1,0]
    v_pk_mul_f32 v[240:241], v[240:241], v[176:177]
    v_pk_mul_f32 v[242:243], v[242:243], v[178:179]
    v_exp_f32 v240, v240
    v_exp_f32 v241, v241
    s_add_u32 s3, s61, 102400
    buffer_load_dwordx4 v[60:63], v3, s[40:43], s3 offen sc1
    v_exp_f32 v242, v242
    v_exp_f32 v243, v243
    v_pk_fma_f32 v[240:241], v[240:241], v[234:235], v[234:235] op_sel_hi:[1,0,0]
    v_pk_fma_f32 v[242:243], v[242:243], v[234:235], v[234:235] op_sel_hi:[1,0,0]
    v_rcp_f32 v240, v240
    v_rcp_f32 v241, v241
    v_rcp_f32 v242, v242
    v_rcp_f32 v243, v243
    v_pk_mul_f32 v[240:241], v[240:241], v[176:177]
    v_pk_mul_f32 v[242:243], v[242:243], v[178:179]
    v_cvt_pk_bf16_f32 v170, v240, v241
    v_cvt_pk_bf16_f32 v171, v242, v243
    buffer_store_dwordx4 v[164:167], v3, s[40:43], s92 offen offset:0 sc1
    s_cmp_lg_u32 s67, 0
    s_cbranch_scc1 Lg_38
    buffer_store_dwordx2 v[6:7], v10, s[40:43], s51 offen offset:3328 sc1
Lg_38:
    buffer_store_dwordx4 v[168:171], v3, s[40:43], s92 offen offset:1024 sc1
    s_waitcnt vmcnt(16)
    v_mfma_f32_32x32x16_bf16 v[204:219], a[0:3], a[224:227], 0
    ds_read_b64_tr_b16 a[56:57], v15 offset:8192
    ds_read_b64_tr_b16 a[58:59], v15 offset:9216
    v_and_b32 v11, 15, v2
    v_mul_u32_u24 v11, 144, v11
    v_mfma_f32_32x32x16_bf16 v[140:155], a[4:7], a[224:227], 0
    ds_read_b64_tr_b16 a[60:61], v16 offset:8192
    ds_read_b64_tr_b16 a[62:63], v16 offset:9216
    v_lshrrev_b32 v14, 4, v2
    v_lshl_add_u32 v11, v14, 3, v11
    s_waitcnt vmcnt(15)
    v_mfma_f32_32x32x16_bf16 v[204:219], a[8:11], a[228:231], v[204:219]
    s_mul_i32 s92, s67, 2304
    s_add_u32 s92, s92, 86016
    ds_read_b64_tr_b16 a[64:65], v17 offset:2048
    ds_read_b64_tr_b16 a[66:67], v17 offset:3072
    ds_read_b64_tr_b16 a[68:69], v18 offset:2048
    v_mfma_f32_32x32x16_bf16 v[140:155], a[12:15], a[228:231], v[140:155]
    s_mul_i32 s93, s67, 17408
    ds_read_b64_tr_b16 a[70:71], v18 offset:3072
    v_add_u32 v11, s92, v11
    v_and_b32 v19, 31, v2
    s_waitcnt vmcnt(14)
    v_mfma_f32_32x32x16_bf16 v[204:219], a[16:19], a[232:235], v[204:219]
    s_buffer_load_dwordx16 s[8:23], s[40:43], s81 offset:256
    ds_read_b64_tr_b16 a[72:73], v17 offset:4096
    ds_read_b64_tr_b16 a[74:75], v17 offset:5120
    ds_read_b64_tr_b16 a[76:77], v18 offset:4096
    v_mfma_f32_32x32x16_bf16 v[140:155], a[20:23], a[232:235], v[140:155]
    ds_read_b64_tr_b16 a[78:79], v18 offset:5120
    ds_read_b64_tr_b16 a[80:81], v17 offset:32768
    v_mul_u32_u24 v19, 272, v19
    v_lshrrev_b32 v14, 5, v2
    s_waitcnt vmcnt(13)
    v_mfma_f32_32x32x16_bf16 v[204:219], a[24:27], a[236:239], v[204:219]
    ds_read_b64_tr_b16 a[82:83], v17 offset:33792
    ds_read_b64_tr_b16 a[84:85], v18 offset:32768
    v_lshl_add_u32 v19, v14, 4, v19
    v_add_u32 v19, s93, v19
    v_mfma_f32_32x32x16_bf16 v[140:155], a[28:31], a[236:239], v[140:155]
    ds_read_b64_tr_b16 a[86:87], v18 offset:33792
    ds_read_b64_tr_b16 a[88:89], v15 offset:0
    v_lshrrev_b32 v26, 3, v0
    v_and_b32 v14, 7, v0
    s_waitcnt vmcnt(11)
    v_mfma_f32_32x32x16_bf16 v[204:219], a[32:35], a[240:243], v[204:219]
    ds_read_b64_tr_b16 a[90:91], v15 offset:1024
    ds_read_b64_tr_b16 a[92:93], v16 offset:0
    ds_read_b64_tr_b16 a[94:95], v16 offset:1024
    v_mul_u32_u24 v24, 272, v26
    v_mfma_f32_32x32x16_bf16 v[140:155], a[36:39], a[240:243], v[140:155]
    ds_read_b64_tr_b16 a[96:97], v15 offset:6144
    v_lshl_add_u32 v24, v14, 5, v24
    v_mul_u32_u24 v25, 144, v26
    v_lshl_add_u32 v25, v14, 4, v25
    s_waitcnt vmcnt(10)
    v_mfma_f32_32x32x16_bf16 v[204:219], a[40:43], a[244:247], v[204:219]
    ds_read_b64_tr_b16 a[98:99], v15 offset:7168
    ds_read_b64_tr_b16 a[100:101], v16 offset:6144
    ds_read_b64_tr_b16 a[102:103], v16 offset:7168
    v_add_u32 v25, 86016, v25
    v_mfma_f32_32x32x16_bf16 v[140:155], a[44:47], a[244:247], v[140:155]
    s_barrier
    s_waitcnt lgkmcnt(0)
    s_xor_b64 s[8:9], s[8:9], s[68:69]
    s_xor_b64 s[10:11], s[10:11], s[68:69]
    s_xor_b64 s[12:13], s[12:13], s[68:69]
    s_xor_b64 s[14:15], s[14:15], s[68:69]
    s_cmp_lg_u32 s67, 0
    s_cbranch_scc1 Lg_39
    buffer_store_dwordx2 v[6:7], v9, s[40:43], s51 offen offset:512
Lg_39:
    ds_read_b64_tr_b16 a[104:105], v17 offset:57344
    ds_read_b64_tr_b16 a[106:107], v17 offset:58368
    s_waitcnt vmcnt(9)
    v_mfma_f32_32x32x16_bf16 v[204:219], a[48:51], a[248:251], v[204:219]
    s_xor_b64 s[16:17], s[16:17], s[68:69]
    s_xor_b64 s[18:19], s[18:19], s[68:69]
    s_xor_b64 s[20:21], s[20:21], s[68:69]
    s_or_b64 s[8:9], s[8:9], s[10:11]
    ds_read_b64_tr_b16 a[108:109], v18 offset:57344
    ds_read_b64_tr_b16 a[110:111], v18 offset:58368
    v_mfma_f32_32x32x16_bf16 v[140:155], a[52:55], a[248:251], v[140:155]
    s_or_b64 s[8:9], s[8:9], s[12:13]
    s_or_b64 s[8:9], s[8:9], s[14:15]
    s_or_b64 s[8:9], s[8:9], s[16:17]
    s_or_b64 s[8:9], s[8:9], s[18:19]
    s_add_u32 s3, s80, 0
    ds_read_b64_tr_b16 a[168:169], v17 offset:0
    ds_read_b64_tr_b16 a[170:171], v17 offset:1024
    s_waitcnt vmcnt(8)
    v_mfma_f32_32x32x16_bf16 v[204:219], a[56:59], a[252:255], v[204:219]
    s_or_b64 s[8:9], s[8:9], s[20:21]
    s_cbranch_scc1 Lslow3_1
Lok3_1:
    buffer_load_dwordx4 v[76:79], v3, s[40:43], s3 offen sc1
    s_add_u32 s3, s80, 4096
    ds_read_b64_tr_b16 a[172:173], v18 offset:0
    ds_read_b64_tr_b16 a[174:175], v18 offset:1024
    v_mfma_f32_32x32x16_bf16 v[140:155], a[60:63], a[252:255], v[140:155]
    buffer_load_dwordx4 v[80:83], v3, s[40:43], s3 offen sc1
    s_add_u32 s3, s80, 16384
    ds_read_b64_tr_b16 a[176:177], v17 offset:28672
    s_waitcnt vmcnt(9)
    v_mfma_f32_32x32x16_bf16 v[204:219], a[64:67], v[40:43], v[204:219]
    buffer_load_dwordx4 v[84:87], v3, s[40:43], s3 offen sc1
    s_add_u32 s3, s80, 20480
    ds_read_b64_tr_b16 a[178:179], v17 offset:29696
    ds_read_b64_tr_b16 a[180:181], v18 offset:28672
    v_mfma_f32_32x32x16_bf16 v[140:155], a[68:71], v[40:43], v[140:155]
    buffer_load_dwordx4 v[88:91], v3, s[40:43], s3 offen sc1
    s_add_u32 s3, s80, 32768
    ds_read_b64_tr_b16 a[182:183], v18 offset:29696
    s_waitcnt vmcnt(10)
    v_mfma_f32_32x32x16_bf16 v[204:219], a[72:75], v[44:47], v[204:219]
    buffer_load_dwordx4 v[92:95], v3, s[40:43], s3 offen sc1
    ds_read_b64_tr_b16 a[184:185], v17 offset:30720
    ds_read_b64_tr_b16 a[186:187], v17 offset:31744
    v_mfma_f32_32x32x16_bf16 v[140:155], a[76:79], v[44:47], v[140:155]
    s_add_u32 s3, s80, 36864
    ds_read_b64_tr_b16 a[188:189], v18 offset:30720
    ds_read_b64_tr_b16 a[190:191], v18 offset:31744
    v_mul_u32_u24 v26, 896, v26
    v_lshl_add_u32 v26, v14, 4, v26
    s_waitcnt vmcnt(10)
    v_mfma_f32_32x32x16_bf16 v[204:219], a[80:83], v[48:51], v[204:219]
    s_mul_i32 s78, s64, 57344
    buffer_load_dwordx4 v[96:99], v3, s[40:43], s3 offen sc1
    ds_read_b64_tr_b16 a[192:193], v15 offset:2048
    v_mfma_f32_32x32x16_bf16 v[140:155], a[84:87], v[48:51], v[140:155]
    s_mul_i32 s95, s66, 128
    s_add_u32 s78, s78, s95
    s_add_u32 s79, s78, 28672
    s_add_u32 s3, s80, 49152
    ds_read_b64_tr_b16 a[194:195], v15 offset:3072
    ds_read_b64_tr_b16 a[196:197], v16 offset:2048
    s_waitcnt vmcnt(10)
    v_mfma_f32_32x32x16_bf16 v[204:219], a[88:91], v[52:55], v[204:219]
    buffer_load_dwordx4 v[100:103], v3, s[40:43], s3 offen sc1
    ds_read_b64_tr_b16 a[198:199], v16 offset:3072
    v_lshlrev_b32 v68, 16, v28
    v_mfma_f32_32x32x16_bf16 v[140:155], a[92:95], v[52:55], v[140:155]
    ds_read_b64_tr_b16 a[200:201], v15 offset:4096
    ds_read_b64_tr_b16 a[202:203], v15 offset:5120
    v_and_b32 v69, 0xffff0000, v28
    v_lshlrev_b32 v70, 16, v29
    s_waitcnt vmcnt(10)
    v_mfma_f32_32x32x16_bf16 v[204:219], a[96:99], v[56:59], v[204:219]
    s_waitcnt vmcnt(7)
    s_barrier
    s_cmp_lg_u32 s67, 0
    s_cbranch_scc1 Lg_40
    buffer_store_dwordx2 v[6:7], v9, s[40:43], s51 offen offset:768
Lg_40:
    s_add_u32 s3, s80, 53248
    buffer_load_dwordx4 v[104:107], v3, s[40:43], s3 offen sc1
    ds_read_b64_tr_b16 a[204:205], v16 offset:4096
    ds_read_b64_tr_b16 a[206:207], v16 offset:5120
    v_mfma_f32_32x32x16_bf16 v[140:155], a[100:103], v[56:59], v[140:155]
    s_add_u32 s3, s80, 65536
    ds_read_b64_tr_b16 a[208:209], v17 offset:59392
    v_and_b32 v71, 0xffff0000, v29
    v_lshlrev_b32 v72, 16, v30
    v_and_b32 v73, 0xffff0000, v30
    s_waitcnt lgkmcnt(15)
    v_mfma_f32_32x32x16_bf16 v[204:219], a[104:107], v[60:63], v[204:219]
    buffer_load_dwordx4 v[108:111], v3, s[40:43], s3 offen sc1
    ds_read_b64_tr_b16 a[210:211], v17 offset:60416
    ds_read_b64_tr_b16 a[212:213], v18 offset:59392
    v_mfma_f32_32x32x16_bf16 v[140:155], a[108:111], v[60:63], v[140:155]
    ds_read_b64_tr_b16 a[214:215], v18 offset:60416
    v_lshlrev_b32 v74, 16, v31
    v_and_b32 v75, 0xffff0000, v31
    s_waitcnt vmcnt(8)
    v_mfma_f32_32x32x16_bf16 v[204:219], a[112:115], v[76:79], v[204:219]
    s_add_u32 s3, s80, 69632
    ds_read_b64_tr_b16 a[216:217], v17 offset:61440
    ds_read_b64_tr_b16 a[218:219], v17 offset:62464
    v_mfma_f32_32x32x16_bf16 v[140:155], a[116:119], v[76:79], v[140:155]
    buffer_load_dwordx4 v[112:115], v3, s[40:43], s3 offen sc1
    ds_read_b64_tr_b16 a[220:221], v18 offset:61440
    ds_read_b64_tr_b16 a[222:223], v18 offset:62464
    s_waitcnt vmcnt(8)
    v_mfma_f32_32x32x16_bf16 v[204:219], a[120:123], v[80:83], v[204:219]
    s_add_u32 s3, s80, 81920
    ds_write_b64 v11, v[32:33] offset:0
    v_mfma_f32_32x32x16_bf16 v[140:155], a[124:127], v[80:83], v[140:155]
    buffer_load_dwordx4 v[116:119], v3, s[40:43], s3 offen sc1
    ds_write_b64 v11, v[34:35] offset:32
    s_waitcnt vmcnt(8)
    v_mfma_f32_32x32x16_bf16 v[204:219], a[128:131], v[84:87], v[204:219]
    s_add_u32 s3, s80, 86016
    ds_write_b64 v11, v[36:37] offset:64
    v_mfma_f32_32x32x16_bf16 v[140:155], a[132:135], v[84:87], v[140:155]
    buffer_load_dwordx4 v[120:123], v3, s[40:43], s3 offen sc1
    ds_write_b64 v11, v[38:39] offset:96
    s_waitcnt vmcnt(8)
    v_mfma_f32_32x32x16_bf16 v[204:219], a[136:139], v[88:91], v[204:219]
    s_buffer_load_dwordx16 s[8:23], s[40:43], s54 offset:512
    s_add_u32 s3, s80, 98304
    v_mfma_f32_32x32x16_bf16 v[140:155], a[140:143], v[88:91], v[140:155]
    buffer_load_dwordx4 v[124:127], v3, s[40:43], s3 offen sc1
    s_waitcnt vmcnt(8)
    v_mfma_f32_32x32x16_bf16 v[204:219], a[144:147], v[92:95], v[204:219]
    s_add_u32 s3, s80, 102400
    v_mfma_f32_32x32x16_bf16 v[140:155], a[148:151], v[92:95], v[140:155]
    buffer_load_dwordx4 v[128:131], v3, s[40:43], s3 offen sc1
    s_waitcnt vmcnt(8)
    v_mfma_f32_32x32x16_bf16 v[204:219], a[152:155], v[96:99], v[204:219]
    v_mfma_f32_32x32x16_bf16 v[140:155], a[156:159], v[96:99], v[140:155]
    s_waitcnt vmcnt(7)
    v_mfma_f32_32x32x16_bf16 v[204:219], a[160:163], v[100:103], v[204:219]
    v_mfma_f32_32x32x16_bf16 v[140:155], a[164:167], v[100:103], v[140:155]
    s_waitcnt lgkmcnt(0)
    s_xor_b64 s[8:9], s[8:9], s[68:69]
    s_xor_b64 s[10:11], s[10:11], s[68:69]
    s_xor_b64 s[12:13], s[12:13], s[68:69]
    s_xor_b64 s[14:15], s[14:15], s[68:69]
    s_waitcnt vmcnt(6)
    v_mfma_f32_32x32x16_bf16 v[204:219], a[168:171], v[104:107], v[204:219]
    s_xor_b64 s[16:17], s[16:17], s[68:69]
    s_xor_b64 s[18:19], s[18:19], s[68:69]
    s_xor_b64 s[20:21], s[20:21], s[68:69]
    s_or_b64 s[8:9], s[8:9], s[10:11]
    v_mfma_f32_32x32x16_bf16 v[140:155], a[172:175], v[104:107], v[140:155]
    s_or_b64 s[8:9], s[8:9], s[12:13]
    s_or_b64 s[8:9], s[8:9], s[14:15]
    s_or_b64 s[8:9], s[8:9], s[16:17]
    s_or_b64 s[8:9], s[8:9], s[18:19]
    s_add_u32 s3, s61, 114688
    s_waitcnt vmcnt(5)
    v_mfma_f32_32x32x16_bf16 v[204:219], a[176:179], v[108:111], v[204:219]
    s_or_b64 s[8:9], s[8:9], s[20:21]
    s_cbranch_scc1 Lslow3_2
Lok3_2:
    buffer_load_dwordx4 v[132:135], v3, s[40:43], s3 offen sc1
    s_add_u32 s3, s61, 118784
    v_mfma_f32_32x32x16_bf16 v[140:155], a[180:183], v[108:111], v[140:155]
    buffer_load_dwordx4 v[136:139], v3, s[40:43], s3 offen sc1
    s_add_u32 s3, s61, 131072
    s_waitcnt vmcnt(6)
    v_mfma_f32_32x32x16_bf16 v[204:219], a[184:187], v[112:115], v[204:219]
    buffer_load_dwordx4 a[224:227], v3, s[40:43], s3 offen sc1
    s_add_u32 s3, s61, 135168
    v_mfma_f32_32x32x16_bf16 v[140:155], a[188:191], v[112:115], v[140:155]
    buffer_load_dwordx4 a[228:231], v3, s[40:43], s3 offen sc1
    s_add_u32 s3, s61, 147456
    s_waitcnt vmcnt(7)
    v_mfma_f32_32x32x16_bf16 v[204:219], a[192:195], v[116:119], v[204:219]
    buffer_load_dwordx4 a[232:235], v3, s[40:43], s3 offen sc1
    v_mfma_f32_32x32x16_bf16 v[140:155], a[196:199], v[116:119], v[140:155]
    s_add_u32 s3, s61, 151552
    s_waitcnt vmcnt(7)
    v_mfma_f32_32x32x16_bf16 v[204:219], a[200:203], v[120:123], v[204:219]
    buffer_load_dwordx4 a[236:239], v3, s[40:43], s3 offen sc1
    v_mfma_f32_32x32x16_bf16 v[140:155], a[204:207], v[120:123], v[140:155]
    s_add_u32 s3, s61, 163840
    s_waitcnt vmcnt(7)
    v_mfma_f32_32x32x16_bf16 v[204:219], a[208:211], v[124:127], v[204:219]
    buffer_load_dwordx4 a[240:243], v3, s[40:43], s3 offen sc1
    v_mfma_f32_32x32x16_bf16 v[140:155], a[212:215], v[124:127], v[140:155]
    s_add_u32 s3, s61, 167936
    s_waitcnt vmcnt(7)
    v_mfma_f32_32x32x16_bf16 v[204:219], a[216:219], v[128:131], v[204:219]
    buffer_load_dwordx4 a[244:247], v3, s[40:43], s3 offen sc1
    v_mfma_f32_32x32x16_bf16 v[140:155], a[220:223], v[128:131], v[140:155]
    s_add_u32 s3, s61, 180224
    s_waitcnt vmcnt(7)
    v_mfma_f32_32x32x16_bf16 v[156:171], a[0:3], v[132:135], 0
    s_buffer_load_dwordx16 s[8:23], s[40:43], s81 offset:768
    buffer_load_dwordx4 a[248:251], v3, s[40:43], s3 offen sc1
    v_mfma_f32_32x32x16_bf16 v[172:187], a[4:7], v[132:135], 0
    s_barrier
    s_waitcnt vmcnt(7)
    v_mfma_f32_32x32x16_bf16 v[156:171], a[8:11], v[136:139], v[156:171]
    s_add_u32 s3, s61, 184320
    ds_write_b128 v19, v[204:207] offset:0
    v_mfma_f32_32x32x16_bf16 v[172:187], a[12:15], v[136:139], v[172:187]
    buffer_load_dwordx4 a[252:255], v3, s[40:43], s3 offen sc1
    s_waitcnt vmcnt(7)
    v_mfma_f32_32x32x16_bf16 v[156:171], a[16:19], a[224:227], v[156:171]
    s_add_u32 s3, s61, 196608
    ds_write_b128 v19, v[208:211] offset:32
    v_mfma_f32_32x32x16_bf16 v[172:187], a[20:23], a[224:227], v[172:187]
    buffer_load_dwordx4 v[40:43], v3, s[40:43], s3 offen sc1
    s_waitcnt vmcnt(7)
    v_mfma_f32_32x32x16_bf16 v[156:171], a[24:27], a[228:231], v[156:171]
    s_add_u32 s3, s61, 200704
    ds_write_b128 v19, v[212:215] offset:64
    v_mfma_f32_32x32x16_bf16 v[172:187], a[28:31], a[228:231], v[172:187]
    s_waitcnt lgkmcnt(0)
    s_xor_b64 s[8:9], s[8:9], s[68:69]
    s_xor_b64 s[10:11], s[10:11], s[68:69]
    s_xor_b64 s[12:13], s[12:13], s[68:69]
    s_xor_b64 s[14:15], s[14:15], s[68:69]
    buffer_load_dwordx4 v[44:47], v3, s[40:43], s3 offen sc1
    s_waitcnt vmcnt(7)
    v_mfma_f32_32x32x16_bf16 v[156:171], a[32:35], a[232:235], v[156:171]
    s_xor_b64 s[16:17], s[16:17], s[68:69]
    s_xor_b64 s[18:19], s[18:19], s[68:69]
    s_xor_b64 s[20:21], s[20:21], s[68:69]
    s_or_b64 s[8:9], s[8:9], s[10:11]
    s_add_u32 s3, s61, 212992
    ds_write_b128 v19, v[216:219] offset:96
    v_mfma_f32_32x32x16_bf16 v[172:187], a[36:39], a[232:235], v[172:187]
    s_or_b64 s[8:9], s[8:9], s[12:13]
    s_or_b64 s[8:9], s[8:9], s[14:15]
    s_or_b64 s[8:9], s[8:9], s[16:17]
    s_or_b64 s[8:9], s[8:9], s[18:19]
    buffer_load_dwordx4 v[48:51], v3, s[40:43], s3 offen sc1
    s_add_u32 s3, s80, 114688
    s_waitcnt vmcnt(7)
    v_mfma_f32_32x32x16_bf16 v[156:171], a[40:43], a[236:239], v[156:171]
    s_or_b64 s[8:9], s[8:9], s[20:21]
    s_cbranch_scc1 Lslow3_3
Lok3_3:
    buffer_load_dwordx4 v[56:59], v3, s[40:43], s3 offen sc1
    s_add_u32 s3, s61, 217088
    ds_write_b128 v19, v[140:143] offset:128
    v_mfma_f32_32x32x16_bf16 v[172:187], a[44:47], a[236:239], v[172:187]
    buffer_load_dwordx4 v[52:55], v3, s[40:43], s3 offen sc1
    s_add_u32 s3, s80, 118784
    buffer_load_dwordx4 v[60:63], v3, s[40:43], s3 offen sc1
    s_add_u32 s3, s80, 131072
    s_waitcnt vmcnt(9)
    v_mfma_f32_32x32x16_bf16 v[156:171], a[48:51], a[240:243], v[156:171]
    buffer_load_dwordx4 v[76:79], v3, s[40:43], s3 offen sc1
    s_add_u32 s3, s80, 135168
    ds_write_b128 v19, v[144:147] offset:160
    v_mfma_f32_32x32x16_bf16 v[172:187], a[52:55], a[240:243], v[172:187]
    buffer_load_dwordx4 v[80:83], v3, s[40:43], s3 offen sc1
    s_add_u32 s3, s80, 147456
    s_waitcnt vmcnt(10)
    v_mfma_f32_32x32x16_bf16 v[156:171], a[56:59], a[244:247], v[156:171]
    buffer_load_dwordx4 v[84:87], v3, s[40:43], s3 offen sc1
    ds_write_b128 v19, v[148:151] offset:192
    v_mfma_f32_32x32x16_bf16 v[172:187], a[60:63], a[244:247], v[172:187]
    s_add_u32 s3, s80, 151552
    s_waitcnt vmcnt(10)
    v_mfma_f32_32x32x16_bf16 v[156:171], a[64:67], a[248:251], v[156:171]
    buffer_load_dwordx4 v[88:91], v3, s[40:43], s3 offen sc1
    ds_write_b128 v19, v[152:155] offset:224
    v_mfma_f32_32x32x16_bf16 v[172:187], a[68:71], a[248:251], v[172:187]
    s_add_u32 s3, s80, 163840
    s_waitcnt vmcnt(10)
    v_mfma_f32_32x32x16_bf16 v[156:171], a[72:75], a[252:255], v[156:171]
    buffer_load_dwordx4 v[92:95], v3, s[40:43], s3 offen sc1
    v_mfma_f32_32x32x16_bf16 v[172:187], a[76:79], a[252:255], v[172:187]
    s_add_u32 s3, s80, 167936
    s_waitcnt vmcnt(10)
    v_mfma_f32_32x32x16_bf16 v[156:171], a[80:83], v[40:43], v[156:171]
    buffer_load_dwordx4 v[96:99], v3, s[40:43], s3 offen sc1
    v_mfma_f32_32x32x16_bf16 v[172:187], a[84:87], v[40:43], v[172:187]
    s_waitcnt lgkmcnt(0)
    s_barrier
    s_add_u32 s3, s80, 180224
    s_waitcnt vmcnt(10)
    v_mfma_f32_32x32x16_bf16 v[156:171], a[88:91], v[44:47], v[156:171]
    buffer_load_dwordx4 v[100:103], v3, s[40:43], s3 offen sc1
    v_mfma_f32_32x32x16_bf16 v[172:187], a[92:95], v[44:47], v[172:187]
    ds_read_b128 v[32:35], v25 offset:0
    ds_read_b128 v[204:207], v24 offset:0
    s_waitcnt vmcnt(10)
    v_mfma_f32_32x32x16_bf16 v[156:171], a[96:99], v[48:51], v[156:171]
    s_add_u32 s3, s80, 184320
    ds_read_b128 v[208:211], v24 offset:16
    v_mfma_f32_32x32x16_bf16 v[172:187], a[100:103], v[48:51], v[172:187]
    buffer_load_dwordx4 v[104:107], v3, s[40:43], s3 offen sc1
    ds_read_b128 v[212:215], v24 offset:17408
    ds_read_b128 v[216:219], v24 offset:17424
Lst19:
Lch2:
    s_cbranch_execz Lback2
    s_waitcnt vmcnt(9)
    v_mfma_f32_32x32x16_bf16 v[156:171], a[104:107], v[52:55], v[156:171]
    s_add_u32 s3, s80, 196608
    ds_read_b128 v[140:143], v24 offset:34816
    v_mfma_f32_32x32x16_bf16 v[172:187], a[108:111], v[52:55], v[172:187]
    buffer_load_dwordx4 v[108:111], v3, s[40:43], s3 offen sc1
    ds_read_b128 v[144:147], v24 offset:34832
    ds_read_b128 v[148:151], v24 offset:52224
    v_mfma_f32_32x32x16_bf16 v[156:171], a[112:115], v[56:59], v[156:171]
    s_add_u32 s3, s80, 200704
    ds_read_b128 v[152:155], v24 offset:52240
    v_mfma_f32_32x32x16_bf16 v[172:187], a[116:119], v[56:59], v[172:187]
    buffer_load_dwordx4 v[112:115], v3, s[40:43], s3 offen sc1
    s_waitcnt vmcnt(10)
    v_mfma_f32_32x32x16_bf16 v[156:171], a[120:123], v[60:63], v[156:171]
    s_add_u32 s3, s80, 212992
    v_mfma_f32_32x32x16_bf16 v[172:187], a[124:127], v[60:63], v[172:187]
    buffer_load_dwordx4 v[116:119], v3, s[40:43], s3 offen sc1
    s_waitcnt lgkmcnt(8)
    v_lshlrev_b32 v188, 16, v32
    s_waitcnt vmcnt(10)
    v_mfma_f32_32x32x16_bf16 v[156:171], a[128:131], v[76:79], v[156:171]
    s_add_u32 s3, s80, 217088
    v_and_b32 v189, 0xffff0000, v32
    v_lshlrev_b32 v190, 16, v33
    v_and_b32 v191, 0xffff0000, v33
    v_add_f32 v188, v188, v68
    v_add_f32 v189, v189, v69
    v_mfma_f32_32x32x16_bf16 v[172:187], a[132:135], v[76:79], v[172:187]
    buffer_load_dwordx4 v[120:123], v3, s[40:43], s3 offen sc1
    v_add_f32 v190, v190, v70
    s_waitcnt vmcnt(10)
    v_mfma_f32_32x32x16_bf16 v[156:171], a[136:139], v[80:83], v[156:171]
    v_add_f32 v191, v191, v71
    v_lshlrev_b32 v192, 16, v34
    v_and_b32 v193, 0xffff0000, v34
    v_lshlrev_b32 v194, 16, v35
    v_and_b32 v195, 0xffff0000, v35
    v_mfma_f32_32x32x16_bf16 v[172:187], a[140:143], v[80:83], v[172:187]
    v_add_f32 v192, v192, v72
    v_add_f32 v193, v193, v73
    v_add_f32 v194, v194, v74
    v_add_f32 v195, v195, v75
    s_waitcnt vmcnt(9)
    v_mfma_f32_32x32x16_bf16 v[156:171], a[144:147], v[84:87], v[156:171]
    s_waitcnt lgkmcnt(7)
    v_add_f32 v188, v188, v204
    v_add_f32 v189, v189, v205
    v_add_f32 v190, v190, v206
    v_add_f32 v191, v191, v207
    v_mfma_f32_32x32x16_bf16 v[172:187], a[148:151], v[84:87], v[172:187]
    s_waitcnt lgkmcnt(6)
    v_add_f32 v192, v192, v208
    v_add_f32 v193, v193, v209
    v_add_f32 v194, v194, v210
    v_add_f32 v195, v195, v211
    s_waitcnt vmcnt(8)
    v_mfma_f32_32x32x16_bf16 v[156:171], a[152:155], v[88:91], v[156:171]
    s_waitcnt lgkmcnt(5)
    v_add_f32 v188, v188, v212
    v_add_f32 v189, v189, v213
    v_add_f32 v190, v190, v214
    v_add_f32 v191, v191, v215
    s_waitcnt lgkmcnt(4)
    v_add_f32 v192, v192, v216
    v_mfma_f32_32x32x16_bf16 v[172:187], a[156:159], v[88:91], v[172:187]
    v_add_f32 v193, v193, v217
    v_add_f32 v194, v194, v218
    v_add_f32 v195, v195, v219
    s_waitcnt lgkmcnt(3)
    v_add_f32 v188, v188, v140
    s_waitcnt vmcnt(7)
    v_mfma_f32_32x32x16_bf16 v[156:171], a[160:163], v[92:95], v[156:171]
    v_add_f32 v189, v189, v141
    v_add_f32 v190, v190, v142
    v_add_f32 v191, v191, v143
    s_waitcnt lgkmcnt(2)
    v_add_f32 v192, v192, v144
    v_mfma_f32_32x32x16_bf16 v[172:187], a[164:167], v[92:95], v[172:187]
    v_add_f32 v193, v193, v145
    v_add_f32 v194, v194, v146
    v_add_f32 v195, v195, v147
    s_waitcnt lgkmcnt(1)
    v_add_f32 v188, v188, v148
    s_waitcnt vmcnt(6)
    v_mfma_f32_32x32x16_bf16 v[156:171], a[168:171], v[96:99], v[156:171]
    v_add_f32 v189, v189, v149
    v_add_f32 v190, v190, v150
    v_add_f32 v191, v191, v151
    s_waitcnt lgkmcnt(0)
    v_add_f32 v192, v192, v152
    v_add_f32 v193, v193, v153
    v_mfma_f32_32x32x16_bf16 v[172:187], a[172:175], v[96:99], v[172:187]
    v_add_f32 v194, v194, v154
    v_add_f32 v195, v195, v155
    v_cvt_pk_bf16_f32 v36, v188, v189
    v_cvt_pk_bf16_f32 v37, v190, v191
    s_waitcnt vmcnt(5)
    v_mfma_f32_32x32x16_bf16 v[156:171], a[176:179], v[100:103], v[156:171]
    v_cvt_pk_bf16_f32 v38, v192, v193
    v_cvt_pk_bf16_f32 v39, v194, v195
    v_mfma_f32_32x32x16_bf16 v[172:187], a[180:183], v[100:103], v[172:187]
    buffer_store_dwordx4 v[36:39], v26, s[36:39], s78 offen sc1
    s_waitcnt vmcnt(5)
    v_mfma_f32_32x32x16_bf16 v[156:171], a[184:187], v[104:107], v[156:171]
    ds_read_b128 v[32:35], v25 offset:4608
    v_mfma_f32_32x32x16_bf16 v[172:187], a[188:191], v[104:107], v[172:187]
    s_waitcnt vmcnt(4)
    v_mfma_f32_32x32x16_bf16 v[156:171], a[192:195], v[108:111], v[156:171]
    s_waitcnt lgkmcnt(0)
    v_lshlrev_b32 v188, 16, v32
    v_and_b32 v189, 0xffff0000, v32
    v_lshlrev_b32 v190, 16, v33
    v_and_b32 v191, 0xffff0000, v33
    v_mfma_f32_32x32x16_bf16 v[172:187], a[196:199], v[108:111], v[172:187]
    v_add_f32 v188, v188, v68
    v_add_f32 v189, v189, v69
    v_add_f32 v190, v190, v70
    v_add_f32 v191, v191, v71
    s_waitcnt vmcnt(3)
    v_mfma_f32_32x32x16_bf16 v[156:171], a[200:203], v[112:115], v[156:171]
    v_lshlrev_b32 v192, 16, v34
    v_and_b32 v193, 0xffff0000, v34
    v_lshlrev_b32 v194, 16, v35
    v_and_b32 v195, 0xffff0000, v35
    v_mfma_f32_32x32x16_bf16 v[172:187], a[204:207], v[112:115], v[172:187]
    v_add_f32 v192, v192, v72
    v_add_f32 v193, v193, v73
    v_add_f32 v194, v194, v74
    v_add_f32 v195, v195, v75
    s_waitcnt vmcnt(2)
    v_mfma_f32_32x32x16_bf16 v[156:171], a[208:211], v[116:119], v[156:171]
    v_mfma_f32_32x32x16_bf16 v[172:187], a[212:215], v[116:119], v[172:187]
    s_waitcnt vmcnt(1)
    v_mfma_f32_32x32x16_bf16 v[156:171], a[216:219], v[120:123], v[156:171]
    v_mfma_f32_32x32x16_bf16 v[172:187], a[220:223], v[120:123], v[172:187]
    s_cmp_lg_u32 s67, 0
    s_cbranch_scc1 Lg_41
    buffer_store_dwordx2 v[6:7], v10, s[40:43], s51 offen offset:3584 sc1
    buffer_store_dwordx2 v[6:7], v10, s[40:43], s51 offen offset:3840 sc1
Lg_41:
    s_nop 8
    ds_write_b128 v19, v[156:159] offset:8704
    ds_write_b128 v19, v[160:163] offset:8736
    ds_write_b128 v19, v[164:167] offset:8768
    ds_write_b128 v19, v[168:171] offset:8800
    ds_write_b128 v19, v[172:175] offset:8832
    ds_write_b128 v19, v[176:179] offset:8864
    ds_write_b128 v19, v[180:183] offset:8896
    ds_write_b128 v19, v[184:187] offset:8928
    s_waitcnt lgkmcnt(0)
    s_barrier
    ds_read_b128 v[204:207], v24 offset:8704
    ds_read_b128 v[208:211], v24 offset:8720
    ds_read_b128 v[212:215], v24 offset:26112
    ds_read_b128 v[216:219], v24 offset:26128
    ds_read_b128 v[140:143], v24 offset:43520
    ds_read_b128 v[144:147], v24 offset:43536
    ds_read_b128 v[148:151], v24 offset:60928
    ds_read_b128 v[152:155], v24 offset:60944
    s_waitcnt lgkmcnt(7)
    v_pk_add_f32 v[188:189], v[188:189], v[204:205]
    v_pk_add_f32 v[190:191], v[190:191], v[206:207]
    s_waitcnt lgkmcnt(6)
    v_pk_add_f32 v[192:193], v[192:193], v[208:209]
    v_pk_add_f32 v[194:195], v[194:195], v[210:211]
    s_waitcnt lgkmcnt(5)
    v_pk_add_f32 v[188:189], v[188:189], v[212:213]
    v_pk_add_f32 v[190:191], v[190:191], v[214:215]
    s_waitcnt lgkmcnt(4)
    v_pk_add_f32 v[192:193], v[192:193], v[216:217]
    v_pk_add_f32 v[194:195], v[194:195], v[218:219]
    s_waitcnt lgkmcnt(3)
    v_pk_add_f32 v[188:189], v[188:189], v[140:141]
    v_pk_add_f32 v[190:191], v[190:191], v[142:143]
    s_waitcnt lgkmcnt(2)
    v_pk_add_f32 v[192:193], v[192:193], v[144:145]
    v_pk_add_f32 v[194:195], v[194:195], v[146:147]
    s_waitcnt lgkmcnt(1)
    v_pk_add_f32 v[188:189], v[188:189], v[148:149]
    v_pk_add_f32 v[190:191], v[190:191], v[150:151]
    s_waitcnt lgkmcnt(0)
    v_pk_add_f32 v[192:193], v[192:193], v[152:153]
    v_pk_add_f32 v[194:195], v[194:195], v[154:155]
    v_cvt_pk_bf16_f32 v36, v188, v189
    v_cvt_pk_bf16_f32 v37, v190, v191
    v_cvt_pk_bf16_f32 v38, v192, v193
    v_cvt_pk_bf16_f32 v39, v194, v195
    buffer_store_dwordx4 v[36:39], v26, s[36:39], s79 offen sc1
Lfin:
Lend:
    s_endpgm
Lslow3_4:
Lst20:
Lch3:
    s_cbranch_execz Lback2
    s_buffer_load_dwordx16 s[8:23], s[40:43], s53 offset:1024
    s_waitcnt lgkmcnt(0)
    s_xor_b64 s[8:9], s[8:9], s[68:69]
    s_xor_b64 s[10:11], s[10:11], s[68:69]
    s_xor_b64 s[12:13], s[12:13], s[68:69]
    s_xor_b64 s[14:15], s[14:15], s[68:69]
    s_xor_b64 s[16:17], s[16:17], s[68:69]
    s_xor_b64 s[18:19], s[18:19], s[68:69]
    s_xor_b64 s[20:21], s[20:21], s[68:69]
    s_or_b64 s[8:9], s[8:9], s[10:11]
    s_or_b64 s[8:9], s[8:9], s[12:13]
    s_or_b64 s[8:9], s[8:9], s[14:15]
    s_or_b64 s[8:9], s[8:9], s[16:17]
    s_or_b64 s[8:9], s[8:9], s[18:19]
    s_or_b64 s[8:9], s[8:9], s[20:21]
    s_cbranch_scc0 Lok3_4
    s_buffer_load_dwordx16 s[8:23], s[40:43], s53 offset:2048
    s_waitcnt lgkmcnt(0)
    s_xor_b64 s[8:9], s[8:9], s[68:69]
    s_xor_b64 s[10:11], s[10:11], s[68:69]
    s_xor_b64 s[12:13], s[12:13], s[68:69]
    s_xor_b64 s[14:15], s[14:15], s[68:69]
    s_xor_b64 s[16:17], s[16:17], s[68:69]
    s_xor_b64 s[18:19], s[18:19], s[68:69]
    s_xor_b64 s[20:21], s[20:21], s[68:69]
    s_or_b64 s[8:9], s[8:9], s[10:11]
    s_or_b64 s[8:9], s[8:9], s[12:13]
    s_or_b64 s[8:9], s[8:9], s[14:15]
    s_or_b64 s[8:9], s[8:9], s[16:17]
    s_or_b64 s[8:9], s[8:9], s[18:19]
    s_or_b64 s[8:9], s[8:9], s[20:21]
    s_cbranch_scc0 Lok3_4
    s_mov_b32 s97, 2
Lpoll_42:
    buffer_load_dwordx2 v[12:13], v8, s[40:43], s53 offen offset:0 sc1
    s_add_u32 s97, s97, 1
    s_waitcnt vmcnt(0)
    v_cmp_ne_u64 vcc, s[68:69], v[12:13]
    s_cmp_lt_u32 s97, 14
    s_cbranch_vccz Lok3_4
    s_cbranch_scc1 Lpoll_42
    buffer_store_dwordx2 v[6:7], v10, s[40:43], s50 offen offset:3072 sc1
Lpoll_43:
    buffer_load_dwordx2 v[12:13], v8, s[40:43], s53 offen offset:0 sc1
    s_add_u32 s97, s97, 1
    s_waitcnt vmcnt(0)
    v_cmp_ne_u64 s[4:5], s[68:69], v[12:13]
    buffer_load_dwordx2 v[12:13], v8, s[40:43], s53 offen offset:3072 sc1
    s_cmp_gt_u32 s97, 0x40000
    s_waitcnt vmcnt(0)
    s_cbranch_scc1 Lok3_4
    v_cmp_ne_u64 vcc, s[68:69], v[12:13]
    s_nop 0
    s_and_b64 vcc, vcc, s[4:5]
    s_cbranch_scc1 Lpoll_43
    s_branch Lok3_4
Lslow3_5:
    s_buffer_load_dwordx16 s[8:23], s[40:43], s52 offset:1024
    s_waitcnt lgkmcnt(0)
    s_xor_b64 s[8:9], s[8:9], s[68:69]
    s_xor_b64 s[10:11], s[10:11], s[68:69]
    s_xor_b64 s[12:13], s[12:13], s[68:69]
    s_xor_b64 s[14:15], s[14:15], s[68:69]
    s_xor_b64 s[16:17], s[16:17], s[68:69]
    s_xor_b64 s[18:19], s[18:19], s[68:69]
    s_xor_b64 s[20:21], s[20:21], s[68:69]
    s_or_b64 s[8:9], s[8:9], s[10:11]
    s_or_b64 s[8:9], s[8:9], s[12:13]
    s_or_b64 s[8:9], s[8:9], s[14:15]
    s_or_b64 s[8:9], s[8:9], s[16:17]
    s_or_b64 s[8:9], s[8:9], s[18:19]
    s_or_b64 s[8:9], s[8:9], s[20:21]
    s_cbranch_scc0 Lok3_5
    s_buffer_load_dwordx16 s[8:23], s[40:43], s52 offset:2048
    s_waitcnt lgkmcnt(0)
    s_xor_b64 s[8:9], s[8:9], s[68:69]
    s_xor_b64 s[10:11], s[10:11], s[68:69]
    s_xor_b64 s[12:13], s[12:13], s[68:69]
    s_xor_b64 s[14:15], s[14:15], s[68:69]
    s_xor_b64 s[16:17], s[16:17], s[68:69]
    s_xor_b64 s[18:19], s[18:19], s[68:69]
    s_xor_b64 s[20:21], s[20:21], s[68:69]
    s_or_b64 s[8:9], s[8:9], s[10:11]
    s_or_b64 s[8:9], s[8:9], s[12:13]
    s_or_b64 s[8:9], s[8:9], s[14:15]
    s_or_b64 s[8:9], s[8:9], s[16:17]
    s_or_b64 s[8:9], s[8:9], s[18:19]
    s_or_b64 s[8:9], s[8:9], s[20:21]
    s_cbranch_scc0 Lok3_5
    s_mov_b32 s97, 2
Lpoll_44:
    buffer_load_dwordx2 v[12:13], v8, s[40:43], s52 offen offset:0 sc1
    s_add_u32 s97, s97, 1
    s_waitcnt vmcnt(0)
    v_cmp_ne_u64 vcc, s[68:69], v[12:13]
    s_cmp_lt_u32 s97, 14
    s_cbranch_vccz Lok3_5
    s_cbranch_scc1 Lpoll_44
    buffer_store_dwordx2 v[6:7], v10, s[40:43], s50 offen offset:3072 sc1
Lpoll_45:
    buffer_load_dwordx2 v[12:13], v8, s[40:43], s52 offen offset:0 sc1
    s_add_u32 s97, s97, 1
    s_waitcnt vmcnt(0)
    v_cmp_ne_u64 s[4:5], s[68:69], v[12:13]
    buffer_load_dwordx2 v[12:13], v8, s[40:43], s52 offen offset:3072 sc1
    s_cmp_gt_u32 s97, 0x40000
    s_waitcnt vmcnt(0)
    s_cbranch_scc1 Lok3_5
    v_cmp_ne_u64 vcc, s[68:69], v[12:13]
    s_nop 0
    s_and_b64 vcc, vcc, s[4:5]
    s_cbranch_scc1 Lpoll_45
    s_branch Lok3_5
Lslow3_0:
    s_buffer_load_dwordx16 s[8:23], s[40:43], s54 offset:1024
    s_waitcnt lgkmcnt(0)
    s_xor_b64 s[8:9], s[8:9], s[68:69]
    s_xor_b64 s[10:11], s[10:11], s[68:69]
    s_xor_b64 s[12:13], s[12:13], s[68:69]
    s_xor_b64 s[14:15], s[14:15], s[68:69]
    s_xor_b64 s[16:17], s[16:17], s[68:69]
    s_xor_b64 s[18:19], s[18:19], s[68:69]
    s_xor_b64 s[20:21], s[20:21], s[68:69]
    s_or_b64 s[8:9], s[8:9], s[10:11]
    s_or_b64 s[8:9], s[8:9], s[12:13]
    s_or_b64 s[8:9], s[8:9], s[14:15]
    s_or_b64 s[8:9], s[8:9], s[16:17]
    s_or_b64 s[8:9], s[8:9], s[18:19]
    s_or_b64 s[8:9], s[8:9], s[20:21]
    s_cbranch_scc0 Lok3_0
    s_buffer_load_dwordx16 s[8:23], s[40:43], s54 offset:2048
    s_waitcnt lgkmcnt(0)
    s_xor_b64 s[8:9], s[8:9], s[68:69]
    s_xor_b64 s[10:11], s[10:11], s[68:69]
    s_xor_b64 s[12:13], s[12:13], s[68:69]
    s_xor_b64 s[14:15], s[14:15], s[68:69]
    s_xor_b64 s[16:17], s[16:17], s[68:69]
    s_xor_b64 s[18:19], s[18:19], s[68:69]
    s_xor_b64 s[20:21], s[20:21], s[68:69]
    s_or_b64 s[8:9], s[8:9], s[10:11]
    s_or_b64 s[8:9], s[8:9], s[12:13]
    s_or_b64 s[8:9], s[8:9], s[14:15]
    s_or_b64 s[8:9], s[8:9], s[16:17]
    s_or_b64 s[8:9], s[8:9], s[18:19]
    s_or_b64 s[8:9], s[8:9], s[20:21]
    s_cbranch_scc0 Lok3_0
    s_mov_b32 s97, 2
Lpoll_46:
    buffer_load_dwordx2 v[12:13], v8, s[40:43], s54 offen offset:0 sc1
    s_add_u32 s97, s97, 1
    s_waitcnt vmcnt(0)
    v_cmp_ne_u64 vcc, s[68:69], v[12:13]
    s_cmp_lt_u32 s97, 14
    s_cbranch_vccz Lok3_0
    s_cbranch_scc1 Lpoll_46
    buffer_store_dwordx2 v[6:7], v10, s[40:43], s51 offen offset:3072 sc1
Lpoll_47:
    buffer_load_dwordx2 v[12:13], v8, s[40:43], s54 offen offset:0 sc1
    s_add_u32 s97, s97, 1
    s_waitcnt vmcnt(0)
    v_cmp_ne_u64 s[4:5], s[68:69], v[12:13]
    buffer_load_dwordx2 v[12:13], v8, s[40:43], s54 offen offset:3072 sc1
    s_cmp_gt_u32 s97, 0x40000
    s_waitcnt vmcnt(0)
    s_cbranch_scc1 Lok3_0
    v_cmp_ne_u64 vcc, s[68:69], v[12:13]
    s_nop 0
    s_and_b64 vcc, vcc, s[4:5]
    s_cbranch_scc1 Lpoll_47
    s_branch Lok3_0
Lslow3_1:
    s_buffer_load_dwordx16 s[8:23], s[40:43], s81 offset:1280
    s_waitcnt lgkmcnt(0)
    s_xor_b64 s[8:9], s[8:9], s[68:69]
    s_xor_b64 s[10:11], s[10:11], s[68:69]
    s_xor_b64 s[12:13], s[12:13], s[68:69]
    s_xor_b64 s[14:15], s[14:15], s[68:69]
    s_xor_b64 s[16:17], s[16:17], s[68:69]
    s_xor_b64 s[18:19], s[18:19], s[68:69]
    s_xor_b64 s[20:21], s[20:21], s[68:69]
    s_or_b64 s[8:9], s[8:9], s[10:11]
    s_or_b64 s[8:9], s[8:9], s[12:13]
    s_or_b64 s[8:9], s[8:9], s[14:15]
    s_or_b64 s[8:9], s[8:9], s[16:17]
    s_or_b64 s[8:9], s[8:9], s[18:19]
    s_or_b64 s[8:9], s[8:9], s[20:21]
    s_cbranch_scc0 Lok3_1
    s_buffer_load_dwordx16 s[8:23], s[40:43], s81 offset:2304
    s_waitcnt lgkmcnt(0)
    s_xor_b64 s[8:9], s[8:9], s[68:69]
    s_xor_b64 s[10:11], s[10:11], s[68:69]
    s_xor_b64 s[12:13], s[12:13], s[68:69]
    s_xor_b64 s[14:15], s[14:15], s[68:69]
    s_xor_b64 s[16:17], s[16:17], s[68:69]
    s_xor_b64 s[18:19], s[18:19], s[68:69]
    s_xor_b64 s[20:21], s[20:21], s[68:69]
    s_or_b64 s[8:9], s[8:9], s[10:11]
    s_or_b64 s[8:9], s[8:9], s[12:13]
    s_or_b64 s[8:9], s[8:9], s[14:15]
    s_or_b64 s[8:9], s[8:9], s[16:17]
    s_or_b64 s[8:9], s[8:9], s[18:19]
    s_or_b64 s[8:9], s[8:9], s[20:21]
    s_cbranch_scc0 Lok3_1
    s_mov_b32 s97, 2
Lpoll_48:
    buffer_load_dwordx2 v[12:13], v8, s[40:43], s81 offen offset:256 sc1
    s_add_u32 s97, s97, 1
    s_waitcnt vmcnt(0)
    v_cmp_ne_u64 vcc, s[68:69], v[12:13]
    s_cmp_lt_u32 s97, 14
    s_cbranch_vccz Lok3_1
    s_cbranch_scc1 Lpoll_48
    buffer_store_dwordx2 v[6:7], v10, s[40:43], s51 offen offset:3072 sc1
    buffer_store_dwordx2 v[6:7], v10, s[40:43], s51 offen offset:3328 sc1
Lpoll_49:
    buffer_load_dwordx2 v[12:13], v8, s[40:43], s81 offen offset:256 sc1
    s_add_u32 s97, s97, 1
    s_waitcnt vmcnt(0)
    v_cmp_ne_u64 s[4:5], s[68:69], v[12:13]
    buffer_load_dwordx2 v[12:13], v8, s[40:43], s81 offen offset:3328 sc1
    s_cmp_gt_u32 s97, 0x40000
    s_waitcnt vmcnt(0)
    s_cbranch_scc1 Lok3_1
    v_cmp_ne_u64 vcc, s[68:69], v[12:13]
    s_nop 0
    s_and_b64 vcc, vcc, s[4:5]
    s_cbranch_scc1 Lpoll_49
    s_branch Lok3_1
Lslow3_2:
    s_buffer_load_dwordx16 s[8:23], s[40:43], s54 offset:1536
    s_waitcnt lgkmcnt(0)
    s_xor_b64 s[8:9], s[8:9], s[68:69]
    s_xor_b64 s[10:11], s[10:11], s[68:69]
    s_xor_b64 s[12:13], s[12:13], s[68:69]
    s_xor_b64 s[14:15], s[14:15], s[68:69]
    s_xor_b64 s[16:17], s[16:17], s[68:69]
    s_xor_b64 s[18:19], s[18:19], s[68:69]
    s_xor_b64 s[20:21], s[20:21], s[68:69]
    s_or_b64 s[8:9], s[8:9], s[10:11]
    s_or_b64 s[8:9], s[8:9], s[12:13]
    s_or_b64 s[8:9], s[8:9], s[14:15]
    s_or_b64 s[8:9], s[8:9], s[16:17]
    s_or_b64 s[8:9], s[8:9], s[18:19]
    s_or_b64 s[8:9], s[8:9], s[20:21]
    s_cbranch_scc0 Lok3_2
    s_buffer_load_dwordx16 s[8:23], s[40:43], s54 offset:2560
    s_waitcnt lgkmcnt(0)
    s_xor_b64 s[8:9], s[8:9], s[68:69]
    s_xor_b64 s[10:11], s[10:11], s[68:69]
    s_xor_b64 s[12:13], s[12:13], s[68:69]
    s_xor_b64 s[14:15], s[14:15], s[68:69]
    s_xor_b64 s[16:17], s[16:17], s[68:69]
    s_xor_b64 s[18:19], s[18:19], s[68:69]
    s_xor_b64 s[20:21], s[20:21], s[68:69]
    s_or_b64 s[8:9], s[8:9], s[10:11]
    s_or_b64 s[8:9], s[8:9], s[12:13]
    s_or_b64 s[8:9], s[8:9], s[14:15]
    s_or_b64 s[8:9], s[8:9], s[16:17]
    s_or_b64 s[8:9], s[8:9], s[18:19]
    s_or_b64 s[8:9], s[8:9], s[20:21]
    s_cbranch_scc0 Lok3_2
    s_mov_b32 s97, 2
Lpoll_50:
    buffer_load_dwordx2 v[12:13], v8, s[40:43], s54 offen offset:512 sc1
    s_add_u32 s97, s97, 1
    s_waitcnt vmcnt(0)
    v_cmp_ne_u64 vcc, s[68:69], v[12:13]
    s_cmp_lt_u32 s97, 14
    s_cbranch_vccz Lok3_2
    s_cbranch_scc1 Lpoll_50
    buffer_store_dwordx2 v[6:7], v10, s[40:43], s51 offen offset:3072 sc1
    buffer_store_dwordx2 v[6:7], v10, s[40:43], s51 offen offset:3328 sc1
    buffer_store_dwordx2 v[6:7], v10, s[40:43], s51 offen offset:3584 sc1
Lpoll_51:
    buffer_load_dwordx2 v[12:13], v8, s[40:43], s54 offen offset:512 sc1
    s_add_u32 s97, s97, 1
    s_waitcnt vmcnt(0)
    v_cmp_ne_u64 s[4:5], s[68:69], v[12:13]
    buffer_load_dwordx2 v[12:13], v8, s[40:43], s54 offen offset:3584 sc1
    s_cmp_gt_u32 s97, 0x40000
    s_waitcnt vmcnt(0)
    s_cbranch_scc1 Lok3_2
    v_cmp_ne_u64 vcc, s[68:69], v[12:13]
    s_nop 0
    s_and_b64 vcc, vcc, s[4:5]
    s_cbranch_scc1 Lpoll_51
    s_branch Lok3_2
Lslow3_3:
    s_buffer_load_dwordx16 s[8:23], s[40:43], s81 offset:1792
    s_waitcnt lgkmcnt(0)
    s_xor_b64 s[8:9], s[8:9], s[68:69]
    s_xor_b64 s[10:11], s[10:11], s[68:69]
    s_xor_b64 s[12:13], s[12:13], s[68:69]
    s_xor_b64 s[14:15], s[14:15], s[68:69]
    s_xor_b64 s[16:17], s[16:17], s[68:69]
    s_xor_b64 s[18:19], s[18:19], s[68:69]
    s_xor_b64 s[20:21], s[20:21], s[68:69]
    s_or_b64 s[8:9], s[8:9], s[10:11]
    s_or_b64 s[8:9], s[8:9], s[12:13]
    s_or_b64 s[8:9], s[8:9], s[14:15]
    s_or_b64 s[8:9], s[8:9], s[16:17]
    s_or_b64 s[8:9], s[8:9], s[18:19]
    s_or_b64 s[8:9], s[8:9], s[20:21]
    s_cbranch_scc0 Lok3_3
    s_buffer_load_dwordx16 s[8:23], s[40:43], s81 offset:2816
    s_waitcnt lgkmcnt(0)
    s_xor_b64 s[8:9], s[8:9], s[68:69]
    s_xor_b64 s[10:11], s[10:11], s[68:69]
    s_xor_b64 s[12:13], s[12:13], s[68:69]
    s_xor_b64 s[14:15], s[14:15], s[68:69]
    s_xor_b64 s[16:17], s[16:17], s[68:69]
    s_xor_b64 s[18:19], s[18:19], s[68:69]
    s_xor_b64 s[20:21], s[20:21], s[68:69]
    s_or_b64 s[8:9], s[8:9], s[10:11]
    s_or_b64 s[8:9], s[8:9], s[12:13]
    s_or_b64 s[8:9], s[8:9], s[14:15]
    s_or_b64 s[8:9], s[8:9], s[16:17]
    s_or_b64 s[8:9], s[8:9], s[18:19]
    s_or_b64 s[8:9], s[8:9], s[20:21]
    s_cbranch_scc0 Lok3_3
    s_mov_b32 s97, 2
Lpoll_52:
    buffer_load_dwordx2 v[12:13], v8, s[40:43], s81 offen offset:768 sc1
    s_add_u32 s97, s97, 1
    s_waitcnt vmcnt(0)
    v_cmp_ne_u64 vcc, s[68:69], v[12:13]
    s_cmp_lt_u32 s97, 14
    s_cbranch_vccz Lok3_3
    s_cbranch_scc1 Lpoll_52
    buffer_store_dwordx2 v[6:7], v10, s[40:43], s51 offen offset:3072 sc1
    buffer_store_dwordx2 v[6:7], v10, s[40:43], s51 offen offset:3328 sc1
    buffer_store_dwordx2 v[6:7], v10, s[40:43], s51 offen offset:3584 sc1
    buffer_store_dwordx2 v[6:7], v10, s[40:43], s51 offen offset:3840 sc1
Lpoll_53:
    buffer_load_dwordx2 v[12:13], v8, s[40:43], s81 offen offset:768 sc1
    s_add_u32 s97, s97, 1
    s_waitcnt vmcnt(0)
    v_cmp_ne_u64 s[4:5], s[68:69], v[12:13]
    buffer_load_dwordx2 v[12:13], v8, s[40:43], s81 offen offset:3840 sc1
    s_cmp_gt_u32 s97, 0x40000
    s_waitcnt vmcnt(0)
    s_cbranch_scc1 Lok3_3
    v_cmp_ne_u64 vcc, s[68:69], v[12:13]
    s_nop 0
    s_and_b64 vcc, vcc, s[4:5]
    s_cbranch_scc1 Lpoll_53
    s_branch Lok3_3
LpB1:
    buffer_store_dwordx2 v[6:7], v10, s[40:43], s49 offen offset:2048 sc1
Lpoll_54:
    buffer_load_dwordx2 v[12:13], v5, s[40:43], s52 offen offset:0 sc1
    s_add_u32 s97, s97, 1
    s_waitcnt vmcnt(0)
    v_cmp_ne_u64 s[4:5], s[68:69], v[12:13]
    buffer_load_dwordx2 v[12:13], v5, s[40:43], s52 offen offset:2048 sc1
    s_cmp_gt_u32 s97, 0x40000
    s_waitcnt vmcnt(0)
    s_cbranch_scc1 LpK1
    v_cmp_ne_u64 vcc, s[68:69], v[12:13]
    s_nop 0
    s_and_b64 vcc, vcc, s[4:5]
    s_cbranch_scc1 Lpoll_54
    s_branch LpK1
Lxd_6:
    s_mov_b32 s97, 0
Lxp_5:
    buffer_load_dwordx4 v[120:123], v3, s[40:43], s93 offen sc1
    s_add_u32 s97, s97, 1
    s_cmp_gt_u32 s97, 0x40000
    s_waitcnt vmcnt(0)
    s_cbranch_scc1 Lxk_4
    v_cmp_ne_u32 vcc, s68, v121
    v_cmp_ne_u32 s[6:7], s69, v123
    s_nop 0
    s_or_b64 vcc, vcc, s[6:7]
    s_cbranch_scc1 Lxp_5
    s_branch Lxk_4
Lxd_10:
    s_mov_b32 s97, 0
Lxp_9:
    buffer_load_dwordx4 v[40:43], v3, s[40:43], s93 offen sc1
    buffer_load_dwordx4 v[120:123], v3, s[40:43], s94 offen sc1
    s_add_u32 s97, s97, 1
    s_cmp_gt_u32 s97, 0x40000
    s_waitcnt vmcnt(0)
    s_cbranch_scc1 Lxk_8
    v_cmp_ne_u32 vcc, s68, v41
    v_cmp_ne_u32 s[6:7], s69, v43
    s_nop 0
    s_or_b64 vcc, vcc, s[6:7]
    v_cmp_ne_u32 s[4:5], s68, v121
    v_cmp_ne_u32 s[6:7], s69, v123
    s_or_b64 vcc, vcc, s[4:5]
    s_or_b64 vcc, vcc, s[6:7]
    s_cbranch_scc1 Lxp_9
    s_branch Lxk_8
Lxd_14:
    s_mov_b32 s97, 0
Lxp_13:
    buffer_load_dwordx4 v[40:43], v3, s[40:43], s93 offen sc1
    buffer_load_dwordx4 v[120:123], v3, s[40:43], s94 offen sc1
    s_add_u32 s97, s97, 1
    s_cmp_gt_u32 s97, 0x40000
    s_waitcnt vmcnt(0)
    s_cbranch_scc1 Lxk_12
    v_cmp_ne_u32 vcc, s68, v41
    v_cmp_ne_u32 s[6:7], s69, v43
    s_nop 0
    s_or_b64 vcc, vcc, s[6:7]
    v_cmp_ne_u32 s[4:5], s68, v121
    v_cmp_ne_u32 s[6:7], s69, v123
    s_or_b64 vcc, vcc, s[4:5]
    s_or_b64 vcc, vcc, s[6:7]
    s_cbranch_scc1 Lxp_13
    s_branch Lxk_12
Lxd_18:
    s_mov_b32 s97, 0
Lxp_17:
    buffer_load_dwordx4 v[40:43], v3, s[40:43], s93 offen sc1
    buffer_load_dwordx4 v[176:179], v3, s[40:43], s94 offen sc1
    s_add_u32 s97, s97, 1
    s_cmp_gt_u32 s97, 0x40000
    s_waitcnt vmcnt(0)
    s_cbranch_scc1 Lxk_16
    v_cmp_ne_u32 vcc, s68, v41
    v_cmp_ne_u32 s[6:7], s69, v43
    s_nop 0
    s_or_b64 vcc, vcc, s[6:7]
    v_cmp_ne_u32 s[4:5], s68, v177
    v_cmp_ne_u32 s[6:7], s69, v179
    s_or_b64 vcc, vcc, s[4:5]
    s_or_b64 vcc, vcc, s[6:7]
    s_cbranch_scc1 Lxp_17
    s_branch Lxk_16
Lxd_22:
    s_mov_b32 s97, 0
Lxp_21:
    buffer_load_dwordx4 v[40:43], v3, s[40:43], s93 offen sc1
    buffer_load_dwordx4 v[120:123], v3, s[40:43], s94 offen sc1
    s_add_u32 s97, s97, 1
    s_cmp_gt_u32 s97, 0x40000
    s_waitcnt vmcnt(0)
    s_cbranch_scc1 Lxk_20
    v_cmp_ne_u32 vcc, s68, v41
    v_cmp_ne_u32 s[6:7], s69, v43
    s_nop 0
    s_or_b64 vcc, vcc, s[6:7]
    v_cmp_ne_u32 s[4:5], s68, v121
    v_cmp_ne_u32 s[6:7], s69, v123
    s_or_b64 vcc, vcc, s[4:5]
    s_or_b64 vcc, vcc, s[6:7]
    s_cbranch_scc1 Lxp_21
    s_branch Lxk_20
Lxd_26:
    s_mov_b32 s97, 0
Lxp_25:
    buffer_load_dwordx4 v[40:43], v3, s[40:43], s93 offen sc1
    buffer_load_dwordx4 v[120:123], v3, s[40:43], s94 offen sc1
    s_add_u32 s97, s97, 1
    s_cmp_gt_u32 s97, 0x40000
    s_waitcnt vmcnt(0)
    s_cbranch_scc1 Lxk_24
    v_cmp_ne_u32 vcc, s68, v41
    v_cmp_ne_u32 s[6:7], s69, v43
    s_nop 0
    s_or_b64 vcc, vcc, s[6:7]
    v_cmp_ne_u32 s[4:5], s68, v121
    v_cmp_ne_u32 s[6:7], s69, v123
    s_or_b64 vcc, vcc, s[4:5]
    s_or_b64 vcc, vcc, s[6:7]
    s_cbranch_scc1 Lxp_25
    s_branch Lxk_24
Lxd_30:
    s_mov_b32 s97, 0
Lxp_29:
    buffer_load_dwordx4 v[40:43], v3, s[40:43], s93 offen sc1
    s_add_u32 s97, s97, 1
    s_cmp_gt_u32 s97, 0x40000
    s_waitcnt vmcnt(0)
    s_cbranch_scc1 Lxk_28
    v_cmp_ne_u32 vcc, s68, v41
    v_cmp_ne_u32 s[6:7], s69, v43
    s_nop 0
    s_or_b64 vcc, vcc, s[6:7]
    s_cbranch_scc1 Lxp_29
    s_branch Lxk_28
.p2align 8
.fill 4608, 4, 0xbf800000
.section .rodata,"a"
.p2align 6
.amdhsa_kernel sequential_preLN__sliding_local_dilated__dense_activation_gelu__prompt_kernel
  .amdhsa_next_free_vgpr 512
  .amdhsa_next_free_sgpr 102
  .amdhsa_accum_offset 256
  .amdhsa_group_segment_fixed_size 0
  .amdhsa_kernarg_size 88
  .amdhsa_user_sgpr_count 2
  .amdhsa_user_sgpr_kernarg_segment_ptr 1
  .amdhsa_system_sgpr_workgroup_id_x 1
.end_amdhsa_kernel
```
